```python
import torch

def _softmax(x, axis=-1):
    return torch.softmax(x, dim=axis)
def _gelu(x):
    return torch.nn.functional.gelu(x, approximate="tanh")
def _silu(x):
    return torch.nn.functional.silu(x)
def _sigmoid(x):
    return torch.sigmoid(x)
def _layernorm(x, axis=-1, eps=1e-5):
    m = x.mean(dim=axis, keepdim=True)
    v = x.var(dim=axis, keepdim=True, unbiased=False)
    return (x - m) / torch.sqrt(v + eps)
def _scatter_add(tgt, idx, src, axis=0):
    return tgt.clone().index_add_(axis, idx, src)
def _segment_sum(src, seg, n):
    out = torch.zeros((n,) + src.shape[1:], dtype=src.dtype)
    return out.index_add_(0, seg, src)
def _pad(x, pw):
    flat = tuple(v for pair in reversed(pw) for v in pair)
    return torch.nn.functional.pad(x, flat)

kernel_name = 'concat_heads__mha_block__compressed_kv_cla__prompt'

def setup_inputs():

    _w = (lambda a: (lambda t: t.to(torch.bfloat16) if t.is_floating_point() else t)(torch.as_tensor(a)))
    def _A_setup():
        B, S, D, H = 1, 2048, 512, 32
        return {
            "x": _w((lambda *s: torch.randn(*s, dtype=torch.bfloat16) * 0.4)(B, S, D)),
            "wqkv": _w((lambda *s: torch.randn(*s, dtype=torch.bfloat16) * 0.4)(D, 3 * D)),
            "wo": _w((lambda *s: torch.randn(*s, dtype=torch.bfloat16) * 0.05)(D, D)),
        }
    _A_in = _A_setup()

    def _B_setup():
        B, H, Sq, Sk, D, M = 1, 32, 2048, 2048, 128, 512
        Dc = 4 * D
        return {
            "x": _w((lambda *s: torch.randn(*s, dtype=torch.bfloat16) * 0.2)(B, Sq, M)),
            "c_kv": _w((lambda *s: torch.randn(*s, dtype=torch.bfloat16) * 1.6)(B, Sk, Dc)),
            "w_q": _w((lambda *s: torch.randn(*s, dtype=torch.bfloat16) * 3.2)(M, H, D) * (M ** -0.5)),
            "w_uk": _w((lambda *s: torch.randn(*s, dtype=torch.bfloat16) * 3.2)(Dc, H, D) * (Dc ** -0.5)),
            "w_uv": _w((lambda *s: torch.randn(*s, dtype=torch.bfloat16) * 1.6)(Dc, H, D) * (Dc ** -0.5)),
            "w_o": _w((lambda *s: torch.randn(*s, dtype=torch.bfloat16) * 1.6)(H, D, M) * ((H * D) ** -0.5)),
        }
    _B_in = _B_setup()

    return {
        "A_x": _A_in["x"],
        "A_wqkv": _A_in["wqkv"],
        "A_wo": _A_in["wo"],
        "B_x": _B_in["x"],
        "B_c_kv": _B_in["c_kv"],
        "B_w_q": _B_in["w_q"],
        "B_w_uk": _B_in["w_uk"],
        "B_w_uv": _B_in["w_uv"],
        "B_w_o": _B_in["w_o"],
    }

def reference(A_x, A_wqkv, A_wo, B_x, B_c_kv, B_w_q, B_w_uk, B_w_uv, B_w_o):
    def _A_ref(x, wqkv, wo):
        B, S, D = x.shape
        H = 32
        Dh = D // H
        qkv = (lambda x, *d: x.permute(*d))((x @ wqkv).reshape(B, S, 3, H, Dh), 2, 0, 3, 1, 4)
        q, k, v = qkv[0], qkv[1], qkv[2]
        scores = torch.einsum("bhqd,bhkd->bhqk", q, k) * (Dh ** -0.5)
        p = _softmax(scores, axis=-1)
        o = torch.einsum("bhqk,bhkd->bhqd", p, v)
        return (lambda x, *d: x.permute(*d))(o, 0, 2, 1, 3).reshape(B, S, D) @ wo

    def _B_ref(x, c_kv, w_q, w_uk, w_uv, w_o):
        B, Sq, M = x.shape[0], x.shape[1], x.shape[2]
        Sk = c_kv.shape[1]
        H, D = w_q.shape[1], w_q.shape[2]
        q = torch.einsum("bqm,mhd->bhqd", x, w_q)
        k = torch.einsum("bkc,chd->bhkd", c_kv, w_uk)
        v = torch.einsum("bkc,chd->bhkd", c_kv, w_uv)
        scores = torch.einsum("bhqd,bhkd->bhqk", q, k) * (D ** -0.5)
        off = Sk - Sq
        qi = torch.arange(Sq)[:, None]
        kj = torch.arange(Sk)[None, :]
        cmask = kj <= (qi + off)
        scores = torch.where(cmask[None, None], scores, -1e9)
        p = _softmax(scores, axis=-1)
        ctx = torch.einsum("bhqk,bhkd->bhqd", p, v)
        return torch.einsum("bhqd,hdm->bqm", ctx, w_o)

    a = _A_ref(A_x, A_wqkv, A_wo)
    b = _B_ref(B_x, B_c_kv, B_w_q, B_w_uk, B_w_uv, B_w_o)
    return torch.concatenate([a, b], axis=-1)
```

```asm
; @launch grid=(256,1,1) block=(512,1,1) lds=163840
.amdgcn_target "amdgcn-amd-amdhsa--gfx950"
.text
.globl concat_heads__mha_block__compressed_kv_cla__prompt_kernel
.p2align 8
.type concat_heads__mha_block__compressed_kv_cla__prompt_kernel,@function
concat_heads__mha_block__compressed_kv_cla__prompt_kernel:
    s_cmp_ge_u32 s2, 256
    s_cbranch_scc1 MEGA_END
    s_load_dwordx2 s[56:57], s[0:1], 88
    s_load_dwordx2 s[68:69], s[0:1], 32
    s_load_dwordx2 s[70:71], s[0:1], 48
    s_load_dwordx2 s[72:73], s[0:1], 56
    s_load_dwordx2 s[74:75], s[0:1], 0
    s_load_dwordx2 s[76:77], s[0:1], 8
    s_load_dwordx2 s[78:79], s[0:1], 24
    s_load_dwordx2 s[80:81], s[0:1], 40
    s_load_dwordx2 s[82:83], s[0:1], 64
    s_load_dwordx2 s[84:85], s[0:1], 16
    s_load_dwordx2 s[86:87], s[0:1], 88
    v_and_b32 v15, 63, v0
    v_lshlrev_b32 v1, 4, v15
    v_and_b32 v8, 0x3ff, v0
    v_lshrrev_b32 v8, 6, v8
    s_and_b32 s25, s2, 7
    s_lshl_b32 s25, s25, 2
    v_readfirstlane_b32 s18, v8
    s_bfe_u32 s16, s2, 0x20003
    s_add_u32 s16, s16, s25
    s_lshr_b32 s17, s2, 5
    v_lshrrev_b32 v6, 4, v15
    s_and_b32 s30, s18, 3
    v_lshrrev_b32 v7, 3, v15
    v_lshlrev_b32 v7, 10, v7
    v_and_b32 v9, 7, v15
    v_xor_b32 v9, v6, v9
    v_lshl_add_u32 v16, v9, 4, v7
    v_xor_b32 v10, 64, v16
    v_add_u32 v17, 7168, v10
    v_add_u32 v18, 14336, v16
    v_add_u32 v19, 21504, v10
    v_and_b32 v9, 15, v15
    v_lshlrev_b32 v10, 1, v6
    v_xor_b32 v9, v10, v9
    v_lshlrev_b32 v9, 4, v9
    v_lshlrev_b32 v7, 13, v6
    s_lshl_b32 s25, s30, 17
    v_add_u32 v7, s25, v7
    v_xor_b32 v10, 128, v9
    v_add_u32 v20, v7, v9
    v_add_u32 v21, v7, v9
    v_add_u32 v21, 31744, v21
    v_add_u32 v22, v7, v10
    v_add_u32 v22, 63488, v22
    v_add_u32 v23, v7, v10
    v_add_u32 v23, 95232, v23
    s_lshl_b32 s47, s30, 13
    s_add_u32 s47, s47, 16384
    s_lshl_b32 s48, s30, 12
    s_waitcnt lgkmcnt(0)
    s_add_u32 s56, s56, 77594624
    s_addc_u32 s57, s57, 0
    s_mov_b32 s58, 10240
    s_mov_b32 s59, 0x20000
    s_mov_b32 s12, s86
    s_mov_b32 s13, s87
    s_mov_b32 s14, 77594624
    s_mov_b32 s15, 0x20000
    s_mov_b32 s8, s68
    s_mov_b32 s9, s69
    s_mov_b32 s10, 2097152
    s_mov_b32 s11, 0x20000
    s_cmp_ge_u32 s18, 4
    s_cbranch_scc1 a_G_GB
    s_mov_b32 s36, s70
    s_mov_b32 s37, s71
    s_mov_b32 s38, 4194304
    s_mov_b32 s39, 0x20000
    s_lshl_b32 s44, s17, 18
    s_lshl_b32 s25, s30, 16
    s_add_u32 s44, s44, s25
    s_add_u32 s54, s44, 32768
    s_lshl_b32 s45, s16, 8
    s_mov_b32 s43, 16384
    s_add_u32 m0, s43, s47
    s_nop 0
    buffer_load_dwordx4 v16, s[8:11], s44 offen offset:0 lds
    buffer_load_dwordx4 v17, s[8:11], s44 offen offset:1024 lds
    buffer_load_dwordx4 v18, s[8:11], s44 offen offset:2048 lds
    buffer_load_dwordx4 v19, s[8:11], s44 offen offset:3072 lds
    s_add_u32 m0, m0, 4096
    s_nop 0
    buffer_load_dwordx4 v16, s[8:11], s54 offen offset:0 lds
    buffer_load_dwordx4 v17, s[8:11], s54 offen offset:1024 lds
    buffer_load_dwordx4 v18, s[8:11], s54 offen offset:2048 lds
    buffer_load_dwordx4 v19, s[8:11], s54 offen offset:3072 lds
    s_add_u32 m0, s43, s48
    s_nop 0
    buffer_load_dwordx4 v20, s[36:39], s45 offen offset:0 lds
    buffer_load_dwordx4 v21, s[36:39], s45 offen offset:1024 lds
    buffer_load_dwordx4 v22, s[36:39], s45 offen offset:2048 lds
    buffer_load_dwordx4 v23, s[36:39], s45 offen offset:3072 lds
    s_add_u32 s44, s44, 128
    s_add_u32 s54, s54, 128
    s_add_u32 s45, s45, 524288
    s_mov_b32 s43, 65536
    s_add_u32 m0, s43, s47
    s_nop 0
    buffer_load_dwordx4 v16, s[8:11], s44 offen offset:0 lds
    buffer_load_dwordx4 v17, s[8:11], s44 offen offset:1024 lds
    buffer_load_dwordx4 v18, s[8:11], s44 offen offset:2048 lds
    buffer_load_dwordx4 v19, s[8:11], s44 offen offset:3072 lds
    s_add_u32 m0, m0, 4096
    s_nop 0
    buffer_load_dwordx4 v16, s[8:11], s54 offen offset:0 lds
    buffer_load_dwordx4 v17, s[8:11], s54 offen offset:1024 lds
    buffer_load_dwordx4 v18, s[8:11], s54 offen offset:2048 lds
    buffer_load_dwordx4 v19, s[8:11], s54 offen offset:3072 lds
    s_add_u32 m0, s43, s48
    s_nop 0
    buffer_load_dwordx4 v20, s[36:39], s45 offen offset:0 lds
    buffer_load_dwordx4 v21, s[36:39], s45 offen offset:1024 lds
    buffer_load_dwordx4 v22, s[36:39], s45 offen offset:2048 lds
    buffer_load_dwordx4 v23, s[36:39], s45 offen offset:3072 lds
    s_add_u32 s44, s44, 128
    s_add_u32 s54, s54, 128
    s_add_u32 s45, s45, 524288
    v_and_b32 v7, 15, v15
    v_lshrrev_b32 v9, 1, v7
    v_xor_b32 v9, v6, v9
    v_lshlrev_b32 v9, 4, v9
    v_lshl_add_u32 v9, v7, 7, v9
    s_lshl_b32 s25, s30, 13
    s_add_u32 s25, s25, 16384
    v_add_u32 v240, s25, v9
    v_xor_b32 v241, 64, v240
    v_lshrrev_b32 v9, 2, v7
    v_lshl_add_u32 v10, v6, 3, v9
    v_lshlrev_b32 v10, 8, v10
    v_and_b32 v160, 3, v7
    v_lshl_add_u32 v10, v160, 3, v10
    v_add_u32 v10, 16384, v10
    v_and_b32 v160, 1, v6
    v_lshl_add_u32 v9, v160, 2, v9
    v_xor_b32 v160, 0, v9
    v_lshl_add_u32 v242, v160, 5, v10
    v_xor_b32 v160, 1, v9
    v_lshl_add_u32 v243, v160, 5, v10
    v_xor_b32 v160, 2, v9
    v_lshl_add_u32 v244, v160, 5, v10
    v_xor_b32 v160, 3, v9
    v_lshl_add_u32 v245, v160, 5, v10
    v_xor_b32 v160, 4, v9
    v_lshl_add_u32 v246, v160, 5, v10
    v_xor_b32 v160, 5, v9
    v_lshl_add_u32 v247, v160, 5, v10
    v_xor_b32 v160, 6, v9
    v_lshl_add_u32 v248, v160, 5, v10
    v_xor_b32 v160, 7, v9
    v_lshl_add_u32 v249, v160, 5, v10
    s_mov_b32 s40, 49152
    s_mov_b32 s41, 49152
    s_mov_b32 s42, 4294868992
    v_mov_b64 v[32:33], 0
    v_mov_b64 v[34:35], 0
    v_mov_b64 v[36:37], 0
    v_mov_b64 v[38:39], 0
    v_mov_b64 v[40:41], 0
    v_mov_b64 v[42:43], 0
    v_mov_b64 v[44:45], 0
    v_mov_b64 v[46:47], 0
    v_mov_b64 v[48:49], 0
    v_mov_b64 v[50:51], 0
    v_mov_b64 v[52:53], 0
    v_mov_b64 v[54:55], 0
    v_mov_b64 v[56:57], 0
    v_mov_b64 v[58:59], 0
    v_mov_b64 v[60:61], 0
    v_mov_b64 v[62:63], 0
    v_mov_b64 v[64:65], 0
    v_mov_b64 v[66:67], 0
    v_mov_b64 v[68:69], 0
    v_mov_b64 v[70:71], 0
    v_mov_b64 v[72:73], 0
    v_mov_b64 v[74:75], 0
    v_mov_b64 v[76:77], 0
    v_mov_b64 v[78:79], 0
    v_mov_b64 v[80:81], 0
    v_mov_b64 v[82:83], 0
    v_mov_b64 v[84:85], 0
    v_mov_b64 v[86:87], 0
    v_mov_b64 v[88:89], 0
    v_mov_b64 v[90:91], 0
    v_mov_b64 v[92:93], 0
    v_mov_b64 v[94:95], 0
    v_mov_b64 v[96:97], 0
    v_mov_b64 v[98:99], 0
    v_mov_b64 v[100:101], 0
    v_mov_b64 v[102:103], 0
    v_mov_b64 v[104:105], 0
    v_mov_b64 v[106:107], 0
    v_mov_b64 v[108:109], 0
    v_mov_b64 v[110:111], 0
    v_mov_b64 v[112:113], 0
    v_mov_b64 v[114:115], 0
    v_mov_b64 v[116:117], 0
    v_mov_b64 v[118:119], 0
    v_mov_b64 v[120:121], 0
    v_mov_b64 v[122:123], 0
    v_mov_b64 v[124:125], 0
    v_mov_b64 v[126:127], 0
    v_mov_b64 v[128:129], 0
    v_mov_b64 v[130:131], 0
    v_mov_b64 v[132:133], 0
    v_mov_b64 v[134:135], 0
    v_mov_b64 v[136:137], 0
    v_mov_b64 v[138:139], 0
    v_mov_b64 v[140:141], 0
    v_mov_b64 v[142:143], 0
    v_mov_b64 v[144:145], 0
    v_mov_b64 v[146:147], 0
    v_mov_b64 v[148:149], 0
    v_mov_b64 v[150:151], 0
    v_mov_b64 v[152:153], 0
    v_mov_b64 v[154:155], 0
    v_mov_b64 v[156:157], 0
    v_mov_b64 v[158:159], 0
    s_mov_b32 s43, 114688
    s_add_u32 m0, s43, s47
    s_waitcnt vmcnt(12)
    s_barrier
    s_mov_b32 s53, 0
a_G_KQ_START:
    ds_read_b128 v[192:195], v240 offset:16384
    ds_read_b128 v[196:199], v240 offset:18432
    ds_read_b128 v[200:203], v240 offset:20480
    ds_read_b128 v[204:207], v240 offset:22528
    ds_read_b64_tr_b16 v[224:225], v242 offset:0
    ds_read_b64_tr_b16 v[226:227], v242 offset:1024
    ds_read_b64_tr_b16 v[228:229], v243 offset:0
    ds_read_b64_tr_b16 v[230:231], v243 offset:1024
    s_waitcnt lgkmcnt(2)
    s_mov_b32 s46, 5
a_G_K_L:
    v_mfma_f32_16x16x32_bf16 v[32:35], v[224:227], v[192:195], v[32:35]
    ds_read_b64_tr_b16 v[232:233], v244 offset:0
    v_mfma_f32_16x16x32_bf16 v[36:39], v[224:227], v[196:199], v[36:39]
    ds_read_b64_tr_b16 v[234:235], v244 offset:1024
    v_mfma_f32_16x16x32_bf16 v[40:43], v[224:227], v[200:203], v[40:43]
    ds_read_b64_tr_b16 v[236:237], v245 offset:0
    buffer_load_dwordx4 v16, s[8:11], s44 offen offset:0 lds
    v_mfma_f32_16x16x32_bf16 v[44:47], v[224:227], v[204:207], v[44:47]
    s_waitcnt lgkmcnt(3)
    ds_read_b64_tr_b16 v[238:239], v245 offset:1024
    v_mfma_f32_16x16x32_bf16 v[48:51], v[228:231], v[192:195], v[48:51]
    ds_read_b64_tr_b16 v[224:225], v246 offset:0
    v_mfma_f32_16x16x32_bf16 v[52:55], v[228:231], v[196:199], v[52:55]
    ds_read_b64_tr_b16 v[226:227], v246 offset:1024
    v_mfma_f32_16x16x32_bf16 v[56:59], v[228:231], v[200:203], v[56:59]
    ds_read_b128 v[208:211], v241 offset:16384
    buffer_load_dwordx4 v17, s[8:11], s44 offen offset:1024 lds
    v_mfma_f32_16x16x32_bf16 v[60:63], v[228:231], v[204:207], v[60:63]
    s_waitcnt lgkmcnt(5)
    v_add_u32 v240, s40, v240
    v_mfma_f32_16x16x32_bf16 v[64:67], v[232:235], v[192:195], v[64:67]
    ds_read_b64_tr_b16 v[228:229], v247 offset:0
    v_mfma_f32_16x16x32_bf16 v[68:71], v[232:235], v[196:199], v[68:71]
    ds_read_b64_tr_b16 v[230:231], v247 offset:1024
    v_mfma_f32_16x16x32_bf16 v[72:75], v[232:235], v[200:203], v[72:75]
    ds_read_b128 v[212:215], v241 offset:18432
    buffer_load_dwordx4 v18, s[8:11], s44 offen offset:2048 lds
    v_mfma_f32_16x16x32_bf16 v[76:79], v[232:235], v[204:207], v[76:79]
    s_waitcnt lgkmcnt(6)
    v_mfma_f32_16x16x32_bf16 v[80:83], v[236:239], v[192:195], v[80:83]
    ds_read_b64_tr_b16 v[232:233], v248 offset:0
    v_mfma_f32_16x16x32_bf16 v[84:87], v[236:239], v[196:199], v[84:87]
    ds_read_b64_tr_b16 v[234:235], v248 offset:1024
    v_mfma_f32_16x16x32_bf16 v[88:91], v[236:239], v[200:203], v[88:91]
    ds_read_b128 v[216:219], v241 offset:20480
    buffer_load_dwordx4 v19, s[8:11], s44 offen offset:3072 lds
    s_add_u32 m0, m0, 4096
    v_mfma_f32_16x16x32_bf16 v[92:95], v[236:239], v[204:207], v[92:95]
    s_waitcnt lgkmcnt(7)
    v_mfma_f32_16x16x32_bf16 v[96:99], v[224:227], v[192:195], v[96:99]
    ds_read_b64_tr_b16 v[236:237], v249 offset:0
    v_mfma_f32_16x16x32_bf16 v[100:103], v[224:227], v[196:199], v[100:103]
    ds_read_b64_tr_b16 v[238:239], v249 offset:1024
    v_mfma_f32_16x16x32_bf16 v[104:107], v[224:227], v[200:203], v[104:107]
    ds_read_b128 v[220:223], v241 offset:22528
    buffer_load_dwordx4 v16, s[8:11], s54 offen offset:0 lds
    v_mfma_f32_16x16x32_bf16 v[108:111], v[224:227], v[204:207], v[108:111]
    s_waitcnt lgkmcnt(7)
    v_mfma_f32_16x16x32_bf16 v[112:115], v[228:231], v[192:195], v[112:115]
    ds_read_b64_tr_b16 v[224:225], v242 offset:8192
    v_mfma_f32_16x16x32_bf16 v[116:119], v[228:231], v[196:199], v[116:119]
    ds_read_b64_tr_b16 v[226:227], v242 offset:9216
    v_mfma_f32_16x16x32_bf16 v[120:123], v[228:231], v[200:203], v[120:123]
    buffer_load_dwordx4 v17, s[8:11], s54 offen offset:1024 lds
    v_mfma_f32_16x16x32_bf16 v[124:127], v[228:231], v[204:207], v[124:127]
    s_waitcnt lgkmcnt(6)
    v_add_u32 v242, s40, v242
    v_mfma_f32_16x16x32_bf16 v[128:131], v[232:235], v[192:195], v[128:131]
    ds_read_b64_tr_b16 v[228:229], v243 offset:8192
    v_mfma_f32_16x16x32_bf16 v[132:135], v[232:235], v[196:199], v[132:135]
    ds_read_b64_tr_b16 v[230:231], v243 offset:9216
    v_mfma_f32_16x16x32_bf16 v[136:139], v[232:235], v[200:203], v[136:139]
    buffer_load_dwordx4 v18, s[8:11], s54 offen offset:2048 lds
    v_mfma_f32_16x16x32_bf16 v[140:143], v[232:235], v[204:207], v[140:143]
    s_waitcnt lgkmcnt(5)
    v_add_u32 v243, s40, v243
    v_add_u32 v241, s40, v241
    v_mfma_f32_16x16x32_bf16 v[144:147], v[236:239], v[192:195], v[144:147]
    ds_read_b64_tr_b16 v[232:233], v244 offset:8192
    v_mfma_f32_16x16x32_bf16 v[148:151], v[236:239], v[196:199], v[148:151]
    ds_read_b64_tr_b16 v[234:235], v244 offset:9216
    v_mfma_f32_16x16x32_bf16 v[152:155], v[236:239], v[200:203], v[152:155]
    buffer_load_dwordx4 v19, s[8:11], s54 offen offset:3072 lds
    s_add_u32 m0, s43, s48
    v_mfma_f32_16x16x32_bf16 v[156:159], v[236:239], v[204:207], v[156:159]
    s_waitcnt lgkmcnt(4)
    v_add_u32 v244, s40, v244
    v_mfma_f32_16x16x32_bf16 v[32:35], v[224:227], v[208:211], v[32:35]
    ds_read_b64_tr_b16 v[236:237], v245 offset:8192
    v_mfma_f32_16x16x32_bf16 v[36:39], v[224:227], v[212:215], v[36:39]
    ds_read_b64_tr_b16 v[238:239], v245 offset:9216
    v_mfma_f32_16x16x32_bf16 v[40:43], v[224:227], v[216:219], v[40:43]
    buffer_load_dwordx4 v20, s[36:39], s45 offen offset:0 lds
    v_mfma_f32_16x16x32_bf16 v[44:47], v[224:227], v[220:223], v[44:47]
    s_waitcnt lgkmcnt(4)
    v_add_u32 v245, s40, v245
    v_mfma_f32_16x16x32_bf16 v[48:51], v[228:231], v[208:211], v[48:51]
    ds_read_b64_tr_b16 v[224:225], v246 offset:8192
    v_mfma_f32_16x16x32_bf16 v[52:55], v[228:231], v[212:215], v[52:55]
    ds_read_b64_tr_b16 v[226:227], v246 offset:9216
    v_mfma_f32_16x16x32_bf16 v[56:59], v[228:231], v[216:219], v[56:59]
    buffer_load_dwordx4 v21, s[36:39], s45 offen offset:1024 lds
    v_mfma_f32_16x16x32_bf16 v[60:63], v[228:231], v[220:223], v[60:63]
    s_waitcnt lgkmcnt(4)
    v_add_u32 v246, s40, v246
    v_mfma_f32_16x16x32_bf16 v[64:67], v[232:235], v[208:211], v[64:67]
    ds_read_b64_tr_b16 v[228:229], v247 offset:8192
    v_mfma_f32_16x16x32_bf16 v[68:71], v[232:235], v[212:215], v[68:71]
    ds_read_b64_tr_b16 v[230:231], v247 offset:9216
    v_mfma_f32_16x16x32_bf16 v[72:75], v[232:235], v[216:219], v[72:75]
    buffer_load_dwordx4 v22, s[36:39], s45 offen offset:2048 lds
    v_mfma_f32_16x16x32_bf16 v[76:79], v[232:235], v[220:223], v[76:79]
    s_waitcnt lgkmcnt(4)
    v_add_u32 v247, s40, v247
    v_mfma_f32_16x16x32_bf16 v[80:83], v[236:239], v[208:211], v[80:83]
    ds_read_b64_tr_b16 v[232:233], v248 offset:8192
    v_mfma_f32_16x16x32_bf16 v[84:87], v[236:239], v[212:215], v[84:87]
    ds_read_b64_tr_b16 v[234:235], v248 offset:9216
    v_mfma_f32_16x16x32_bf16 v[88:91], v[236:239], v[216:219], v[88:91]
    buffer_load_dwordx4 v23, s[36:39], s45 offen offset:3072 lds
    v_mfma_f32_16x16x32_bf16 v[92:95], v[236:239], v[220:223], v[92:95]
    s_waitcnt lgkmcnt(4)
    v_add_u32 v248, s40, v248
    v_mfma_f32_16x16x32_bf16 v[96:99], v[224:227], v[208:211], v[96:99]
    ds_read_b64_tr_b16 v[236:237], v249 offset:8192
    v_mfma_f32_16x16x32_bf16 v[100:103], v[224:227], v[212:215], v[100:103]
    ds_read_b64_tr_b16 v[238:239], v249 offset:9216
    v_mfma_f32_16x16x32_bf16 v[104:107], v[224:227], v[216:219], v[104:107]
    v_mfma_f32_16x16x32_bf16 v[108:111], v[224:227], v[220:223], v[108:111]
    s_waitcnt lgkmcnt(4)
    v_add_u32 v249, s40, v249
    s_add_u32 s44, s44, 128
    s_add_u32 s54, s54, 128
    s_add_u32 s45, s45, 524288
    s_add_u32 s43, s43, s42
    v_mfma_f32_16x16x32_bf16 v[112:115], v[228:231], v[208:211], v[112:115]
    v_mfma_f32_16x16x32_bf16 v[116:119], v[228:231], v[212:215], v[116:119]
    s_mov_b32 s25, s40
    s_mov_b32 s40, s41
    v_mfma_f32_16x16x32_bf16 v[120:123], v[228:231], v[216:219], v[120:123]
    v_mfma_f32_16x16x32_bf16 v[124:127], v[228:231], v[220:223], v[124:127]
    s_waitcnt lgkmcnt(2)
    v_mfma_f32_16x16x32_bf16 v[128:131], v[232:235], v[208:211], v[128:131]
    s_waitcnt vmcnt(12) lgkmcnt(0)
    s_barrier
    ds_read_b128 v[192:195], v240 offset:16384
    ds_read_b64_tr_b16 v[224:225], v242 offset:0
    v_mfma_f32_16x16x32_bf16 v[132:135], v[232:235], v[212:215], v[132:135]
    ds_read_b128 v[196:199], v240 offset:18432
    ds_read_b64_tr_b16 v[226:227], v242 offset:1024
    s_mov_b32 s41, s42
    s_mov_b32 s42, s25
    v_mfma_f32_16x16x32_bf16 v[136:139], v[232:235], v[216:219], v[136:139]
    ds_read_b128 v[200:203], v240 offset:20480
    v_mfma_f32_16x16x32_bf16 v[140:143], v[232:235], v[220:223], v[140:143]
    s_waitcnt lgkmcnt(5)
    ds_read_b128 v[204:207], v240 offset:22528
    v_mfma_f32_16x16x32_bf16 v[144:147], v[236:239], v[208:211], v[144:147]
    ds_read_b64_tr_b16 v[228:229], v243 offset:0
    v_mfma_f32_16x16x32_bf16 v[148:151], v[236:239], v[212:215], v[148:151]
    ds_read_b64_tr_b16 v[230:231], v243 offset:1024
    s_add_u32 m0, s43, s47
    v_mfma_f32_16x16x32_bf16 v[152:155], v[236:239], v[216:219], v[152:155]
    v_mfma_f32_16x16x32_bf16 v[156:159], v[236:239], v[220:223], v[156:159]
    s_waitcnt lgkmcnt(2)
    s_sub_u32 s46, s46, 1
    s_cbranch_scc0 a_G_K_L
    s_mov_b32 s46, 1
a_G_K_T:
    v_mfma_f32_16x16x32_bf16 v[32:35], v[224:227], v[192:195], v[32:35]
    ds_read_b64_tr_b16 v[232:233], v244 offset:0
    v_mfma_f32_16x16x32_bf16 v[36:39], v[224:227], v[196:199], v[36:39]
    ds_read_b64_tr_b16 v[234:235], v244 offset:1024
    v_mfma_f32_16x16x32_bf16 v[40:43], v[224:227], v[200:203], v[40:43]
    ds_read_b64_tr_b16 v[236:237], v245 offset:0
    v_mfma_f32_16x16x32_bf16 v[44:47], v[224:227], v[204:207], v[44:47]
    s_waitcnt lgkmcnt(3)
    ds_read_b64_tr_b16 v[238:239], v245 offset:1024
    v_mfma_f32_16x16x32_bf16 v[48:51], v[228:231], v[192:195], v[48:51]
    ds_read_b64_tr_b16 v[224:225], v246 offset:0
    v_mfma_f32_16x16x32_bf16 v[52:55], v[228:231], v[196:199], v[52:55]
    ds_read_b64_tr_b16 v[226:227], v246 offset:1024
    v_mfma_f32_16x16x32_bf16 v[56:59], v[228:231], v[200:203], v[56:59]
    ds_read_b128 v[208:211], v241 offset:16384
    v_mfma_f32_16x16x32_bf16 v[60:63], v[228:231], v[204:207], v[60:63]
    s_waitcnt lgkmcnt(5)
    v_add_u32 v240, s40, v240
    v_mfma_f32_16x16x32_bf16 v[64:67], v[232:235], v[192:195], v[64:67]
    ds_read_b64_tr_b16 v[228:229], v247 offset:0
    v_mfma_f32_16x16x32_bf16 v[68:71], v[232:235], v[196:199], v[68:71]
    ds_read_b64_tr_b16 v[230:231], v247 offset:1024
    v_mfma_f32_16x16x32_bf16 v[72:75], v[232:235], v[200:203], v[72:75]
    ds_read_b128 v[212:215], v241 offset:18432
    v_mfma_f32_16x16x32_bf16 v[76:79], v[232:235], v[204:207], v[76:79]
    s_waitcnt lgkmcnt(6)
    v_mfma_f32_16x16x32_bf16 v[80:83], v[236:239], v[192:195], v[80:83]
    ds_read_b64_tr_b16 v[232:233], v248 offset:0
    v_mfma_f32_16x16x32_bf16 v[84:87], v[236:239], v[196:199], v[84:87]
    ds_read_b64_tr_b16 v[234:235], v248 offset:1024
    v_mfma_f32_16x16x32_bf16 v[88:91], v[236:239], v[200:203], v[88:91]
    ds_read_b128 v[216:219], v241 offset:20480
    v_mfma_f32_16x16x32_bf16 v[92:95], v[236:239], v[204:207], v[92:95]
    s_waitcnt lgkmcnt(7)
    v_mfma_f32_16x16x32_bf16 v[96:99], v[224:227], v[192:195], v[96:99]
    ds_read_b64_tr_b16 v[236:237], v249 offset:0
    v_mfma_f32_16x16x32_bf16 v[100:103], v[224:227], v[196:199], v[100:103]
    ds_read_b64_tr_b16 v[238:239], v249 offset:1024
    v_mfma_f32_16x16x32_bf16 v[104:107], v[224:227], v[200:203], v[104:107]
    ds_read_b128 v[220:223], v241 offset:22528
    v_mfma_f32_16x16x32_bf16 v[108:111], v[224:227], v[204:207], v[108:111]
    s_waitcnt lgkmcnt(7)
    v_mfma_f32_16x16x32_bf16 v[112:115], v[228:231], v[192:195], v[112:115]
    ds_read_b64_tr_b16 v[224:225], v242 offset:8192
    v_mfma_f32_16x16x32_bf16 v[116:119], v[228:231], v[196:199], v[116:119]
    ds_read_b64_tr_b16 v[226:227], v242 offset:9216
    v_mfma_f32_16x16x32_bf16 v[120:123], v[228:231], v[200:203], v[120:123]
    v_mfma_f32_16x16x32_bf16 v[124:127], v[228:231], v[204:207], v[124:127]
    s_waitcnt lgkmcnt(6)
    v_add_u32 v242, s40, v242
    v_mfma_f32_16x16x32_bf16 v[128:131], v[232:235], v[192:195], v[128:131]
    ds_read_b64_tr_b16 v[228:229], v243 offset:8192
    v_mfma_f32_16x16x32_bf16 v[132:135], v[232:235], v[196:199], v[132:135]
    ds_read_b64_tr_b16 v[230:231], v243 offset:9216
    v_mfma_f32_16x16x32_bf16 v[136:139], v[232:235], v[200:203], v[136:139]
    v_mfma_f32_16x16x32_bf16 v[140:143], v[232:235], v[204:207], v[140:143]
    s_waitcnt lgkmcnt(5)
    v_add_u32 v243, s40, v243
    v_add_u32 v241, s40, v241
    v_mfma_f32_16x16x32_bf16 v[144:147], v[236:239], v[192:195], v[144:147]
    ds_read_b64_tr_b16 v[232:233], v244 offset:8192
    v_mfma_f32_16x16x32_bf16 v[148:151], v[236:239], v[196:199], v[148:151]
    ds_read_b64_tr_b16 v[234:235], v244 offset:9216
    v_mfma_f32_16x16x32_bf16 v[152:155], v[236:239], v[200:203], v[152:155]
    v_mfma_f32_16x16x32_bf16 v[156:159], v[236:239], v[204:207], v[156:159]
    s_waitcnt lgkmcnt(4)
    v_add_u32 v244, s40, v244
    v_mfma_f32_16x16x32_bf16 v[32:35], v[224:227], v[208:211], v[32:35]
    ds_read_b64_tr_b16 v[236:237], v245 offset:8192
    v_mfma_f32_16x16x32_bf16 v[36:39], v[224:227], v[212:215], v[36:39]
    ds_read_b64_tr_b16 v[238:239], v245 offset:9216
    v_mfma_f32_16x16x32_bf16 v[40:43], v[224:227], v[216:219], v[40:43]
    v_mfma_f32_16x16x32_bf16 v[44:47], v[224:227], v[220:223], v[44:47]
    s_waitcnt lgkmcnt(4)
    v_add_u32 v245, s40, v245
    v_mfma_f32_16x16x32_bf16 v[48:51], v[228:231], v[208:211], v[48:51]
    ds_read_b64_tr_b16 v[224:225], v246 offset:8192
    v_mfma_f32_16x16x32_bf16 v[52:55], v[228:231], v[212:215], v[52:55]
    ds_read_b64_tr_b16 v[226:227], v246 offset:9216
    v_mfma_f32_16x16x32_bf16 v[56:59], v[228:231], v[216:219], v[56:59]
    v_mfma_f32_16x16x32_bf16 v[60:63], v[228:231], v[220:223], v[60:63]
    s_waitcnt lgkmcnt(4)
    v_add_u32 v246, s40, v246
    v_mfma_f32_16x16x32_bf16 v[64:67], v[232:235], v[208:211], v[64:67]
    ds_read_b64_tr_b16 v[228:229], v247 offset:8192
    v_mfma_f32_16x16x32_bf16 v[68:71], v[232:235], v[212:215], v[68:71]
    ds_read_b64_tr_b16 v[230:231], v247 offset:9216
    v_mfma_f32_16x16x32_bf16 v[72:75], v[232:235], v[216:219], v[72:75]
    v_mfma_f32_16x16x32_bf16 v[76:79], v[232:235], v[220:223], v[76:79]
    s_waitcnt lgkmcnt(4)
    v_add_u32 v247, s40, v247
    v_mfma_f32_16x16x32_bf16 v[80:83], v[236:239], v[208:211], v[80:83]
    ds_read_b64_tr_b16 v[232:233], v248 offset:8192
    v_mfma_f32_16x16x32_bf16 v[84:87], v[236:239], v[212:215], v[84:87]
    ds_read_b64_tr_b16 v[234:235], v248 offset:9216
    v_mfma_f32_16x16x32_bf16 v[88:91], v[236:239], v[216:219], v[88:91]
    v_mfma_f32_16x16x32_bf16 v[92:95], v[236:239], v[220:223], v[92:95]
    s_waitcnt lgkmcnt(4)
    v_add_u32 v248, s40, v248
    v_mfma_f32_16x16x32_bf16 v[96:99], v[224:227], v[208:211], v[96:99]
    ds_read_b64_tr_b16 v[236:237], v249 offset:8192
    v_mfma_f32_16x16x32_bf16 v[100:103], v[224:227], v[212:215], v[100:103]
    ds_read_b64_tr_b16 v[238:239], v249 offset:9216
    v_mfma_f32_16x16x32_bf16 v[104:107], v[224:227], v[216:219], v[104:107]
    v_mfma_f32_16x16x32_bf16 v[108:111], v[224:227], v[220:223], v[108:111]
    s_waitcnt lgkmcnt(4)
    v_add_u32 v249, s40, v249
    v_mfma_f32_16x16x32_bf16 v[112:115], v[228:231], v[208:211], v[112:115]
    v_mfma_f32_16x16x32_bf16 v[116:119], v[228:231], v[212:215], v[116:119]
    s_mov_b32 s25, s40
    s_mov_b32 s40, s41
    v_mfma_f32_16x16x32_bf16 v[120:123], v[228:231], v[216:219], v[120:123]
    v_mfma_f32_16x16x32_bf16 v[124:127], v[228:231], v[220:223], v[124:127]
    s_waitcnt lgkmcnt(2)
    v_mfma_f32_16x16x32_bf16 v[128:131], v[232:235], v[208:211], v[128:131]
    s_waitcnt vmcnt(0) lgkmcnt(0)
    s_barrier
    ds_read_b128 v[192:195], v240 offset:16384
    ds_read_b64_tr_b16 v[224:225], v242 offset:0
    v_mfma_f32_16x16x32_bf16 v[132:135], v[232:235], v[212:215], v[132:135]
    ds_read_b128 v[196:199], v240 offset:18432
    ds_read_b64_tr_b16 v[226:227], v242 offset:1024
    s_mov_b32 s41, s42
    s_mov_b32 s42, s25
    v_mfma_f32_16x16x32_bf16 v[136:139], v[232:235], v[216:219], v[136:139]
    ds_read_b128 v[200:203], v240 offset:20480
    v_mfma_f32_16x16x32_bf16 v[140:143], v[232:235], v[220:223], v[140:143]
    s_waitcnt lgkmcnt(5)
    ds_read_b128 v[204:207], v240 offset:22528
    v_mfma_f32_16x16x32_bf16 v[144:147], v[236:239], v[208:211], v[144:147]
    ds_read_b64_tr_b16 v[228:229], v243 offset:0
    v_mfma_f32_16x16x32_bf16 v[148:151], v[236:239], v[212:215], v[148:151]
    ds_read_b64_tr_b16 v[230:231], v243 offset:1024
    v_mfma_f32_16x16x32_bf16 v[152:155], v[236:239], v[216:219], v[152:155]
    v_mfma_f32_16x16x32_bf16 v[156:159], v[236:239], v[220:223], v[156:159]
    s_waitcnt lgkmcnt(2)
    s_sub_u32 s46, s46, 1
    s_cbranch_scc0 a_G_K_T
    s_cmp_eq_u32 s53, 0
    s_cbranch_scc0 a_G_QEPI
    s_lshl_b32 s50, s16, 20
    s_lshl_b32 s25, s17, 17
    s_add_u32 s50, s50, s25
    s_lshl_b32 s25, s30, 15
    s_add_u32 s50, s50, s25
    s_add_u32 s51, s50, 0
    v_cvt_pk_bf16_f32 v160, v32, v33
    v_cvt_pk_bf16_f32 v161, v34, v35
    v_cvt_pk_bf16_f32 v162, v48, v49
    v_cvt_pk_bf16_f32 v163, v50, v51
    buffer_store_dwordx4 v[160:163], v1, s[12:15], s51 offen offset:0 sc1
    v_cvt_pk_bf16_f32 v164, v64, v65
    v_cvt_pk_bf16_f32 v165, v66, v67
    v_cvt_pk_bf16_f32 v166, v80, v81
    v_cvt_pk_bf16_f32 v167, v82, v83
    buffer_store_dwordx4 v[164:167], v1, s[12:15], s51 offen offset:1024 sc1
    v_cvt_pk_bf16_f32 v168, v96, v97
    v_cvt_pk_bf16_f32 v169, v98, v99
    v_cvt_pk_bf16_f32 v170, v112, v113
    v_cvt_pk_bf16_f32 v171, v114, v115
    buffer_store_dwordx4 v[168:171], v1, s[12:15], s51 offen offset:2048 sc1
    s_barrier
    v_cvt_pk_bf16_f32 v172, v128, v129
    v_cvt_pk_bf16_f32 v173, v130, v131
    v_cvt_pk_bf16_f32 v174, v144, v145
    v_cvt_pk_bf16_f32 v175, v146, v147
    buffer_store_dwordx4 v[172:175], v1, s[12:15], s51 offen offset:3072 sc1
    s_add_u32 s51, s50, 4096
    v_cvt_pk_bf16_f32 v160, v36, v37
    v_cvt_pk_bf16_f32 v161, v38, v39
    v_cvt_pk_bf16_f32 v162, v52, v53
    v_cvt_pk_bf16_f32 v163, v54, v55
    buffer_store_dwordx4 v[160:163], v1, s[12:15], s51 offen offset:0 sc1
    v_cvt_pk_bf16_f32 v164, v68, v69
    v_cvt_pk_bf16_f32 v165, v70, v71
    v_cvt_pk_bf16_f32 v166, v84, v85
    v_cvt_pk_bf16_f32 v167, v86, v87
    buffer_store_dwordx4 v[164:167], v1, s[12:15], s51 offen offset:1024 sc1
    s_barrier
    v_cvt_pk_bf16_f32 v168, v100, v101
    v_cvt_pk_bf16_f32 v169, v102, v103
    v_cvt_pk_bf16_f32 v170, v116, v117
    v_cvt_pk_bf16_f32 v171, v118, v119
    buffer_store_dwordx4 v[168:171], v1, s[12:15], s51 offen offset:2048 sc1
    v_cvt_pk_bf16_f32 v172, v132, v133
    v_cvt_pk_bf16_f32 v173, v134, v135
    v_cvt_pk_bf16_f32 v174, v148, v149
    v_cvt_pk_bf16_f32 v175, v150, v151
    buffer_store_dwordx4 v[172:175], v1, s[12:15], s51 offen offset:3072 sc1
    s_add_u32 s51, s50, 16384
    v_cvt_pk_bf16_f32 v160, v40, v41
    v_cvt_pk_bf16_f32 v161, v42, v43
    v_cvt_pk_bf16_f32 v162, v56, v57
    v_cvt_pk_bf16_f32 v163, v58, v59
    buffer_store_dwordx4 v[160:163], v1, s[12:15], s51 offen offset:0 sc1
    s_barrier
    v_cvt_pk_bf16_f32 v164, v72, v73
    v_cvt_pk_bf16_f32 v165, v74, v75
    v_cvt_pk_bf16_f32 v166, v88, v89
    v_cvt_pk_bf16_f32 v167, v90, v91
    buffer_store_dwordx4 v[164:167], v1, s[12:15], s51 offen offset:1024 sc1
    v_cvt_pk_bf16_f32 v168, v104, v105
    v_cvt_pk_bf16_f32 v169, v106, v107
    v_cvt_pk_bf16_f32 v170, v120, v121
    v_cvt_pk_bf16_f32 v171, v122, v123
    buffer_store_dwordx4 v[168:171], v1, s[12:15], s51 offen offset:2048 sc1
    v_cvt_pk_bf16_f32 v172, v136, v137
    v_cvt_pk_bf16_f32 v173, v138, v139
    v_cvt_pk_bf16_f32 v174, v152, v153
    v_cvt_pk_bf16_f32 v175, v154, v155
    buffer_store_dwordx4 v[172:175], v1, s[12:15], s51 offen offset:3072 sc1
    s_barrier
    s_add_u32 s51, s50, 20480
    v_cvt_pk_bf16_f32 v160, v44, v45
    v_cvt_pk_bf16_f32 v161, v46, v47
    v_cvt_pk_bf16_f32 v162, v60, v61
    v_cvt_pk_bf16_f32 v163, v62, v63
    buffer_store_dwordx4 v[160:163], v1, s[12:15], s51 offen offset:0 sc1
    v_cvt_pk_bf16_f32 v164, v76, v77
    v_cvt_pk_bf16_f32 v165, v78, v79
    v_cvt_pk_bf16_f32 v166, v92, v93
    v_cvt_pk_bf16_f32 v167, v94, v95
    buffer_store_dwordx4 v[164:167], v1, s[12:15], s51 offen offset:1024 sc1
    s_barrier
    v_cvt_pk_bf16_f32 v168, v108, v109
    v_cvt_pk_bf16_f32 v169, v110, v111
    v_cvt_pk_bf16_f32 v170, v124, v125
    v_cvt_pk_bf16_f32 v171, v126, v127
    buffer_store_dwordx4 v[168:171], v1, s[12:15], s51 offen offset:2048 sc1
    v_cvt_pk_bf16_f32 v172, v140, v141
    v_cvt_pk_bf16_f32 v173, v142, v143
    v_cvt_pk_bf16_f32 v174, v156, v157
    v_cvt_pk_bf16_f32 v175, v158, v159
    buffer_store_dwordx4 v[172:175], v1, s[12:15], s51 offen offset:3072 sc1
    s_load_dwordx2 s[64:65], s[0:1], 80
    s_waitcnt lgkmcnt(0)
    s_mov_b32 s66, 256
    s_mov_b32 s67, 0x20000
    v_mov_b32 v31, 0
    buffer_load_dword v30, v31, s[64:67], 0 offen sc1
    s_mov_b32 s8, s78
    s_mov_b32 s9, s79
    s_mov_b32 s10, 2097152
    s_mov_b32 s11, 0x20000
    s_mov_b32 s36, s80
    s_mov_b32 s37, s81
    s_mov_b32 s38, 4194304
    s_mov_b32 s39, 0x20000
    s_sub_u32 s25, 15, s17
    s_lshl_b32 s25, s25, 2
    s_add_u32 s25, s25, s30
    s_lshl_b32 s44, s25, 15
    s_lshl_b32 s25, s17, 2
    s_add_u32 s25, s25, s30
    s_lshl_b32 s54, s25, 15
    s_lshl_b32 s45, s16, 8
    v_and_b32 v7, 15, v15
    v_lshrrev_b32 v9, 1, v7
    v_xor_b32 v9, v6, v9
    v_lshlrev_b32 v9, 4, v9
    v_lshl_add_u32 v9, v7, 7, v9
    s_lshl_b32 s25, s30, 13
    s_add_u32 s25, s25, 65536
    v_add_u32 v240, s25, v9
    v_xor_b32 v241, 64, v240
    v_lshrrev_b32 v9, 2, v7
    v_lshl_add_u32 v10, v6, 3, v9
    v_lshlrev_b32 v10, 8, v10
    v_and_b32 v160, 3, v7
    v_lshl_add_u32 v10, v160, 3, v10
    v_add_u32 v10, 65536, v10
    v_and_b32 v160, 1, v6
    v_lshl_add_u32 v9, v160, 2, v9
    v_xor_b32 v160, 0, v9
    v_lshl_add_u32 v242, v160, 5, v10
    v_xor_b32 v160, 1, v9
    v_lshl_add_u32 v243, v160, 5, v10
    v_xor_b32 v160, 2, v9
    v_lshl_add_u32 v244, v160, 5, v10
    v_xor_b32 v160, 3, v9
    v_lshl_add_u32 v245, v160, 5, v10
    v_xor_b32 v160, 4, v9
    v_lshl_add_u32 v246, v160, 5, v10
    v_xor_b32 v160, 5, v9
    v_lshl_add_u32 v247, v160, 5, v10
    v_xor_b32 v160, 6, v9
    v_lshl_add_u32 v248, v160, 5, v10
    v_xor_b32 v160, 7, v9
    v_lshl_add_u32 v249, v160, 5, v10
    s_mov_b32 s40, 49152
    s_mov_b32 s41, 4294868992
    s_mov_b32 s42, 49152
    v_mov_b64 v[32:33], 0
    v_mov_b64 v[34:35], 0
    v_mov_b64 v[36:37], 0
    v_mov_b64 v[38:39], 0
    v_mov_b64 v[40:41], 0
    v_mov_b64 v[42:43], 0
    v_mov_b64 v[44:45], 0
    v_mov_b64 v[46:47], 0
    v_mov_b64 v[48:49], 0
    v_mov_b64 v[50:51], 0
    v_mov_b64 v[52:53], 0
    v_mov_b64 v[54:55], 0
    v_mov_b64 v[56:57], 0
    v_mov_b64 v[58:59], 0
    v_mov_b64 v[60:61], 0
    v_mov_b64 v[62:63], 0
    v_mov_b64 v[64:65], 0
    v_mov_b64 v[66:67], 0
    v_mov_b64 v[68:69], 0
    v_mov_b64 v[70:71], 0
    v_mov_b64 v[72:73], 0
    v_mov_b64 v[74:75], 0
    v_mov_b64 v[76:77], 0
    v_mov_b64 v[78:79], 0
    v_mov_b64 v[80:81], 0
    v_mov_b64 v[82:83], 0
    v_mov_b64 v[84:85], 0
    v_mov_b64 v[86:87], 0
    v_mov_b64 v[88:89], 0
    v_mov_b64 v[90:91], 0
    v_mov_b64 v[92:93], 0
    v_mov_b64 v[94:95], 0
    v_mov_b64 v[96:97], 0
    v_mov_b64 v[98:99], 0
    v_mov_b64 v[100:101], 0
    v_mov_b64 v[102:103], 0
    v_mov_b64 v[104:105], 0
    v_mov_b64 v[106:107], 0
    v_mov_b64 v[108:109], 0
    v_mov_b64 v[110:111], 0
    v_mov_b64 v[112:113], 0
    v_mov_b64 v[114:115], 0
    v_mov_b64 v[116:117], 0
    v_mov_b64 v[118:119], 0
    v_mov_b64 v[120:121], 0
    v_mov_b64 v[122:123], 0
    v_mov_b64 v[124:125], 0
    v_mov_b64 v[126:127], 0
    v_mov_b64 v[128:129], 0
    v_mov_b64 v[130:131], 0
    v_mov_b64 v[132:133], 0
    v_mov_b64 v[134:135], 0
    v_mov_b64 v[136:137], 0
    v_mov_b64 v[138:139], 0
    v_mov_b64 v[140:141], 0
    v_mov_b64 v[142:143], 0
    v_mov_b64 v[144:145], 0
    v_mov_b64 v[146:147], 0
    v_mov_b64 v[148:149], 0
    v_mov_b64 v[150:151], 0
    v_mov_b64 v[152:153], 0
    v_mov_b64 v[154:155], 0
    v_mov_b64 v[156:157], 0
    v_mov_b64 v[158:159], 0
    s_barrier
    s_mov_b32 s43, 65536
    s_add_u32 m0, s43, s47
    s_nop 0
    buffer_load_dwordx4 v16, s[8:11], s44 offen offset:0 lds
    buffer_load_dwordx4 v17, s[8:11], s44 offen offset:1024 lds
    buffer_load_dwordx4 v18, s[8:11], s44 offen offset:2048 lds
    buffer_load_dwordx4 v19, s[8:11], s44 offen offset:3072 lds
    s_add_u32 m0, m0, 4096
    s_nop 0
    buffer_load_dwordx4 v16, s[8:11], s54 offen offset:0 lds
    buffer_load_dwordx4 v17, s[8:11], s54 offen offset:1024 lds
    buffer_load_dwordx4 v18, s[8:11], s54 offen offset:2048 lds
    buffer_load_dwordx4 v19, s[8:11], s54 offen offset:3072 lds
    s_add_u32 m0, s43, s48
    s_nop 0
    buffer_load_dwordx4 v20, s[36:39], s45 offen offset:0 lds
    buffer_load_dwordx4 v21, s[36:39], s45 offen offset:1024 lds
    buffer_load_dwordx4 v22, s[36:39], s45 offen offset:2048 lds
    buffer_load_dwordx4 v23, s[36:39], s45 offen offset:3072 lds
    s_add_u32 s44, s44, 128
    s_add_u32 s54, s54, 128
    s_add_u32 s45, s45, 524288
    s_barrier
    s_mov_b32 s43, 114688
    s_add_u32 m0, s43, s47
    s_nop 0
    buffer_load_dwordx4 v16, s[8:11], s44 offen offset:0 lds
    buffer_load_dwordx4 v17, s[8:11], s44 offen offset:1024 lds
    buffer_load_dwordx4 v18, s[8:11], s44 offen offset:2048 lds
    buffer_load_dwordx4 v19, s[8:11], s44 offen offset:3072 lds
    s_add_u32 m0, m0, 4096
    s_nop 0
    buffer_load_dwordx4 v16, s[8:11], s54 offen offset:0 lds
    buffer_load_dwordx4 v17, s[8:11], s54 offen offset:1024 lds
    buffer_load_dwordx4 v18, s[8:11], s54 offen offset:2048 lds
    buffer_load_dwordx4 v19, s[8:11], s54 offen offset:3072 lds
    s_add_u32 m0, s43, s48
    s_nop 0
    buffer_load_dwordx4 v20, s[36:39], s45 offen offset:0 lds
    buffer_load_dwordx4 v21, s[36:39], s45 offen offset:1024 lds
    buffer_load_dwordx4 v22, s[36:39], s45 offen offset:2048 lds
    buffer_load_dwordx4 v23, s[36:39], s45 offen offset:3072 lds
    s_add_u32 s44, s44, 128
    s_add_u32 s54, s54, 128
    s_add_u32 s45, s45, 524288
    s_mov_b32 s43, 16384
    s_add_u32 m0, s43, s47
    s_waitcnt vmcnt(12)
    v_readfirstlane_b32 s63, v30
    s_nop 3
    s_barrier
    s_mov_b32 s53, 1
    s_branch a_G_KQ_START
a_G_QEPI:
    s_mov_b32 s25, 0x3e0293ee
    s_and_b32 s26, s30, 1
    s_lshl_b32 s26, s26, 13
    s_cmp_ge_u32 s30, 2
    s_cselect_b32 s27, 49152, 0
    s_add_u32 s26, s26, s27
    s_add_u32 s26, s26, 98304
    v_add_u32 v7, s26, v1
    s_nop 2
    v_mul_f32 v40, s25, v40
    v_mul_f32 v56, s25, v56
    v_mul_f32 v41, s25, v41
    v_mul_f32 v57, s25, v57
    v_mul_f32 v42, s25, v42
    v_mul_f32 v58, s25, v58
    v_mul_f32 v43, s25, v43
    v_mul_f32 v59, s25, v59
    v_cvt_pk_bf16_f32 v192, v40, v41
    v_cvt_pk_bf16_f32 v193, v42, v43
    v_cvt_pk_bf16_f32 v194, v56, v57
    v_cvt_pk_bf16_f32 v195, v58, v59
    ds_write_b128 v7, v[192:195] offset:0
    v_mul_f32 v72, s25, v72
    v_mul_f32 v88, s25, v88
    v_mul_f32 v73, s25, v73
    v_mul_f32 v89, s25, v89
    v_mul_f32 v74, s25, v74
    v_mul_f32 v90, s25, v90
    v_mul_f32 v75, s25, v75
    v_mul_f32 v91, s25, v91
    v_cvt_pk_bf16_f32 v196, v72, v73
    v_cvt_pk_bf16_f32 v197, v74, v75
    v_cvt_pk_bf16_f32 v198, v88, v89
    v_cvt_pk_bf16_f32 v199, v90, v91
    ds_write_b128 v7, v[196:199] offset:1024
    v_mul_f32 v104, s25, v104
    v_mul_f32 v120, s25, v120
    v_mul_f32 v105, s25, v105
    v_mul_f32 v121, s25, v121
    v_mul_f32 v106, s25, v106
    v_mul_f32 v122, s25, v122
    v_mul_f32 v107, s25, v107
    v_mul_f32 v123, s25, v123
    v_cvt_pk_bf16_f32 v200, v104, v105
    v_cvt_pk_bf16_f32 v201, v106, v107
    v_cvt_pk_bf16_f32 v202, v120, v121
    v_cvt_pk_bf16_f32 v203, v122, v123
    ds_write_b128 v7, v[200:203] offset:2048
    v_mul_f32 v136, s25, v136
    v_mul_f32 v152, s25, v152
    v_mul_f32 v137, s25, v137
    v_mul_f32 v153, s25, v153
    v_mul_f32 v138, s25, v138
    v_mul_f32 v154, s25, v154
    v_mul_f32 v139, s25, v139
    v_mul_f32 v155, s25, v155
    v_cvt_pk_bf16_f32 v204, v136, v137
    v_cvt_pk_bf16_f32 v205, v138, v139
    v_cvt_pk_bf16_f32 v206, v152, v153
    v_cvt_pk_bf16_f32 v207, v154, v155
    ds_write_b128 v7, v[204:207] offset:3072
    s_barrier
    v_mul_f32 v44, s25, v44
    v_mul_f32 v60, s25, v60
    v_mul_f32 v45, s25, v45
    v_mul_f32 v61, s25, v61
    v_mul_f32 v46, s25, v46
    v_mul_f32 v62, s25, v62
    v_mul_f32 v47, s25, v47
    v_mul_f32 v63, s25, v63
    v_cvt_pk_bf16_f32 v208, v44, v45
    v_cvt_pk_bf16_f32 v209, v46, v47
    v_cvt_pk_bf16_f32 v210, v60, v61
    v_cvt_pk_bf16_f32 v211, v62, v63
    ds_write_b128 v7, v[208:211] offset:4096
    v_mul_f32 v76, s25, v76
    v_mul_f32 v92, s25, v92
    v_mul_f32 v77, s25, v77
    v_mul_f32 v93, s25, v93
    v_mul_f32 v78, s25, v78
    v_mul_f32 v94, s25, v94
    v_mul_f32 v79, s25, v79
    v_mul_f32 v95, s25, v95
    v_cvt_pk_bf16_f32 v212, v76, v77
    v_cvt_pk_bf16_f32 v213, v78, v79
    v_cvt_pk_bf16_f32 v214, v92, v93
    v_cvt_pk_bf16_f32 v215, v94, v95
    ds_write_b128 v7, v[212:215] offset:5120
    v_mul_f32 v108, s25, v108
    v_mul_f32 v124, s25, v124
    v_mul_f32 v109, s25, v109
    v_mul_f32 v125, s25, v125
    v_mul_f32 v110, s25, v110
    v_mul_f32 v126, s25, v126
    v_mul_f32 v111, s25, v111
    v_mul_f32 v127, s25, v127
    v_cvt_pk_bf16_f32 v216, v108, v109
    v_cvt_pk_bf16_f32 v217, v110, v111
    v_cvt_pk_bf16_f32 v218, v124, v125
    v_cvt_pk_bf16_f32 v219, v126, v127
    ds_write_b128 v7, v[216:219] offset:6144
    v_mul_f32 v140, s25, v140
    v_mul_f32 v156, s25, v156
    v_mul_f32 v141, s25, v141
    v_mul_f32 v157, s25, v157
    v_mul_f32 v142, s25, v142
    v_mul_f32 v158, s25, v158
    v_mul_f32 v143, s25, v143
    v_mul_f32 v159, s25, v159
    v_cvt_pk_bf16_f32 v220, v140, v141
    v_cvt_pk_bf16_f32 v221, v142, v143
    v_cvt_pk_bf16_f32 v222, v156, v157
    v_cvt_pk_bf16_f32 v223, v158, v159
    ds_write_b128 v7, v[220:223] offset:7168
    s_barrier
    v_mul_f32 v32, s25, v32
    v_mul_f32 v48, s25, v48
    v_mul_f32 v33, s25, v33
    v_mul_f32 v49, s25, v49
    v_mul_f32 v34, s25, v34
    v_mul_f32 v50, s25, v50
    v_mul_f32 v35, s25, v35
    v_mul_f32 v51, s25, v51
    v_cvt_pk_bf16_f32 v160, v32, v33
    v_cvt_pk_bf16_f32 v161, v34, v35
    v_cvt_pk_bf16_f32 v162, v48, v49
    v_cvt_pk_bf16_f32 v163, v50, v51
    v_mul_f32 v64, s25, v64
    v_mul_f32 v80, s25, v80
    v_mul_f32 v65, s25, v65
    v_mul_f32 v81, s25, v81
    v_mul_f32 v66, s25, v66
    v_mul_f32 v82, s25, v82
    v_mul_f32 v67, s25, v67
    v_mul_f32 v83, s25, v83
    v_cvt_pk_bf16_f32 v164, v64, v65
    v_cvt_pk_bf16_f32 v165, v66, v67
    v_cvt_pk_bf16_f32 v166, v80, v81
    v_cvt_pk_bf16_f32 v167, v82, v83
    v_mul_f32 v96, s25, v96
    v_mul_f32 v112, s25, v112
    v_mul_f32 v97, s25, v97
    v_mul_f32 v113, s25, v113
    v_mul_f32 v98, s25, v98
    v_mul_f32 v114, s25, v114
    v_mul_f32 v99, s25, v99
    v_mul_f32 v115, s25, v115
    v_cvt_pk_bf16_f32 v168, v96, v97
    v_cvt_pk_bf16_f32 v169, v98, v99
    v_cvt_pk_bf16_f32 v170, v112, v113
    v_cvt_pk_bf16_f32 v171, v114, v115
    v_mul_f32 v128, s25, v128
    v_mul_f32 v144, s25, v144
    v_mul_f32 v129, s25, v129
    v_mul_f32 v145, s25, v145
    v_mul_f32 v130, s25, v130
    v_mul_f32 v146, s25, v146
    v_mul_f32 v131, s25, v131
    v_mul_f32 v147, s25, v147
    v_cvt_pk_bf16_f32 v172, v128, v129
    v_cvt_pk_bf16_f32 v173, v130, v131
    v_cvt_pk_bf16_f32 v174, v144, v145
    v_cvt_pk_bf16_f32 v175, v146, v147
    s_barrier
    v_mul_f32 v36, s25, v36
    v_mul_f32 v52, s25, v52
    v_mul_f32 v37, s25, v37
    v_mul_f32 v53, s25, v53
    v_mul_f32 v38, s25, v38
    v_mul_f32 v54, s25, v54
    v_mul_f32 v39, s25, v39
    v_mul_f32 v55, s25, v55
    v_cvt_pk_bf16_f32 v176, v36, v37
    v_cvt_pk_bf16_f32 v177, v38, v39
    v_cvt_pk_bf16_f32 v178, v52, v53
    v_cvt_pk_bf16_f32 v179, v54, v55
    v_mul_f32 v68, s25, v68
    v_mul_f32 v84, s25, v84
    v_mul_f32 v69, s25, v69
    v_mul_f32 v85, s25, v85
    v_mul_f32 v70, s25, v70
    v_mul_f32 v86, s25, v86
    v_mul_f32 v71, s25, v71
    v_mul_f32 v87, s25, v87
    v_cvt_pk_bf16_f32 v180, v68, v69
    v_cvt_pk_bf16_f32 v181, v70, v71
    v_cvt_pk_bf16_f32 v182, v84, v85
    v_cvt_pk_bf16_f32 v183, v86, v87
    v_mul_f32 v100, s25, v100
    v_mul_f32 v116, s25, v116
    v_mul_f32 v101, s25, v101
    v_mul_f32 v117, s25, v117
    v_mul_f32 v102, s25, v102
    v_mul_f32 v118, s25, v118
    v_mul_f32 v103, s25, v103
    v_mul_f32 v119, s25, v119
    v_cvt_pk_bf16_f32 v184, v100, v101
    v_cvt_pk_bf16_f32 v185, v102, v103
    v_cvt_pk_bf16_f32 v186, v116, v117
    v_cvt_pk_bf16_f32 v187, v118, v119
    v_mul_f32 v132, s25, v132
    v_mul_f32 v148, s25, v148
    v_mul_f32 v133, s25, v133
    v_mul_f32 v149, s25, v149
    v_mul_f32 v134, s25, v134
    v_mul_f32 v150, s25, v150
    v_mul_f32 v135, s25, v135
    v_mul_f32 v151, s25, v151
    v_cvt_pk_bf16_f32 v188, v132, v133
    v_cvt_pk_bf16_f32 v189, v134, v135
    v_cvt_pk_bf16_f32 v190, v148, v149
    v_cvt_pk_bf16_f32 v191, v150, v151
    s_cmp_eq_u32 s18, 1
    s_cbranch_scc0 a_G_NOSIG
    s_add_u32 s25, s16, 0
    s_lshl_b32 s60, s25, 7
    s_lshl_b32 s61, s17, 2
    s_add_u32 s60, s60, s61
    v_and_b32 v30, 63, v0
    v_lshlrev_b32 v30, 16, v30
    v_mov_b32 v31, s63
    buffer_store_dword v31, v30, s[56:59], s60 offen sc1
a_G_NOSIG:
    s_waitcnt lgkmcnt(0)
    s_barrier
    s_barrier
    s_cmp_eq_u32 s18, 1
    s_cbranch_scc0 a_G_NOWAIT
    s_add_u32 s25, s16, 0
    v_and_b32 v30, 7, v0
    v_lshlrev_b32 v30, 2, v30
    s_lshl_b32 s62, s25, 7
    s_mov_b32 s61, 0
a_W_KV:
    buffer_load_dword v31, v30, s[56:59], s62 offen sc1
    s_waitcnt vmcnt(0)
    v_cmp_ne_u32 vcc, s63, v31
    s_nop 4
    s_cbranch_vccz a_WOK_KV
    s_sleep 8
    s_add_u32 s61, s61, 1
    s_cmp_lt_u32 s61, 65536
    s_cbranch_scc1 a_W_KV
a_WOK_KV:
a_G_NOWAIT:
    s_barrier
    s_barrier
    s_load_dwordx2 s[34:35], s[0:1], 88
    s_lshl_b32 s25, s30, 13
    v_add_u32 v11, s25, v1
    v_add_u32 v12, 4096, v11
    s_lshl_b32 s23, s30, 13
    s_mov_b32 s22, 0
    s_lshl_b32 s26, s16, 20
    s_waitcnt lgkmcnt(0)
    s_add_u32 s4, s34, s26
    s_addc_u32 s5, s35, 0
    s_mov_b32 s6, 1048576
    s_mov_b32 s7, 0x20000
    s_mov_b32 m0, s23
    s_nop 0
    buffer_load_dwordx4 v11, s[4:7], s22 offen offset:0 lds
    buffer_load_dwordx4 v11, s[4:7], s22 offen offset:1024 lds
    buffer_load_dwordx4 v11, s[4:7], s22 offen offset:2048 lds
    buffer_load_dwordx4 v11, s[4:7], s22 offen offset:3072 lds
    s_add_u32 m0, s23, 4096
    s_nop 0
    buffer_load_dwordx4 v12, s[4:7], s22 offen offset:0 lds
    buffer_load_dwordx4 v12, s[4:7], s22 offen offset:1024 lds
    buffer_load_dwordx4 v12, s[4:7], s22 offen offset:2048 lds
    buffer_load_dwordx4 v12, s[4:7], s22 offen offset:3072 lds
    s_add_u32 s22, s22, 32768
    s_add_u32 s23, s23, 32768
    s_and_b32 s23, s23, 131071
    s_mov_b32 m0, s23
    s_nop 0
    buffer_load_dwordx4 v11, s[4:7], s22 offen offset:0 lds
    buffer_load_dwordx4 v11, s[4:7], s22 offen offset:1024 lds
    buffer_load_dwordx4 v11, s[4:7], s22 offen offset:2048 lds
    buffer_load_dwordx4 v11, s[4:7], s22 offen offset:3072 lds
    s_add_u32 m0, s23, 4096
    s_nop 0
    buffer_load_dwordx4 v12, s[4:7], s22 offen offset:0 lds
    buffer_load_dwordx4 v12, s[4:7], s22 offen offset:1024 lds
    buffer_load_dwordx4 v12, s[4:7], s22 offen offset:2048 lds
    buffer_load_dwordx4 v12, s[4:7], s22 offen offset:3072 lds
    s_add_u32 s22, s22, 32768
    s_add_u32 s23, s23, 32768
    s_and_b32 s23, s23, 131071
    s_barrier
    s_waitcnt vmcnt(0)
    s_branch K2_QJOIN
a_G_GB:
    s_cmp_eq_u32 s18, 6
    s_cbranch_scc0 a_G_NONONCE
    s_load_dwordx2 s[64:65], s[0:1], 80
    s_memrealtime s[60:61]
    s_waitcnt lgkmcnt(0)
    s_mov_b32 s66, 256
    s_mov_b32 s67, 0x20000
    s_or_b32 s60, s60, 1
    v_and_b32 v28, 63, v0
    v_lshlrev_b32 v28, 8, v28
    v_mov_b32 v30, s60
    v_mov_b32 v31, 0
    buffer_atomic_cmpswap v[30:31], v28, s[64:67], 0 offen
    s_waitcnt vmcnt(0)
a_G_NONONCE:
    v_lshlrev_b32 v160, 7, v15
    s_lshl_b32 s51, s2, 13
    s_cmp_eq_u32 s18, 5
    s_cbranch_scc0 a_G_NOPF1
    s_mov_b32 s8, s68
    s_mov_b32 s9, s69
    s_mov_b32 s10, 2097152
    s_mov_b32 s11, 0x20000
    s_add_u32 s26, s51, 0
    buffer_load_dword v253, v160, s[8:11], s26 offen
    s_mov_b32 s8, s70
    s_mov_b32 s9, s71
    s_mov_b32 s10, 4194304
    s_mov_b32 s11, 0x20000
    s_add_u32 s26, s51, 0
    buffer_load_dword v253, v160, s[8:11], s26 offen
    s_mov_b32 s8, s70
    s_mov_b32 s9, s71
    s_mov_b32 s10, 4194304
    s_mov_b32 s11, 0x20000
    s_add_u32 s26, s51, 2097152
    buffer_load_dword v253, v160, s[8:11], s26 offen
a_G_NOPF1:
    s_barrier
    s_cmp_eq_u32 s18, 5
    s_cbranch_scc0 a_G_NOPF2
    s_mov_b32 s8, s72
    s_mov_b32 s9, s73
    s_mov_b32 s10, 4194304
    s_mov_b32 s11, 0x20000
    s_add_u32 s26, s51, 0
    buffer_load_dword v253, v160, s[8:11], s26 offen
a_G_NOPF2:
    s_barrier
    s_cmp_eq_u32 s18, 5
    s_cbranch_scc0 a_G_NOPF3
    s_mov_b32 s8, s72
    s_mov_b32 s9, s73
    s_mov_b32 s10, 4194304
    s_mov_b32 s11, 0x20000
    s_add_u32 s26, s51, 2097152
    buffer_load_dword v253, v160, s[8:11], s26 offen
a_G_NOPF3:
    s_barrier
    s_cmp_eq_u32 s18, 5
    s_cbranch_scc0 a_G_NOPF4
    s_mov_b32 s8, s78
    s_mov_b32 s9, s79
    s_mov_b32 s10, 2097152
    s_mov_b32 s11, 0x20000
    s_add_u32 s26, s51, 0
    buffer_load_dword v253, v160, s[8:11], s26 offen
a_G_NOPF4:
    s_barrier
    s_cmp_eq_u32 s18, 5
    s_cbranch_scc0 a_G_NOPF5
    s_mov_b32 s8, s80
    s_mov_b32 s9, s81
    s_mov_b32 s10, 4194304
    s_mov_b32 s11, 0x20000
    s_add_u32 s26, s51, 0
    buffer_load_dword v253, v160, s[8:11], s26 offen
a_G_NOPF5:
    s_barrier
    s_cmp_eq_u32 s18, 5
    s_cbranch_scc0 a_G_NOPF6
    s_mov_b32 s8, s80
    s_mov_b32 s9, s81
    s_mov_b32 s10, 4194304
    s_mov_b32 s11, 0x20000
    s_add_u32 s26, s51, 2097152
    buffer_load_dword v253, v160, s[8:11], s26 offen
a_G_NOPF6:
    s_mov_b32 s8, s68
    s_mov_b32 s9, s69
    s_mov_b32 s10, 2097152
    s_mov_b32 s11, 0x20000
    s_mov_b32 s36, s72
    s_mov_b32 s37, s73
    s_mov_b32 s38, 4194304
    s_mov_b32 s39, 0x20000
    s_lshl_b32 s44, s17, 18
    s_lshl_b32 s25, s30, 16
    s_add_u32 s44, s44, s25
    s_add_u32 s54, s44, 32768
    s_lshl_b32 s45, s16, 8
    v_and_b32 v7, 15, v15
    v_lshrrev_b32 v9, 1, v7
    v_xor_b32 v9, v6, v9
    v_lshlrev_b32 v9, 4, v9
    v_lshl_add_u32 v9, v7, 7, v9
    s_lshl_b32 s25, s30, 13
    s_add_u32 s25, s25, 114688
    v_add_u32 v240, s25, v9
    v_xor_b32 v241, 64, v240
    v_lshrrev_b32 v9, 2, v7
    v_lshl_add_u32 v10, v6, 3, v9
    v_lshlrev_b32 v10, 8, v10
    v_and_b32 v160, 3, v7
    v_lshl_add_u32 v10, v160, 3, v10
    v_add_u32 v10, 114688, v10
    v_and_b32 v160, 1, v6
    v_lshl_add_u32 v9, v160, 2, v9
    v_xor_b32 v160, 0, v9
    v_lshl_add_u32 v242, v160, 5, v10
    v_xor_b32 v160, 1, v9
    v_lshl_add_u32 v243, v160, 5, v10
    v_xor_b32 v160, 2, v9
    v_lshl_add_u32 v244, v160, 5, v10
    v_xor_b32 v160, 3, v9
    v_lshl_add_u32 v245, v160, 5, v10
    v_xor_b32 v160, 4, v9
    v_lshl_add_u32 v246, v160, 5, v10
    v_xor_b32 v160, 5, v9
    v_lshl_add_u32 v247, v160, 5, v10
    v_xor_b32 v160, 6, v9
    v_lshl_add_u32 v248, v160, 5, v10
    v_xor_b32 v160, 7, v9
    v_lshl_add_u32 v249, v160, 5, v10
    s_mov_b32 s40, 4294868992
    s_mov_b32 s41, 49152
    s_mov_b32 s42, 49152
    v_mov_b64 v[32:33], 0
    v_mov_b64 v[34:35], 0
    v_mov_b64 v[36:37], 0
    v_mov_b64 v[38:39], 0
    v_mov_b64 v[40:41], 0
    v_mov_b64 v[42:43], 0
    v_mov_b64 v[44:45], 0
    v_mov_b64 v[46:47], 0
    v_mov_b64 v[48:49], 0
    v_mov_b64 v[50:51], 0
    v_mov_b64 v[52:53], 0
    v_mov_b64 v[54:55], 0
    v_mov_b64 v[56:57], 0
    v_mov_b64 v[58:59], 0
    v_mov_b64 v[60:61], 0
    v_mov_b64 v[62:63], 0
    v_mov_b64 v[64:65], 0
    v_mov_b64 v[66:67], 0
    v_mov_b64 v[68:69], 0
    v_mov_b64 v[70:71], 0
    v_mov_b64 v[72:73], 0
    v_mov_b64 v[74:75], 0
    v_mov_b64 v[76:77], 0
    v_mov_b64 v[78:79], 0
    v_mov_b64 v[80:81], 0
    v_mov_b64 v[82:83], 0
    v_mov_b64 v[84:85], 0
    v_mov_b64 v[86:87], 0
    v_mov_b64 v[88:89], 0
    v_mov_b64 v[90:91], 0
    v_mov_b64 v[92:93], 0
    v_mov_b64 v[94:95], 0
    v_mov_b64 v[96:97], 0
    v_mov_b64 v[98:99], 0
    v_mov_b64 v[100:101], 0
    v_mov_b64 v[102:103], 0
    v_mov_b64 v[104:105], 0
    v_mov_b64 v[106:107], 0
    v_mov_b64 v[108:109], 0
    v_mov_b64 v[110:111], 0
    v_mov_b64 v[112:113], 0
    v_mov_b64 v[114:115], 0
    v_mov_b64 v[116:117], 0
    v_mov_b64 v[118:119], 0
    v_mov_b64 v[120:121], 0
    v_mov_b64 v[122:123], 0
    v_mov_b64 v[124:125], 0
    v_mov_b64 v[126:127], 0
    v_mov_b64 v[128:129], 0
    v_mov_b64 v[130:131], 0
    v_mov_b64 v[132:133], 0
    v_mov_b64 v[134:135], 0
    v_mov_b64 v[136:137], 0
    v_mov_b64 v[138:139], 0
    v_mov_b64 v[140:141], 0
    v_mov_b64 v[142:143], 0
    v_mov_b64 v[144:145], 0
    v_mov_b64 v[146:147], 0
    v_mov_b64 v[148:149], 0
    v_mov_b64 v[150:151], 0
    v_mov_b64 v[152:153], 0
    v_mov_b64 v[154:155], 0
    v_mov_b64 v[156:157], 0
    v_mov_b64 v[158:159], 0
    s_barrier
    s_barrier
    s_mov_b32 s43, 114688
    s_add_u32 m0, s43, s47
    s_nop 0
    buffer_load_dwordx4 v16, s[8:11], s44 offen offset:0 lds
    buffer_load_dwordx4 v17, s[8:11], s44 offen offset:1024 lds
    buffer_load_dwordx4 v18, s[8:11], s44 offen offset:2048 lds
    buffer_load_dwordx4 v19, s[8:11], s44 offen offset:3072 lds
    s_add_u32 m0, m0, 4096
    s_nop 0
    buffer_load_dwordx4 v16, s[8:11], s54 offen offset:0 lds
    buffer_load_dwordx4 v17, s[8:11], s54 offen offset:1024 lds
    buffer_load_dwordx4 v18, s[8:11], s54 offen offset:2048 lds
    buffer_load_dwordx4 v19, s[8:11], s54 offen offset:3072 lds
    s_add_u32 m0, s43, s48
    s_nop 0
    buffer_load_dwordx4 v20, s[36:39], s45 offen offset:0 lds
    buffer_load_dwordx4 v21, s[36:39], s45 offen offset:1024 lds
    buffer_load_dwordx4 v22, s[36:39], s45 offen offset:2048 lds
    buffer_load_dwordx4 v23, s[36:39], s45 offen offset:3072 lds
    s_add_u32 s44, s44, 128
    s_add_u32 s54, s54, 128
    s_add_u32 s45, s45, 524288
    s_barrier
    s_mov_b32 s43, 16384
    s_add_u32 m0, s43, s47
    s_nop 0
    buffer_load_dwordx4 v16, s[8:11], s44 offen offset:0 lds
    buffer_load_dwordx4 v17, s[8:11], s44 offen offset:1024 lds
    buffer_load_dwordx4 v18, s[8:11], s44 offen offset:2048 lds
    buffer_load_dwordx4 v19, s[8:11], s44 offen offset:3072 lds
    s_add_u32 m0, m0, 4096
    s_nop 0
    buffer_load_dwordx4 v16, s[8:11], s54 offen offset:0 lds
    buffer_load_dwordx4 v17, s[8:11], s54 offen offset:1024 lds
    buffer_load_dwordx4 v18, s[8:11], s54 offen offset:2048 lds
    buffer_load_dwordx4 v19, s[8:11], s54 offen offset:3072 lds
    s_add_u32 m0, s43, s48
    s_nop 0
    buffer_load_dwordx4 v20, s[36:39], s45 offen offset:0 lds
    buffer_load_dwordx4 v21, s[36:39], s45 offen offset:1024 lds
    buffer_load_dwordx4 v22, s[36:39], s45 offen offset:2048 lds
    buffer_load_dwordx4 v23, s[36:39], s45 offen offset:3072 lds
    s_add_u32 s44, s44, 128
    s_add_u32 s54, s54, 128
    s_add_u32 s45, s45, 524288
    s_mov_b32 s43, 65536
    s_add_u32 m0, s43, s47
    s_waitcnt vmcnt(12)
    s_barrier
    ds_read_b128 v[192:195], v240 offset:16384
    ds_read_b128 v[196:199], v240 offset:18432
    ds_read_b128 v[200:203], v240 offset:20480
    ds_read_b128 v[204:207], v240 offset:22528
    ds_read_b64_tr_b16 v[224:225], v242 offset:0
    ds_read_b64_tr_b16 v[226:227], v242 offset:1024
    ds_read_b64_tr_b16 v[228:229], v243 offset:0
    ds_read_b64_tr_b16 v[230:231], v243 offset:1024
    s_waitcnt lgkmcnt(2)
    s_mov_b32 s46, 5
a_G_V_L:
    v_mfma_f32_16x16x32_bf16 v[32:35], v[192:195], v[224:227], v[32:35]
    ds_read_b64_tr_b16 v[232:233], v244 offset:0
    v_mfma_f32_16x16x32_bf16 v[36:39], v[196:199], v[224:227], v[36:39]
    ds_read_b64_tr_b16 v[234:235], v244 offset:1024
    v_mfma_f32_16x16x32_bf16 v[40:43], v[200:203], v[224:227], v[40:43]
    ds_read_b64_tr_b16 v[236:237], v245 offset:0
    buffer_load_dwordx4 v16, s[8:11], s44 offen offset:0 lds
    v_mfma_f32_16x16x32_bf16 v[44:47], v[204:207], v[224:227], v[44:47]
    s_waitcnt lgkmcnt(3)
    ds_read_b64_tr_b16 v[238:239], v245 offset:1024
    v_mfma_f32_16x16x32_bf16 v[48:51], v[192:195], v[228:231], v[48:51]
    ds_read_b64_tr_b16 v[224:225], v246 offset:0
    v_mfma_f32_16x16x32_bf16 v[52:55], v[196:199], v[228:231], v[52:55]
    ds_read_b64_tr_b16 v[226:227], v246 offset:1024
    v_mfma_f32_16x16x32_bf16 v[56:59], v[200:203], v[228:231], v[56:59]
    ds_read_b128 v[208:211], v241 offset:16384
    buffer_load_dwordx4 v17, s[8:11], s44 offen offset:1024 lds
    v_mfma_f32_16x16x32_bf16 v[60:63], v[204:207], v[228:231], v[60:63]
    s_waitcnt lgkmcnt(5)
    v_add_u32 v240, s40, v240
    v_mfma_f32_16x16x32_bf16 v[64:67], v[192:195], v[232:235], v[64:67]
    ds_read_b64_tr_b16 v[228:229], v247 offset:0
    v_mfma_f32_16x16x32_bf16 v[68:71], v[196:199], v[232:235], v[68:71]
    ds_read_b64_tr_b16 v[230:231], v247 offset:1024
    v_mfma_f32_16x16x32_bf16 v[72:75], v[200:203], v[232:235], v[72:75]
    ds_read_b128 v[212:215], v241 offset:18432
    buffer_load_dwordx4 v18, s[8:11], s44 offen offset:2048 lds
    v_mfma_f32_16x16x32_bf16 v[76:79], v[204:207], v[232:235], v[76:79]
    s_waitcnt lgkmcnt(6)
    v_mfma_f32_16x16x32_bf16 v[80:83], v[192:195], v[236:239], v[80:83]
    ds_read_b64_tr_b16 v[232:233], v248 offset:0
    v_mfma_f32_16x16x32_bf16 v[84:87], v[196:199], v[236:239], v[84:87]
    ds_read_b64_tr_b16 v[234:235], v248 offset:1024
    v_mfma_f32_16x16x32_bf16 v[88:91], v[200:203], v[236:239], v[88:91]
    ds_read_b128 v[216:219], v241 offset:20480
    buffer_load_dwordx4 v19, s[8:11], s44 offen offset:3072 lds
    s_add_u32 m0, m0, 4096
    v_mfma_f32_16x16x32_bf16 v[92:95], v[204:207], v[236:239], v[92:95]
    s_waitcnt lgkmcnt(7)
    v_mfma_f32_16x16x32_bf16 v[96:99], v[192:195], v[224:227], v[96:99]
    ds_read_b64_tr_b16 v[236:237], v249 offset:0
    v_mfma_f32_16x16x32_bf16 v[100:103], v[196:199], v[224:227], v[100:103]
    ds_read_b64_tr_b16 v[238:239], v249 offset:1024
    v_mfma_f32_16x16x32_bf16 v[104:107], v[200:203], v[224:227], v[104:107]
    ds_read_b128 v[220:223], v241 offset:22528
    buffer_load_dwordx4 v16, s[8:11], s54 offen offset:0 lds
    v_mfma_f32_16x16x32_bf16 v[108:111], v[204:207], v[224:227], v[108:111]
    s_waitcnt lgkmcnt(7)
    v_mfma_f32_16x16x32_bf16 v[112:115], v[192:195], v[228:231], v[112:115]
    ds_read_b64_tr_b16 v[224:225], v242 offset:8192
    v_mfma_f32_16x16x32_bf16 v[116:119], v[196:199], v[228:231], v[116:119]
    ds_read_b64_tr_b16 v[226:227], v242 offset:9216
    v_mfma_f32_16x16x32_bf16 v[120:123], v[200:203], v[228:231], v[120:123]
    buffer_load_dwordx4 v17, s[8:11], s54 offen offset:1024 lds
    v_mfma_f32_16x16x32_bf16 v[124:127], v[204:207], v[228:231], v[124:127]
    s_waitcnt lgkmcnt(6)
    v_add_u32 v242, s40, v242
    v_mfma_f32_16x16x32_bf16 v[128:131], v[192:195], v[232:235], v[128:131]
    ds_read_b64_tr_b16 v[228:229], v243 offset:8192
    v_mfma_f32_16x16x32_bf16 v[132:135], v[196:199], v[232:235], v[132:135]
    ds_read_b64_tr_b16 v[230:231], v243 offset:9216
    v_mfma_f32_16x16x32_bf16 v[136:139], v[200:203], v[232:235], v[136:139]
    buffer_load_dwordx4 v18, s[8:11], s54 offen offset:2048 lds
    v_mfma_f32_16x16x32_bf16 v[140:143], v[204:207], v[232:235], v[140:143]
    s_waitcnt lgkmcnt(5)
    v_add_u32 v243, s40, v243
    v_add_u32 v241, s40, v241
    v_mfma_f32_16x16x32_bf16 v[144:147], v[192:195], v[236:239], v[144:147]
    ds_read_b64_tr_b16 v[232:233], v244 offset:8192
    v_mfma_f32_16x16x32_bf16 v[148:151], v[196:199], v[236:239], v[148:151]
    ds_read_b64_tr_b16 v[234:235], v244 offset:9216
    v_mfma_f32_16x16x32_bf16 v[152:155], v[200:203], v[236:239], v[152:155]
    buffer_load_dwordx4 v19, s[8:11], s54 offen offset:3072 lds
    s_add_u32 m0, s43, s48
    v_mfma_f32_16x16x32_bf16 v[156:159], v[204:207], v[236:239], v[156:159]
    s_waitcnt lgkmcnt(4)
    v_add_u32 v244, s40, v244
    v_mfma_f32_16x16x32_bf16 v[32:35], v[208:211], v[224:227], v[32:35]
    ds_read_b64_tr_b16 v[236:237], v245 offset:8192
    v_mfma_f32_16x16x32_bf16 v[36:39], v[212:215], v[224:227], v[36:39]
    ds_read_b64_tr_b16 v[238:239], v245 offset:9216
    v_mfma_f32_16x16x32_bf16 v[40:43], v[216:219], v[224:227], v[40:43]
    buffer_load_dwordx4 v20, s[36:39], s45 offen offset:0 lds
    v_mfma_f32_16x16x32_bf16 v[44:47], v[220:223], v[224:227], v[44:47]
    s_waitcnt lgkmcnt(4)
    v_add_u32 v245, s40, v245
    v_mfma_f32_16x16x32_bf16 v[48:51], v[208:211], v[228:231], v[48:51]
    ds_read_b64_tr_b16 v[224:225], v246 offset:8192
    v_mfma_f32_16x16x32_bf16 v[52:55], v[212:215], v[228:231], v[52:55]
    ds_read_b64_tr_b16 v[226:227], v246 offset:9216
    v_mfma_f32_16x16x32_bf16 v[56:59], v[216:219], v[228:231], v[56:59]
    buffer_load_dwordx4 v21, s[36:39], s45 offen offset:1024 lds
    v_mfma_f32_16x16x32_bf16 v[60:63], v[220:223], v[228:231], v[60:63]
    s_waitcnt lgkmcnt(4)
    v_add_u32 v246, s40, v246
    v_mfma_f32_16x16x32_bf16 v[64:67], v[208:211], v[232:235], v[64:67]
    ds_read_b64_tr_b16 v[228:229], v247 offset:8192
    v_mfma_f32_16x16x32_bf16 v[68:71], v[212:215], v[232:235], v[68:71]
    ds_read_b64_tr_b16 v[230:231], v247 offset:9216
    v_mfma_f32_16x16x32_bf16 v[72:75], v[216:219], v[232:235], v[72:75]
    buffer_load_dwordx4 v22, s[36:39], s45 offen offset:2048 lds
    v_mfma_f32_16x16x32_bf16 v[76:79], v[220:223], v[232:235], v[76:79]
    s_waitcnt lgkmcnt(4)
    v_add_u32 v247, s40, v247
    v_mfma_f32_16x16x32_bf16 v[80:83], v[208:211], v[236:239], v[80:83]
    ds_read_b64_tr_b16 v[232:233], v248 offset:8192
    v_mfma_f32_16x16x32_bf16 v[84:87], v[212:215], v[236:239], v[84:87]
    ds_read_b64_tr_b16 v[234:235], v248 offset:9216
    v_mfma_f32_16x16x32_bf16 v[88:91], v[216:219], v[236:239], v[88:91]
    buffer_load_dwordx4 v23, s[36:39], s45 offen offset:3072 lds
    v_mfma_f32_16x16x32_bf16 v[92:95], v[220:223], v[236:239], v[92:95]
    s_waitcnt lgkmcnt(4)
    v_add_u32 v248, s40, v248
    v_mfma_f32_16x16x32_bf16 v[96:99], v[208:211], v[224:227], v[96:99]
    ds_read_b64_tr_b16 v[236:237], v249 offset:8192
    v_mfma_f32_16x16x32_bf16 v[100:103], v[212:215], v[224:227], v[100:103]
    ds_read_b64_tr_b16 v[238:239], v249 offset:9216
    v_mfma_f32_16x16x32_bf16 v[104:107], v[216:219], v[224:227], v[104:107]
    v_mfma_f32_16x16x32_bf16 v[108:111], v[220:223], v[224:227], v[108:111]
    s_waitcnt lgkmcnt(4)
    v_add_u32 v249, s40, v249
    s_add_u32 s44, s44, 128
    s_add_u32 s54, s54, 128
    s_add_u32 s45, s45, 524288
    s_add_u32 s43, s43, s42
    v_mfma_f32_16x16x32_bf16 v[112:115], v[208:211], v[228:231], v[112:115]
    v_mfma_f32_16x16x32_bf16 v[116:119], v[212:215], v[228:231], v[116:119]
    s_mov_b32 s25, s40
    s_mov_b32 s40, s41
    v_mfma_f32_16x16x32_bf16 v[120:123], v[216:219], v[228:231], v[120:123]
    v_mfma_f32_16x16x32_bf16 v[124:127], v[220:223], v[228:231], v[124:127]
    s_waitcnt lgkmcnt(2)
    v_mfma_f32_16x16x32_bf16 v[128:131], v[208:211], v[232:235], v[128:131]
    s_waitcnt vmcnt(12) lgkmcnt(0)
    s_barrier
    ds_read_b128 v[192:195], v240 offset:16384
    ds_read_b64_tr_b16 v[224:225], v242 offset:0
    v_mfma_f32_16x16x32_bf16 v[132:135], v[212:215], v[232:235], v[132:135]
    ds_read_b128 v[196:199], v240 offset:18432
    ds_read_b64_tr_b16 v[226:227], v242 offset:1024
    s_mov_b32 s41, s42
    s_mov_b32 s42, s25
    v_mfma_f32_16x16x32_bf16 v[136:139], v[216:219], v[232:235], v[136:139]
    ds_read_b128 v[200:203], v240 offset:20480
    v_mfma_f32_16x16x32_bf16 v[140:143], v[220:223], v[232:235], v[140:143]
    s_waitcnt lgkmcnt(5)
    ds_read_b128 v[204:207], v240 offset:22528
    v_mfma_f32_16x16x32_bf16 v[144:147], v[208:211], v[236:239], v[144:147]
    ds_read_b64_tr_b16 v[228:229], v243 offset:0
    v_mfma_f32_16x16x32_bf16 v[148:151], v[212:215], v[236:239], v[148:151]
    ds_read_b64_tr_b16 v[230:231], v243 offset:1024
    s_add_u32 m0, s43, s47
    v_mfma_f32_16x16x32_bf16 v[152:155], v[216:219], v[236:239], v[152:155]
    v_mfma_f32_16x16x32_bf16 v[156:159], v[220:223], v[236:239], v[156:159]
    s_waitcnt lgkmcnt(2)
    s_sub_u32 s46, s46, 1
    s_cbranch_scc0 a_G_V_L
    s_mov_b32 s46, 1
a_G_V_T:
    v_mfma_f32_16x16x32_bf16 v[32:35], v[192:195], v[224:227], v[32:35]
    ds_read_b64_tr_b16 v[232:233], v244 offset:0
    v_mfma_f32_16x16x32_bf16 v[36:39], v[196:199], v[224:227], v[36:39]
    ds_read_b64_tr_b16 v[234:235], v244 offset:1024
    v_mfma_f32_16x16x32_bf16 v[40:43], v[200:203], v[224:227], v[40:43]
    ds_read_b64_tr_b16 v[236:237], v245 offset:0
    v_mfma_f32_16x16x32_bf16 v[44:47], v[204:207], v[224:227], v[44:47]
    s_waitcnt lgkmcnt(3)
    ds_read_b64_tr_b16 v[238:239], v245 offset:1024
    v_mfma_f32_16x16x32_bf16 v[48:51], v[192:195], v[228:231], v[48:51]
    ds_read_b64_tr_b16 v[224:225], v246 offset:0
    v_mfma_f32_16x16x32_bf16 v[52:55], v[196:199], v[228:231], v[52:55]
    ds_read_b64_tr_b16 v[226:227], v246 offset:1024
    v_mfma_f32_16x16x32_bf16 v[56:59], v[200:203], v[228:231], v[56:59]
    ds_read_b128 v[208:211], v241 offset:16384
    v_mfma_f32_16x16x32_bf16 v[60:63], v[204:207], v[228:231], v[60:63]
    s_waitcnt lgkmcnt(5)
    v_add_u32 v240, s40, v240
    v_mfma_f32_16x16x32_bf16 v[64:67], v[192:195], v[232:235], v[64:67]
    ds_read_b64_tr_b16 v[228:229], v247 offset:0
    v_mfma_f32_16x16x32_bf16 v[68:71], v[196:199], v[232:235], v[68:71]
    ds_read_b64_tr_b16 v[230:231], v247 offset:1024
    v_mfma_f32_16x16x32_bf16 v[72:75], v[200:203], v[232:235], v[72:75]
    ds_read_b128 v[212:215], v241 offset:18432
    v_mfma_f32_16x16x32_bf16 v[76:79], v[204:207], v[232:235], v[76:79]
    s_waitcnt lgkmcnt(6)
    v_mfma_f32_16x16x32_bf16 v[80:83], v[192:195], v[236:239], v[80:83]
    ds_read_b64_tr_b16 v[232:233], v248 offset:0
    v_mfma_f32_16x16x32_bf16 v[84:87], v[196:199], v[236:239], v[84:87]
    ds_read_b64_tr_b16 v[234:235], v248 offset:1024
    v_mfma_f32_16x16x32_bf16 v[88:91], v[200:203], v[236:239], v[88:91]
    ds_read_b128 v[216:219], v241 offset:20480
    v_mfma_f32_16x16x32_bf16 v[92:95], v[204:207], v[236:239], v[92:95]
    s_waitcnt lgkmcnt(7)
    v_mfma_f32_16x16x32_bf16 v[96:99], v[192:195], v[224:227], v[96:99]
    ds_read_b64_tr_b16 v[236:237], v249 offset:0
    v_mfma_f32_16x16x32_bf16 v[100:103], v[196:199], v[224:227], v[100:103]
    ds_read_b64_tr_b16 v[238:239], v249 offset:1024
    v_mfma_f32_16x16x32_bf16 v[104:107], v[200:203], v[224:227], v[104:107]
    ds_read_b128 v[220:223], v241 offset:22528
    v_mfma_f32_16x16x32_bf16 v[108:111], v[204:207], v[224:227], v[108:111]
    s_waitcnt lgkmcnt(7)
    v_mfma_f32_16x16x32_bf16 v[112:115], v[192:195], v[228:231], v[112:115]
    ds_read_b64_tr_b16 v[224:225], v242 offset:8192
    v_mfma_f32_16x16x32_bf16 v[116:119], v[196:199], v[228:231], v[116:119]
    ds_read_b64_tr_b16 v[226:227], v242 offset:9216
    v_mfma_f32_16x16x32_bf16 v[120:123], v[200:203], v[228:231], v[120:123]
    v_mfma_f32_16x16x32_bf16 v[124:127], v[204:207], v[228:231], v[124:127]
    s_waitcnt lgkmcnt(6)
    v_add_u32 v242, s40, v242
    v_mfma_f32_16x16x32_bf16 v[128:131], v[192:195], v[232:235], v[128:131]
    ds_read_b64_tr_b16 v[228:229], v243 offset:8192
    v_mfma_f32_16x16x32_bf16 v[132:135], v[196:199], v[232:235], v[132:135]
    ds_read_b64_tr_b16 v[230:231], v243 offset:9216
    v_mfma_f32_16x16x32_bf16 v[136:139], v[200:203], v[232:235], v[136:139]
    v_mfma_f32_16x16x32_bf16 v[140:143], v[204:207], v[232:235], v[140:143]
    s_waitcnt lgkmcnt(5)
    v_add_u32 v243, s40, v243
    v_add_u32 v241, s40, v241
    v_mfma_f32_16x16x32_bf16 v[144:147], v[192:195], v[236:239], v[144:147]
    ds_read_b64_tr_b16 v[232:233], v244 offset:8192
    v_mfma_f32_16x16x32_bf16 v[148:151], v[196:199], v[236:239], v[148:151]
    ds_read_b64_tr_b16 v[234:235], v244 offset:9216
    v_mfma_f32_16x16x32_bf16 v[152:155], v[200:203], v[236:239], v[152:155]
    v_mfma_f32_16x16x32_bf16 v[156:159], v[204:207], v[236:239], v[156:159]
    s_waitcnt lgkmcnt(4)
    v_add_u32 v244, s40, v244
    v_mfma_f32_16x16x32_bf16 v[32:35], v[208:211], v[224:227], v[32:35]
    ds_read_b64_tr_b16 v[236:237], v245 offset:8192
    v_mfma_f32_16x16x32_bf16 v[36:39], v[212:215], v[224:227], v[36:39]
    ds_read_b64_tr_b16 v[238:239], v245 offset:9216
    v_mfma_f32_16x16x32_bf16 v[40:43], v[216:219], v[224:227], v[40:43]
    v_mfma_f32_16x16x32_bf16 v[44:47], v[220:223], v[224:227], v[44:47]
    s_waitcnt lgkmcnt(4)
    v_add_u32 v245, s40, v245
    v_mfma_f32_16x16x32_bf16 v[48:51], v[208:211], v[228:231], v[48:51]
    ds_read_b64_tr_b16 v[224:225], v246 offset:8192
    v_mfma_f32_16x16x32_bf16 v[52:55], v[212:215], v[228:231], v[52:55]
    ds_read_b64_tr_b16 v[226:227], v246 offset:9216
    v_mfma_f32_16x16x32_bf16 v[56:59], v[216:219], v[228:231], v[56:59]
    v_mfma_f32_16x16x32_bf16 v[60:63], v[220:223], v[228:231], v[60:63]
    s_waitcnt lgkmcnt(4)
    v_add_u32 v246, s40, v246
    v_mfma_f32_16x16x32_bf16 v[64:67], v[208:211], v[232:235], v[64:67]
    ds_read_b64_tr_b16 v[228:229], v247 offset:8192
    v_mfma_f32_16x16x32_bf16 v[68:71], v[212:215], v[232:235], v[68:71]
    ds_read_b64_tr_b16 v[230:231], v247 offset:9216
    v_mfma_f32_16x16x32_bf16 v[72:75], v[216:219], v[232:235], v[72:75]
    v_mfma_f32_16x16x32_bf16 v[76:79], v[220:223], v[232:235], v[76:79]
    s_waitcnt lgkmcnt(4)
    v_add_u32 v247, s40, v247
    v_mfma_f32_16x16x32_bf16 v[80:83], v[208:211], v[236:239], v[80:83]
    ds_read_b64_tr_b16 v[232:233], v248 offset:8192
    v_mfma_f32_16x16x32_bf16 v[84:87], v[212:215], v[236:239], v[84:87]
    ds_read_b64_tr_b16 v[234:235], v248 offset:9216
    v_mfma_f32_16x16x32_bf16 v[88:91], v[216:219], v[236:239], v[88:91]
    v_mfma_f32_16x16x32_bf16 v[92:95], v[220:223], v[236:239], v[92:95]
    s_waitcnt lgkmcnt(4)
    v_add_u32 v248, s40, v248
    v_mfma_f32_16x16x32_bf16 v[96:99], v[208:211], v[224:227], v[96:99]
    ds_read_b64_tr_b16 v[236:237], v249 offset:8192
    v_mfma_f32_16x16x32_bf16 v[100:103], v[212:215], v[224:227], v[100:103]
    ds_read_b64_tr_b16 v[238:239], v249 offset:9216
    v_mfma_f32_16x16x32_bf16 v[104:107], v[216:219], v[224:227], v[104:107]
    v_mfma_f32_16x16x32_bf16 v[108:111], v[220:223], v[224:227], v[108:111]
    s_waitcnt lgkmcnt(4)
    v_add_u32 v249, s40, v249
    v_mfma_f32_16x16x32_bf16 v[112:115], v[208:211], v[228:231], v[112:115]
    v_mfma_f32_16x16x32_bf16 v[116:119], v[212:215], v[228:231], v[116:119]
    s_mov_b32 s25, s40
    s_mov_b32 s40, s41
    v_mfma_f32_16x16x32_bf16 v[120:123], v[216:219], v[228:231], v[120:123]
    v_mfma_f32_16x16x32_bf16 v[124:127], v[220:223], v[228:231], v[124:127]
    s_waitcnt lgkmcnt(2)
    v_mfma_f32_16x16x32_bf16 v[128:131], v[208:211], v[232:235], v[128:131]
    s_waitcnt vmcnt(0) lgkmcnt(0)
    s_barrier
    ds_read_b128 v[192:195], v240 offset:16384
    ds_read_b64_tr_b16 v[224:225], v242 offset:0
    v_mfma_f32_16x16x32_bf16 v[132:135], v[212:215], v[232:235], v[132:135]
    ds_read_b128 v[196:199], v240 offset:18432
    ds_read_b64_tr_b16 v[226:227], v242 offset:1024
    s_mov_b32 s41, s42
    s_mov_b32 s42, s25
    v_mfma_f32_16x16x32_bf16 v[136:139], v[216:219], v[232:235], v[136:139]
    ds_read_b128 v[200:203], v240 offset:20480
    v_mfma_f32_16x16x32_bf16 v[140:143], v[220:223], v[232:235], v[140:143]
    s_waitcnt lgkmcnt(5)
    ds_read_b128 v[204:207], v240 offset:22528
    v_mfma_f32_16x16x32_bf16 v[144:147], v[208:211], v[236:239], v[144:147]
    ds_read_b64_tr_b16 v[228:229], v243 offset:0
    v_mfma_f32_16x16x32_bf16 v[148:151], v[212:215], v[236:239], v[148:151]
    ds_read_b64_tr_b16 v[230:231], v243 offset:1024
    v_mfma_f32_16x16x32_bf16 v[152:155], v[216:219], v[236:239], v[152:155]
    v_mfma_f32_16x16x32_bf16 v[156:159], v[220:223], v[236:239], v[156:159]
    s_waitcnt lgkmcnt(2)
    s_sub_u32 s46, s46, 1
    s_cbranch_scc0 a_G_V_T
    s_lshl_b32 s50, s16, 20
    s_lshl_b32 s25, s17, 17
    s_add_u32 s50, s50, s25
    s_lshl_b32 s25, s30, 15
    s_add_u32 s50, s50, s25
    v_lshlrev_b32 v26, 7, v15
    s_lshl_b32 s52, s2, 13
    s_add_u32 s51, s50, 8192
    v_cvt_pk_bf16_f32 v160, v32, v33
    v_cvt_pk_bf16_f32 v161, v34, v35
    v_cvt_pk_bf16_f32 v162, v36, v37
    v_cvt_pk_bf16_f32 v163, v38, v39
    buffer_store_dwordx4 v[160:163], v1, s[12:15], s51 offen offset:0 sc1
    v_cvt_pk_bf16_f32 v164, v48, v49
    v_cvt_pk_bf16_f32 v165, v50, v51
    v_cvt_pk_bf16_f32 v166, v52, v53
    v_cvt_pk_bf16_f32 v167, v54, v55
    buffer_store_dwordx4 v[164:167], v1, s[12:15], s51 offen offset:1024 sc1
    v_cvt_pk_bf16_f32 v168, v64, v65
    v_cvt_pk_bf16_f32 v169, v66, v67
    v_cvt_pk_bf16_f32 v170, v68, v69
    v_cvt_pk_bf16_f32 v171, v70, v71
    buffer_store_dwordx4 v[168:171], v1, s[12:15], s51 offen offset:2048 sc1
    s_cmp_eq_u32 s18, 5
    s_cbranch_scc0 a_G_NOPF7
    s_mov_b32 s8, s74
    s_mov_b32 s9, s75
    s_mov_b32 s10, 2097152
    s_mov_b32 s11, 0x20000
    s_add_u32 s26, s52, 0
    buffer_load_dword v253, v26, s[8:11], s26 offen
a_G_NOPF7:
    s_barrier
    v_cvt_pk_bf16_f32 v172, v80, v81
    v_cvt_pk_bf16_f32 v173, v82, v83
    v_cvt_pk_bf16_f32 v174, v84, v85
    v_cvt_pk_bf16_f32 v175, v86, v87
    buffer_store_dwordx4 v[172:175], v1, s[12:15], s51 offen offset:3072 sc1
    s_add_u32 s51, s50, 12288
    v_cvt_pk_bf16_f32 v160, v96, v97
    v_cvt_pk_bf16_f32 v161, v98, v99
    v_cvt_pk_bf16_f32 v162, v100, v101
    v_cvt_pk_bf16_f32 v163, v102, v103
    buffer_store_dwordx4 v[160:163], v1, s[12:15], s51 offen offset:0 sc1
    v_cvt_pk_bf16_f32 v164, v112, v113
    v_cvt_pk_bf16_f32 v165, v114, v115
    v_cvt_pk_bf16_f32 v166, v116, v117
    v_cvt_pk_bf16_f32 v167, v118, v119
    buffer_store_dwordx4 v[164:167], v1, s[12:15], s51 offen offset:1024 sc1
    s_cmp_eq_u32 s18, 5
    s_cbranch_scc0 a_G_NOPF8
    s_mov_b32 s8, s76
    s_mov_b32 s9, s77
    s_mov_b32 s10, 1572864
    s_mov_b32 s11, 0x20000
    s_add_u32 s26, s52, 0
    buffer_load_dword v253, v26, s[8:11], s26 offen
a_G_NOPF8:
    s_barrier
    v_cvt_pk_bf16_f32 v168, v128, v129
    v_cvt_pk_bf16_f32 v169, v130, v131
    v_cvt_pk_bf16_f32 v170, v132, v133
    v_cvt_pk_bf16_f32 v171, v134, v135
    buffer_store_dwordx4 v[168:171], v1, s[12:15], s51 offen offset:2048 sc1
    v_cvt_pk_bf16_f32 v172, v144, v145
    v_cvt_pk_bf16_f32 v173, v146, v147
    v_cvt_pk_bf16_f32 v174, v148, v149
    v_cvt_pk_bf16_f32 v175, v150, v151
    buffer_store_dwordx4 v[172:175], v1, s[12:15], s51 offen offset:3072 sc1
    s_add_u32 s51, s50, 24576
    v_cvt_pk_bf16_f32 v160, v40, v41
    v_cvt_pk_bf16_f32 v161, v42, v43
    v_cvt_pk_bf16_f32 v162, v44, v45
    v_cvt_pk_bf16_f32 v163, v46, v47
    buffer_store_dwordx4 v[160:163], v1, s[12:15], s51 offen offset:0 sc1
    s_cmp_eq_u32 s18, 5
    s_cbranch_scc0 a_G_NOPF9
    s_mov_b32 s8, s82
    s_mov_b32 s9, s83
    s_mov_b32 s10, 4194304
    s_mov_b32 s11, 0x20000
    s_add_u32 s26, s52, 0
    buffer_load_dword v253, v26, s[8:11], s26 offen
a_G_NOPF9:
    s_barrier
    v_cvt_pk_bf16_f32 v164, v56, v57
    v_cvt_pk_bf16_f32 v165, v58, v59
    v_cvt_pk_bf16_f32 v166, v60, v61
    v_cvt_pk_bf16_f32 v167, v62, v63
    buffer_store_dwordx4 v[164:167], v1, s[12:15], s51 offen offset:1024 sc1
    v_cvt_pk_bf16_f32 v168, v72, v73
    v_cvt_pk_bf16_f32 v169, v74, v75
    v_cvt_pk_bf16_f32 v170, v76, v77
    v_cvt_pk_bf16_f32 v171, v78, v79
    buffer_store_dwordx4 v[168:171], v1, s[12:15], s51 offen offset:2048 sc1
    v_cvt_pk_bf16_f32 v172, v88, v89
    v_cvt_pk_bf16_f32 v173, v90, v91
    v_cvt_pk_bf16_f32 v174, v92, v93
    v_cvt_pk_bf16_f32 v175, v94, v95
    buffer_store_dwordx4 v[172:175], v1, s[12:15], s51 offen offset:3072 sc1
    s_cmp_eq_u32 s18, 5
    s_cbranch_scc0 a_G_NOPF10
    s_mov_b32 s8, s82
    s_mov_b32 s9, s83
    s_mov_b32 s10, 4194304
    s_mov_b32 s11, 0x20000
    s_add_u32 s26, s52, 2097152
    buffer_load_dword v253, v26, s[8:11], s26 offen
a_G_NOPF10:
    s_barrier
    s_add_u32 s51, s50, 28672
    v_cvt_pk_bf16_f32 v160, v104, v105
    v_cvt_pk_bf16_f32 v161, v106, v107
    v_cvt_pk_bf16_f32 v162, v108, v109
    v_cvt_pk_bf16_f32 v163, v110, v111
    buffer_store_dwordx4 v[160:163], v1, s[12:15], s51 offen offset:0 sc1
    v_cvt_pk_bf16_f32 v164, v120, v121
    v_cvt_pk_bf16_f32 v165, v122, v123
    v_cvt_pk_bf16_f32 v166, v124, v125
    v_cvt_pk_bf16_f32 v167, v126, v127
    buffer_store_dwordx4 v[164:167], v1, s[12:15], s51 offen offset:1024 sc1
    s_cmp_eq_u32 s18, 5
    s_cbranch_scc0 a_G_NOPF11
    s_mov_b32 s8, s84
    s_mov_b32 s9, s85
    s_mov_b32 s10, 524288
    s_mov_b32 s11, 0x20000
    s_add_u32 s26, s52, 0
    buffer_load_dword v253, v26, s[8:11], s26 offen
a_G_NOPF11:
    s_barrier
    v_cvt_pk_bf16_f32 v168, v136, v137
    v_cvt_pk_bf16_f32 v169, v138, v139
    v_cvt_pk_bf16_f32 v170, v140, v141
    v_cvt_pk_bf16_f32 v171, v142, v143
    buffer_store_dwordx4 v[168:171], v1, s[12:15], s51 offen offset:2048 sc1
    v_cvt_pk_bf16_f32 v172, v152, v153
    v_cvt_pk_bf16_f32 v173, v154, v155
    v_cvt_pk_bf16_f32 v174, v156, v157
    v_cvt_pk_bf16_f32 v175, v158, v159
    buffer_store_dwordx4 v[172:175], v1, s[12:15], s51 offen offset:3072 sc1
    s_mov_b32 s8, s74
    s_mov_b32 s9, s75
    s_mov_b32 s10, 2097152
    s_mov_b32 s11, 0x20000
    s_mov_b32 s36, s76
    s_mov_b32 s37, s77
    s_mov_b32 s38, 1572864
    s_mov_b32 s39, 0x20000
    s_lshl_b32 s25, s30, 14
    v_lshrrev_b32 v7, 3, v15
    v_lshlrev_b32 v7, 10, v7
    v_add_u32 v7, s25, v7
    v_and_b32 v9, 7, v15
    v_xor_b32 v9, v6, v9
    v_lshlrev_b32 v10, 4, v9
    v_add_u32 v16, v7, v10
    v_xor_b32 v10, 64, v10
    v_add_u32 v17, v7, v10
    v_add_u32 v17, 7168, v17
    s_mul_i32 s25, s30, 49152
    v_lshrrev_b32 v7, 3, v15
    v_mul_u32_u24 v7, 3072, v7
    v_add_u32 v7, s25, v7
    v_and_b32 v9, 1, v6
    v_lshlrev_b32 v9, 1, v9
    v_and_b32 v10, 7, v15
    v_xor_b32 v9, v9, v10
    v_lshlrev_b32 v9, 4, v9
    v_xor_b32 v10, 64, v9
    v_add_u32 v20, v7, v9
    v_add_u32 v21, v7, v10
    v_add_u32 v21, 23552, v21
    v_add_u32 v22, v7, v9
    v_add_u32 v23, v7, v10
    v_add_u32 v22, 1024, v22
    v_add_u32 v23, 24576, v23
    v_add_u32 v24, v7, v9
    v_add_u32 v25, v7, v10
    v_add_u32 v24, 2048, v24
    v_add_u32 v25, 25600, v25
    s_lshl_b32 s44, s16, 16
    s_lshl_b32 s45, s17, 7
    s_lshl_b32 s47, s30, 11
    s_add_u32 s47, s47, 24576
    s_lshl_b32 s48, s30, 11
    v_and_b32 v7, 15, v15
    v_lshrrev_b32 v9, 1, v7
    v_xor_b32 v9, v6, v9
    v_lshlrev_b32 v9, 4, v9
    v_lshl_add_u32 v240, v7, 7, v9
    v_add_u32 v240, 16384, v240
    v_xor_b32 v241, 64, v240
    v_lshrrev_b32 v9, 2, v7
    v_lshl_add_u32 v10, v6, 3, v9
    v_lshlrev_b32 v10, 7, v10
    v_and_b32 v160, 3, v7
    v_lshl_add_u32 v10, v160, 3, v10
    v_lshrrev_b32 v9, 3, v7
    v_and_b32 v160, 1, v6
    v_lshl_add_u32 v9, v160, 1, v9
    v_xor_b32 v9, s30, v9
    v_lshl_add_u32 v242, v9, 5, v10
    v_add_u32 v242, 16384, v242
    s_mov_b32 s40, 49152
    s_mov_b32 s41, 49152
    s_mov_b32 s42, 4294868992
    v_mov_b64 v[32:33], 0
    v_mov_b64 v[34:35], 0
    v_mov_b64 v[36:37], 0
    v_mov_b64 v[38:39], 0
    v_mov_b64 v[40:41], 0
    v_mov_b64 v[42:43], 0
    v_mov_b64 v[44:45], 0
    v_mov_b64 v[46:47], 0
    v_mov_b64 v[48:49], 0
    v_mov_b64 v[50:51], 0
    v_mov_b64 v[52:53], 0
    v_mov_b64 v[54:55], 0
    v_mov_b64 v[56:57], 0
    v_mov_b64 v[58:59], 0
    v_mov_b64 v[60:61], 0
    v_mov_b64 v[62:63], 0
    v_mov_b64 v[64:65], 0
    v_mov_b64 v[66:67], 0
    v_mov_b64 v[68:69], 0
    v_mov_b64 v[70:71], 0
    v_mov_b64 v[72:73], 0
    v_mov_b64 v[74:75], 0
    v_mov_b64 v[76:77], 0
    v_mov_b64 v[78:79], 0
    s_load_dwordx2 s[64:65], s[0:1], 80
    s_waitcnt lgkmcnt(0)
    s_mov_b32 s66, 256
    s_mov_b32 s67, 0x20000
    v_mov_b32 v31, 0
    buffer_load_dword v30, v31, s[64:67], 0 offen sc1
    s_barrier
    s_mov_b32 s43, 16384
    s_add_u32 m0, s43, s47
    s_nop 0
    buffer_load_dwordx4 v16, s[8:11], s44 offen offset:0 lds
    buffer_load_dwordx4 v17, s[8:11], s44 offen offset:1024 lds
    s_add_u32 m0, s43, s48
    s_nop 0
    buffer_load_dwordx4 v20, s[36:39], s45 offen offset:0 lds
    buffer_load_dwordx4 v21, s[36:39], s45 offen offset:1024 lds
    s_add_u32 m0, m0, 8192
    s_nop 0
    buffer_load_dwordx4 v22, s[36:39], s45 offen offset:0 lds
    buffer_load_dwordx4 v23, s[36:39], s45 offen offset:1024 lds
    s_add_u32 m0, m0, 8192
    s_nop 0
    buffer_load_dwordx4 v24, s[36:39], s45 offen offset:0 lds
    buffer_load_dwordx4 v25, s[36:39], s45 offen offset:1024 lds
    s_add_u32 s44, s44, 128
    s_add_u32 s45, s45, 196608
    s_barrier
    s_mov_b32 s43, 65536
    s_add_u32 m0, s43, s47
    s_nop 0
    buffer_load_dwordx4 v16, s[8:11], s44 offen offset:0 lds
    buffer_load_dwordx4 v17, s[8:11], s44 offen offset:1024 lds
    s_add_u32 m0, s43, s48
    s_nop 0
    buffer_load_dwordx4 v20, s[36:39], s45 offen offset:0 lds
    buffer_load_dwordx4 v21, s[36:39], s45 offen offset:1024 lds
    s_add_u32 m0, m0, 8192
    s_nop 0
    buffer_load_dwordx4 v22, s[36:39], s45 offen offset:0 lds
    buffer_load_dwordx4 v23, s[36:39], s45 offen offset:1024 lds
    s_add_u32 m0, m0, 8192
    s_nop 0
    buffer_load_dwordx4 v24, s[36:39], s45 offen offset:0 lds
    buffer_load_dwordx4 v25, s[36:39], s45 offen offset:1024 lds
    s_add_u32 s44, s44, 128
    s_add_u32 s45, s45, 196608
    s_mov_b32 s43, 114688
    s_add_u32 m0, s43, s47
    s_waitcnt vmcnt(8)
    v_readfirstlane_b32 s63, v30
    s_nop 3
    s_barrier
    ds_read_b128 v[192:195], v240 offset:24576
    ds_read_b128 v[196:199], v240 offset:26624
    ds_read_b128 v[200:203], v240 offset:28672
    ds_read_b128 v[204:207], v240 offset:30720
    ds_read_b64_tr_b16 v[224:225], v242 offset:0
    ds_read_b64_tr_b16 v[226:227], v242 offset:512
    ds_read_b64_tr_b16 v[228:229], v242 offset:8192
    ds_read_b64_tr_b16 v[230:231], v242 offset:8704
    s_waitcnt lgkmcnt(2)
    s_mov_b32 s46, 2
a_G_A_L:
    v_mfma_f32_16x16x32_bf16 v[32:35], v[224:227], v[192:195], v[32:35]
    ds_read_b64_tr_b16 v[232:233], v242 offset:16384
    v_mfma_f32_16x16x32_bf16 v[36:39], v[224:227], v[196:199], v[36:39]
    ds_read_b64_tr_b16 v[234:235], v242 offset:16896
    v_mfma_f32_16x16x32_bf16 v[40:43], v[224:227], v[200:203], v[40:43]
    ds_read_b64_tr_b16 v[236:237], v242 offset:4096
    ds_read_b128 v[208:211], v241 offset:24576
    ds_read_b128 v[212:215], v241 offset:26624
    buffer_load_dwordx4 v16, s[8:11], s44 offen offset:0 lds
    buffer_load_dwordx4 v17, s[8:11], s44 offen offset:1024 lds
    s_add_u32 m0, s43, s48
    v_mfma_f32_16x16x32_bf16 v[44:47], v[224:227], v[204:207], v[44:47]
    s_waitcnt lgkmcnt(5)
    ds_read_b64_tr_b16 v[238:239], v242 offset:4608
    v_mfma_f32_16x16x32_bf16 v[48:51], v[228:231], v[192:195], v[48:51]
    ds_read_b64_tr_b16 v[224:225], v242 offset:12288
    v_mfma_f32_16x16x32_bf16 v[52:55], v[228:231], v[196:199], v[52:55]
    ds_read_b64_tr_b16 v[226:227], v242 offset:12800
    v_mfma_f32_16x16x32_bf16 v[56:59], v[228:231], v[200:203], v[56:59]
    ds_read_b128 v[216:219], v241 offset:28672
    ds_read_b128 v[220:223], v241 offset:30720
    buffer_load_dwordx4 v20, s[36:39], s45 offen offset:0 lds
    buffer_load_dwordx4 v21, s[36:39], s45 offen offset:1024 lds
    s_add_u32 m0, m0, 8192
    v_mfma_f32_16x16x32_bf16 v[60:63], v[228:231], v[204:207], v[60:63]
    s_waitcnt lgkmcnt(8)
    v_add_u32 v240, s40, v240
    v_mfma_f32_16x16x32_bf16 v[64:67], v[192:195], v[232:235], v[64:67]
    ds_read_b64_tr_b16 v[228:229], v242 offset:20480
    v_mfma_f32_16x16x32_bf16 v[68:71], v[196:199], v[232:235], v[68:71]
    ds_read_b64_tr_b16 v[230:231], v242 offset:20992
    v_mfma_f32_16x16x32_bf16 v[72:75], v[200:203], v[232:235], v[72:75]
    buffer_load_dwordx4 v22, s[36:39], s45 offen offset:0 lds
    buffer_load_dwordx4 v23, s[36:39], s45 offen offset:1024 lds
    s_add_u32 m0, m0, 8192
    v_mfma_f32_16x16x32_bf16 v[76:79], v[204:207], v[232:235], v[76:79]
    s_waitcnt lgkmcnt(2)
    v_add_u32 v242, s40, v242
    v_add_u32 v241, s40, v241
    v_mfma_f32_16x16x32_bf16 v[32:35], v[236:239], v[208:211], v[32:35]
    v_mfma_f32_16x16x32_bf16 v[36:39], v[236:239], v[212:215], v[36:39]
    v_mfma_f32_16x16x32_bf16 v[40:43], v[236:239], v[216:219], v[40:43]
    buffer_load_dwordx4 v24, s[36:39], s45 offen offset:0 lds
    buffer_load_dwordx4 v25, s[36:39], s45 offen offset:1024 lds
    v_mfma_f32_16x16x32_bf16 v[44:47], v[236:239], v[220:223], v[44:47]
    s_waitcnt lgkmcnt(2)
    s_add_u32 s44, s44, 128
    s_add_u32 s45, s45, 196608
    s_add_u32 s43, s43, s42
    v_mfma_f32_16x16x32_bf16 v[48:51], v[224:227], v[208:211], v[48:51]
    s_waitcnt vmcnt(8) lgkmcnt(0)
    s_barrier
    ds_read_b128 v[192:195], v240 offset:24576
    ds_read_b64_tr_b16 v[232:233], v242 offset:0
    v_mfma_f32_16x16x32_bf16 v[52:55], v[224:227], v[212:215], v[52:55]
    ds_read_b128 v[196:199], v240 offset:26624
    ds_read_b64_tr_b16 v[234:235], v242 offset:512
    s_mov_b32 s25, s40
    s_mov_b32 s40, s41
    s_mov_b32 s41, s42
    v_mfma_f32_16x16x32_bf16 v[56:59], v[224:227], v[216:219], v[56:59]
    ds_read_b128 v[200:203], v240 offset:28672
    v_mfma_f32_16x16x32_bf16 v[60:63], v[224:227], v[220:223], v[60:63]
    s_waitcnt lgkmcnt(5)
    ds_read_b128 v[204:207], v240 offset:30720
    v_mfma_f32_16x16x32_bf16 v[64:67], v[208:211], v[228:231], v[64:67]
    ds_read_b64_tr_b16 v[236:237], v242 offset:8192
    v_mfma_f32_16x16x32_bf16 v[68:71], v[212:215], v[228:231], v[68:71]
    ds_read_b64_tr_b16 v[238:239], v242 offset:8704
    s_mov_b32 s42, s25
    s_add_u32 m0, s43, s47
    v_mfma_f32_16x16x32_bf16 v[72:75], v[216:219], v[228:231], v[72:75]
    v_mfma_f32_16x16x32_bf16 v[76:79], v[220:223], v[228:231], v[76:79]
    s_waitcnt lgkmcnt(2)
    v_mfma_f32_16x16x32_bf16 v[32:35], v[232:235], v[192:195], v[32:35]
    ds_read_b64_tr_b16 v[224:225], v242 offset:16384
    v_mfma_f32_16x16x32_bf16 v[36:39], v[232:235], v[196:199], v[36:39]
    ds_read_b64_tr_b16 v[226:227], v242 offset:16896
    v_mfma_f32_16x16x32_bf16 v[40:43], v[232:235], v[200:203], v[40:43]
    ds_read_b64_tr_b16 v[228:229], v242 offset:4096
    ds_read_b128 v[208:211], v241 offset:24576
    ds_read_b128 v[212:215], v241 offset:26624
    buffer_load_dwordx4 v16, s[8:11], s44 offen offset:0 lds
    buffer_load_dwordx4 v17, s[8:11], s44 offen offset:1024 lds
    s_add_u32 m0, s43, s48
    v_mfma_f32_16x16x32_bf16 v[44:47], v[232:235], v[204:207], v[44:47]
    s_waitcnt lgkmcnt(5)
    ds_read_b64_tr_b16 v[230:231], v242 offset:4608
    v_mfma_f32_16x16x32_bf16 v[48:51], v[236:239], v[192:195], v[48:51]
    ds_read_b64_tr_b16 v[232:233], v242 offset:12288
    v_mfma_f32_16x16x32_bf16 v[52:55], v[236:239], v[196:199], v[52:55]
    ds_read_b64_tr_b16 v[234:235], v242 offset:12800
    v_mfma_f32_16x16x32_bf16 v[56:59], v[236:239], v[200:203], v[56:59]
    ds_read_b128 v[216:219], v241 offset:28672
    ds_read_b128 v[220:223], v241 offset:30720
    buffer_load_dwordx4 v20, s[36:39], s45 offen offset:0 lds
    buffer_load_dwordx4 v21, s[36:39], s45 offen offset:1024 lds
    s_add_u32 m0, m0, 8192
    v_mfma_f32_16x16x32_bf16 v[60:63], v[236:239], v[204:207], v[60:63]
    s_waitcnt lgkmcnt(8)
    v_add_u32 v240, s40, v240
    v_mfma_f32_16x16x32_bf16 v[64:67], v[192:195], v[224:227], v[64:67]
    ds_read_b64_tr_b16 v[236:237], v242 offset:20480
    v_mfma_f32_16x16x32_bf16 v[68:71], v[196:199], v[224:227], v[68:71]
    ds_read_b64_tr_b16 v[238:239], v242 offset:20992
    v_mfma_f32_16x16x32_bf16 v[72:75], v[200:203], v[224:227], v[72:75]
    buffer_load_dwordx4 v22, s[36:39], s45 offen offset:0 lds
    buffer_load_dwordx4 v23, s[36:39], s45 offen offset:1024 lds
    s_add_u32 m0, m0, 8192
    v_mfma_f32_16x16x32_bf16 v[76:79], v[204:207], v[224:227], v[76:79]
    s_waitcnt lgkmcnt(2)
    v_add_u32 v242, s40, v242
    v_add_u32 v241, s40, v241
    v_mfma_f32_16x16x32_bf16 v[32:35], v[228:231], v[208:211], v[32:35]
    v_mfma_f32_16x16x32_bf16 v[36:39], v[228:231], v[212:215], v[36:39]
    v_mfma_f32_16x16x32_bf16 v[40:43], v[228:231], v[216:219], v[40:43]
    buffer_load_dwordx4 v24, s[36:39], s45 offen offset:0 lds
    buffer_load_dwordx4 v25, s[36:39], s45 offen offset:1024 lds
    v_mfma_f32_16x16x32_bf16 v[44:47], v[228:231], v[220:223], v[44:47]
    s_waitcnt lgkmcnt(2)
    s_add_u32 s44, s44, 128
    s_add_u32 s45, s45, 196608
    s_add_u32 s43, s43, s42
    v_mfma_f32_16x16x32_bf16 v[48:51], v[232:235], v[208:211], v[48:51]
    s_waitcnt vmcnt(8) lgkmcnt(0)
    s_barrier
    ds_read_b128 v[192:195], v240 offset:24576
    ds_read_b64_tr_b16 v[224:225], v242 offset:0
    v_mfma_f32_16x16x32_bf16 v[52:55], v[232:235], v[212:215], v[52:55]
    ds_read_b128 v[196:199], v240 offset:26624
    ds_read_b64_tr_b16 v[226:227], v242 offset:512
    s_mov_b32 s25, s40
    s_mov_b32 s40, s41
    s_mov_b32 s41, s42
    v_mfma_f32_16x16x32_bf16 v[56:59], v[232:235], v[216:219], v[56:59]
    ds_read_b128 v[200:203], v240 offset:28672
    v_mfma_f32_16x16x32_bf16 v[60:63], v[232:235], v[220:223], v[60:63]
    s_waitcnt lgkmcnt(5)
    ds_read_b128 v[204:207], v240 offset:30720
    v_mfma_f32_16x16x32_bf16 v[64:67], v[208:211], v[236:239], v[64:67]
    ds_read_b64_tr_b16 v[228:229], v242 offset:8192
    v_mfma_f32_16x16x32_bf16 v[68:71], v[212:215], v[236:239], v[68:71]
    ds_read_b64_tr_b16 v[230:231], v242 offset:8704
    s_mov_b32 s42, s25
    s_add_u32 m0, s43, s47
    v_mfma_f32_16x16x32_bf16 v[72:75], v[216:219], v[236:239], v[72:75]
    v_mfma_f32_16x16x32_bf16 v[76:79], v[220:223], v[236:239], v[76:79]
    s_waitcnt lgkmcnt(2)
    s_sub_u32 s46, s46, 1
    s_cbranch_scc0 a_G_A_L
    s_mov_b32 s46, 0
a_G_A_T:
    v_mfma_f32_16x16x32_bf16 v[32:35], v[224:227], v[192:195], v[32:35]
    ds_read_b64_tr_b16 v[232:233], v242 offset:16384
    v_mfma_f32_16x16x32_bf16 v[36:39], v[224:227], v[196:199], v[36:39]
    ds_read_b64_tr_b16 v[234:235], v242 offset:16896
    v_mfma_f32_16x16x32_bf16 v[40:43], v[224:227], v[200:203], v[40:43]
    ds_read_b64_tr_b16 v[236:237], v242 offset:4096
    ds_read_b128 v[208:211], v241 offset:24576
    ds_read_b128 v[212:215], v241 offset:26624
    v_mfma_f32_16x16x32_bf16 v[44:47], v[224:227], v[204:207], v[44:47]
    s_waitcnt lgkmcnt(5)
    ds_read_b64_tr_b16 v[238:239], v242 offset:4608
    v_mfma_f32_16x16x32_bf16 v[48:51], v[228:231], v[192:195], v[48:51]
    ds_read_b64_tr_b16 v[224:225], v242 offset:12288
    v_mfma_f32_16x16x32_bf16 v[52:55], v[228:231], v[196:199], v[52:55]
    ds_read_b64_tr_b16 v[226:227], v242 offset:12800
    v_mfma_f32_16x16x32_bf16 v[56:59], v[228:231], v[200:203], v[56:59]
    ds_read_b128 v[216:219], v241 offset:28672
    ds_read_b128 v[220:223], v241 offset:30720
    v_mfma_f32_16x16x32_bf16 v[60:63], v[228:231], v[204:207], v[60:63]
    s_waitcnt lgkmcnt(8)
    v_add_u32 v240, s40, v240
    v_mfma_f32_16x16x32_bf16 v[64:67], v[192:195], v[232:235], v[64:67]
    ds_read_b64_tr_b16 v[228:229], v242 offset:20480
    v_mfma_f32_16x16x32_bf16 v[68:71], v[196:199], v[232:235], v[68:71]
    ds_read_b64_tr_b16 v[230:231], v242 offset:20992
    v_mfma_f32_16x16x32_bf16 v[72:75], v[200:203], v[232:235], v[72:75]
    v_mfma_f32_16x16x32_bf16 v[76:79], v[204:207], v[232:235], v[76:79]
    s_waitcnt lgkmcnt(2)
    v_add_u32 v242, s40, v242
    v_add_u32 v241, s40, v241
    v_mfma_f32_16x16x32_bf16 v[32:35], v[236:239], v[208:211], v[32:35]
    v_mfma_f32_16x16x32_bf16 v[36:39], v[236:239], v[212:215], v[36:39]
    s_mov_b32 s25, s40
    s_mov_b32 s40, s41
    v_mfma_f32_16x16x32_bf16 v[40:43], v[236:239], v[216:219], v[40:43]
    v_mfma_f32_16x16x32_bf16 v[44:47], v[236:239], v[220:223], v[44:47]
    s_waitcnt lgkmcnt(2)
    v_mfma_f32_16x16x32_bf16 v[48:51], v[224:227], v[208:211], v[48:51]
    s_waitcnt vmcnt(0) lgkmcnt(0)
    s_barrier
    ds_read_b128 v[192:195], v240 offset:24576
    ds_read_b64_tr_b16 v[232:233], v242 offset:0
    v_mfma_f32_16x16x32_bf16 v[52:55], v[224:227], v[212:215], v[52:55]
    ds_read_b128 v[196:199], v240 offset:26624
    ds_read_b64_tr_b16 v[234:235], v242 offset:512
    s_mov_b32 s41, s42
    s_mov_b32 s42, s25
    v_mfma_f32_16x16x32_bf16 v[56:59], v[224:227], v[216:219], v[56:59]
    ds_read_b128 v[200:203], v240 offset:28672
    v_mfma_f32_16x16x32_bf16 v[60:63], v[224:227], v[220:223], v[60:63]
    s_waitcnt lgkmcnt(5)
    ds_read_b128 v[204:207], v240 offset:30720
    v_mfma_f32_16x16x32_bf16 v[64:67], v[208:211], v[228:231], v[64:67]
    ds_read_b64_tr_b16 v[236:237], v242 offset:8192
    v_mfma_f32_16x16x32_bf16 v[68:71], v[212:215], v[228:231], v[68:71]
    ds_read_b64_tr_b16 v[238:239], v242 offset:8704
    v_mfma_f32_16x16x32_bf16 v[72:75], v[216:219], v[228:231], v[72:75]
    v_mfma_f32_16x16x32_bf16 v[76:79], v[220:223], v[228:231], v[76:79]
    s_waitcnt lgkmcnt(2)
    v_mfma_f32_16x16x32_bf16 v[32:35], v[232:235], v[192:195], v[32:35]
    ds_read_b64_tr_b16 v[224:225], v242 offset:16384
    v_mfma_f32_16x16x32_bf16 v[36:39], v[232:235], v[196:199], v[36:39]
    ds_read_b64_tr_b16 v[226:227], v242 offset:16896
    v_mfma_f32_16x16x32_bf16 v[40:43], v[232:235], v[200:203], v[40:43]
    ds_read_b64_tr_b16 v[228:229], v242 offset:4096
    ds_read_b128 v[208:211], v241 offset:24576
    ds_read_b128 v[212:215], v241 offset:26624
    v_mfma_f32_16x16x32_bf16 v[44:47], v[232:235], v[204:207], v[44:47]
    s_waitcnt lgkmcnt(5)
    ds_read_b64_tr_b16 v[230:231], v242 offset:4608
    v_mfma_f32_16x16x32_bf16 v[48:51], v[236:239], v[192:195], v[48:51]
    ds_read_b64_tr_b16 v[232:233], v242 offset:12288
    v_mfma_f32_16x16x32_bf16 v[52:55], v[236:239], v[196:199], v[52:55]
    ds_read_b64_tr_b16 v[234:235], v242 offset:12800
    v_mfma_f32_16x16x32_bf16 v[56:59], v[236:239], v[200:203], v[56:59]
    ds_read_b128 v[216:219], v241 offset:28672
    ds_read_b128 v[220:223], v241 offset:30720
    v_mfma_f32_16x16x32_bf16 v[60:63], v[236:239], v[204:207], v[60:63]
    s_waitcnt lgkmcnt(8)
    v_add_u32 v240, s40, v240
    v_mfma_f32_16x16x32_bf16 v[64:67], v[192:195], v[224:227], v[64:67]
    ds_read_b64_tr_b16 v[236:237], v242 offset:20480
    v_mfma_f32_16x16x32_bf16 v[68:71], v[196:199], v[224:227], v[68:71]
    ds_read_b64_tr_b16 v[238:239], v242 offset:20992
    v_mfma_f32_16x16x32_bf16 v[72:75], v[200:203], v[224:227], v[72:75]
    v_mfma_f32_16x16x32_bf16 v[76:79], v[204:207], v[224:227], v[76:79]
    s_waitcnt lgkmcnt(2)
    v_add_u32 v242, s40, v242
    v_add_u32 v241, s40, v241
    v_mfma_f32_16x16x32_bf16 v[32:35], v[228:231], v[208:211], v[32:35]
    v_mfma_f32_16x16x32_bf16 v[36:39], v[228:231], v[212:215], v[36:39]
    s_mov_b32 s25, s40
    s_mov_b32 s40, s41
    v_mfma_f32_16x16x32_bf16 v[40:43], v[228:231], v[216:219], v[40:43]
    v_mfma_f32_16x16x32_bf16 v[44:47], v[228:231], v[220:223], v[44:47]
    s_waitcnt lgkmcnt(2)
    v_mfma_f32_16x16x32_bf16 v[48:51], v[232:235], v[208:211], v[48:51]
    s_waitcnt vmcnt(0) lgkmcnt(0)
    s_barrier
    ds_read_b128 v[192:195], v240 offset:24576
    ds_read_b64_tr_b16 v[224:225], v242 offset:0
    v_mfma_f32_16x16x32_bf16 v[52:55], v[232:235], v[212:215], v[52:55]
    ds_read_b128 v[196:199], v240 offset:26624
    ds_read_b64_tr_b16 v[226:227], v242 offset:512
    s_mov_b32 s41, s42
    s_mov_b32 s42, s25
    v_mfma_f32_16x16x32_bf16 v[56:59], v[232:235], v[216:219], v[56:59]
    ds_read_b128 v[200:203], v240 offset:28672
    v_mfma_f32_16x16x32_bf16 v[60:63], v[232:235], v[220:223], v[60:63]
    s_waitcnt lgkmcnt(5)
    ds_read_b128 v[204:207], v240 offset:30720
    v_mfma_f32_16x16x32_bf16 v[64:67], v[208:211], v[236:239], v[64:67]
    ds_read_b64_tr_b16 v[228:229], v242 offset:8192
    v_mfma_f32_16x16x32_bf16 v[68:71], v[212:215], v[236:239], v[68:71]
    ds_read_b64_tr_b16 v[230:231], v242 offset:8704
    v_mfma_f32_16x16x32_bf16 v[72:75], v[216:219], v[236:239], v[72:75]
    v_mfma_f32_16x16x32_bf16 v[76:79], v[220:223], v[236:239], v[76:79]
    s_waitcnt lgkmcnt(2)
    s_sub_u32 s46, s46, 1
    s_cbranch_scc0 a_G_A_T
    s_load_dwordx2 s[34:35], s[0:1], 88
    s_lshl_b32 s25, s30, 13
    v_add_u32 v11, s25, v1
    v_add_u32 v12, 4096, v11
    s_lshl_b32 s23, s30, 13
    s_mov_b32 s22, 0
    s_lshl_b32 s26, s16, 20
    s_waitcnt lgkmcnt(0)
    s_add_u32 s4, s34, s26
    s_addc_u32 s5, s35, 0
    s_mov_b32 s6, 1048576
    s_mov_b32 s7, 0x20000
    s_add_u32 s22, s22, 65536
    s_add_u32 s23, s23, 65536
    s_lshl_b32 s25, s17, 2
    s_add_u32 s25, s25, s30
    s_lshl_b32 s26, s25, 6
    s_lshl_b32 s50, s16, 1
    s_add_u32 s26, s26, s50
    s_lshl_b32 s51, s26, 10
    s_add_u32 s51, s51, 67108864
    s_mul_i32 s52, s26, 3072
    s_add_u32 s52, s52, 69206016
    v_and_b32 v7, 15, v15
    v_lshlrev_b32 v7, 4, v7
    v_lshrrev_b32 v9, 1, v6
    v_and_b32 v10, 1, v6
    v_lshl_add_u32 v26, v9, 9, v7
    v_lshl_add_u32 v26, v10, 3, v26
    v_lshl_add_u32 v27, v10, 9, v7
    v_lshl_add_u32 v27, v9, 3, v27
    v_mov_b32 v28, 0x3f803f80
    v_mov_b32 v29, 0x3f803f80
    s_mov_b32 s25, 0x3eb8aa3b
    v_mul_f32 v32, s25, v32
    v_mul_f32 v33, s25, v33
    v_mul_f32 v34, s25, v34
    v_mul_f32 v35, s25, v35
    v_cvt_pk_bf16_f32 v192, v32, v33
    v_cvt_pk_bf16_f32 v193, v34, v35
    buffer_store_dwordx2 v[192:193], v26, s[12:15], s51 offen offset:0 sc1
    v_cvt_pk_bf16_f32 v194, v48, v49
    v_cvt_pk_bf16_f32 v195, v50, v51
    buffer_store_dwordx2 v[194:195], v26, s[12:15], s52 offen offset:0 sc1
    v_cvt_pk_bf16_f32 v196, v64, v65
    v_cvt_pk_bf16_f32 v197, v66, v67
    buffer_store_dwordx2 v[196:197], v27, s[12:15], s52 offen offset:1024 sc1
    buffer_store_dwordx2 v[28:29], v27, s[12:15], s52 offen offset:1280 sc1
    v_mul_f32 v36, s25, v36
    v_mul_f32 v37, s25, v37
    v_mul_f32 v38, s25, v38
    v_mul_f32 v39, s25, v39
    v_cvt_pk_bf16_f32 v200, v36, v37
    v_cvt_pk_bf16_f32 v201, v38, v39
    buffer_store_dwordx2 v[200:201], v26, s[12:15], s51 offen offset:256 sc1
    v_cvt_pk_bf16_f32 v202, v52, v53
    v_cvt_pk_bf16_f32 v203, v54, v55
    buffer_store_dwordx2 v[202:203], v26, s[12:15], s52 offen offset:256 sc1
    v_cvt_pk_bf16_f32 v204, v68, v69
    v_cvt_pk_bf16_f32 v205, v70, v71
    buffer_store_dwordx2 v[204:205], v27, s[12:15], s52 offen offset:2048 sc1
    buffer_store_dwordx2 v[28:29], v27, s[12:15], s52 offen offset:2304 sc1
    v_mul_f32 v40, s25, v40
    v_mul_f32 v41, s25, v41
    v_mul_f32 v42, s25, v42
    v_mul_f32 v43, s25, v43
    v_cvt_pk_bf16_f32 v192, v40, v41
    v_cvt_pk_bf16_f32 v193, v42, v43
    buffer_store_dwordx2 v[192:193], v26, s[12:15], s51 offen offset:1024 sc1
    v_cvt_pk_bf16_f32 v194, v56, v57
    v_cvt_pk_bf16_f32 v195, v58, v59
    s_add_u32 s52, s52, 3072
    buffer_store_dwordx2 v[194:195], v26, s[12:15], s52 offen offset:0 sc1
    v_cvt_pk_bf16_f32 v196, v72, v73
    v_cvt_pk_bf16_f32 v197, v74, v75
    buffer_store_dwordx2 v[196:197], v27, s[12:15], s52 offen offset:1024 sc1
    buffer_store_dwordx2 v[28:29], v27, s[12:15], s52 offen offset:1280 sc1
    v_mul_f32 v44, s25, v44
    v_mul_f32 v45, s25, v45
    v_mul_f32 v46, s25, v46
    v_mul_f32 v47, s25, v47
    v_cvt_pk_bf16_f32 v200, v44, v45
    v_cvt_pk_bf16_f32 v201, v46, v47
    buffer_store_dwordx2 v[200:201], v26, s[12:15], s51 offen offset:1280 sc1
    v_cvt_pk_bf16_f32 v202, v60, v61
    v_cvt_pk_bf16_f32 v203, v62, v63
    buffer_store_dwordx2 v[202:203], v26, s[12:15], s52 offen offset:256 sc1
    v_cvt_pk_bf16_f32 v204, v76, v77
    v_cvt_pk_bf16_f32 v205, v78, v79
    buffer_store_dwordx2 v[204:205], v27, s[12:15], s52 offen offset:2048 sc1
    buffer_store_dwordx2 v[28:29], v27, s[12:15], s52 offen offset:2304 sc1
    s_mov_b32 m0, s23
    s_nop 0
    buffer_load_dwordx4 v11, s[4:7], s22 offen offset:0 lds
    buffer_load_dwordx4 v11, s[4:7], s22 offen offset:1024 lds
    buffer_load_dwordx4 v11, s[4:7], s22 offen offset:2048 lds
    buffer_load_dwordx4 v11, s[4:7], s22 offen offset:3072 lds
    s_add_u32 m0, s23, 4096
    s_nop 0
    buffer_load_dwordx4 v12, s[4:7], s22 offen offset:0 lds
    buffer_load_dwordx4 v12, s[4:7], s22 offen offset:1024 lds
    buffer_load_dwordx4 v12, s[4:7], s22 offen offset:2048 lds
    buffer_load_dwordx4 v12, s[4:7], s22 offen offset:3072 lds
    s_add_u32 s22, s22, 32768
    s_add_u32 s23, s23, 32768
    s_and_b32 s23, s23, 131071
    s_branch K2_QJOIN
K2_ENTRY:
K2_QJOIN:
    s_sub_u32 s25, 16, s17
    s_lshl_b32 s25, s25, 1
    s_add_u32 s26, s17, 1
    s_lshl_b32 s26, s26, 1
    s_sub_u32 s28, s25, s26
    s_cmp_ge_u32 s18, 4
    s_cselect_b32 s20, s26, s25
    s_sub_u32 s25, 15, s17
    s_cmp_ge_u32 s18, 4
    s_cselect_b32 s19, s17, s25
    s_lshl_b32 s19, s19, 2
    s_add_u32 s19, s19, s30
    s_lshl_b32 s26, s16, 20
    s_add_u32 s4, s34, s26
    s_addc_u32 s5, s35, 0
    s_mov_b32 s6, 1048576
    s_mov_b32 s7, 0x20000
    s_add_u32 s12, s34, 50331648
    s_addc_u32 s13, s35, 0
    s_mov_b32 s14, 16777216
    s_mov_b32 s15, 0x20000
    v_and_b32 v7, 15, v15
    v_lshrrev_b32 v9, 4, v15
    v_lshlrev_b32 v9, 2, v9
    v_sub_u32 v6, v7, v9
    v_mov_b32 v13, 0xf149f2ca
    v_mov_b32 v14, 0
    v_mov_b32 v16, 0x3f803f80
    v_mov_b32 v17, 0x3f803f80
    v_mov_b32 v18, 0x3f803f80
    v_mov_b32 v19, 0x3f803f80
    s_mov_b32 s29, 0x53800000
    s_mov_b32 s49, 0
    v_mov_b32 v2, v1
    v_add_u32 v3, 32768, v1
    s_barrier
    s_cmp_ge_u32 s18, 4
    s_cbranch_scc0 b_QGOT
    s_and_b32 s26, s30, 1
    s_lshl_b32 s26, s26, 13
    s_cmp_ge_u32 s30, 2
    s_cselect_b32 s27, 49152, 0
    s_add_u32 s26, s26, s27
    s_add_u32 s26, s26, 98304
    v_add_u32 v7, s26, v1
    ds_read_b128 v[160:163], v7 offset:0
    ds_read_b128 v[164:167], v7 offset:1024
    ds_read_b128 v[168:171], v7 offset:2048
    ds_read_b128 v[172:175], v7 offset:3072
    ds_read_b128 v[176:179], v7 offset:4096
    ds_read_b128 v[180:183], v7 offset:5120
    ds_read_b128 v[184:187], v7 offset:6144
    ds_read_b128 v[188:191], v7 offset:7168
    s_waitcnt lgkmcnt(0)
b_QGOT:
    s_cmp_eq_u32 s19, 0
    s_cbranch_scc1 b_P0_TRI
    v_mov_b64 v[32:33], 0
    v_mov_b64 v[34:35], 0
    v_mov_b64 v[36:37], 0
    v_mov_b64 v[38:39], 0
    v_mov_b64 v[40:41], 0
    v_mov_b64 v[42:43], 0
    v_mov_b64 v[44:45], 0
    v_mov_b64 v[46:47], 0
b_P0_GO:
    ds_read_b128 v[64:67], v2 offset:0
    ds_read_b128 v[68:71], v2 offset:1024
    ds_read_b128 v[72:75], v2 offset:2048
    ds_read_b128 v[76:79], v2 offset:3072
    ds_read_b128 v[80:83], v2 offset:4096
    ds_read_b128 v[84:87], v2 offset:5120
    ds_read_b128 v[88:91], v2 offset:6144
    ds_read_b128 v[92:95], v2 offset:7168
    v_mov_b64 v[20:21], 0
    v_mov_b64 v[22:23], 0
    v_mov_b64 v[24:25], 0
    v_mov_b64 v[26:27], 0
    s_waitcnt lgkmcnt(7)
    v_mfma_f32_16x16x32_bf16 v[128:131], v[64:67], v[160:163], v[32:35]
    v_mfma_f32_16x16x32_bf16 v[132:135], v[64:67], v[176:179], v[36:39]
    s_waitcnt lgkmcnt(6)
    v_mfma_f32_16x16x32_bf16 v[128:131], v[68:71], v[164:167], v[128:131]
    v_mfma_f32_16x16x32_bf16 v[132:135], v[68:71], v[180:183], v[132:135]
    s_waitcnt lgkmcnt(5)
    v_mfma_f32_16x16x32_bf16 v[128:131], v[72:75], v[168:171], v[128:131]
    v_mfma_f32_16x16x32_bf16 v[132:135], v[72:75], v[184:187], v[132:135]
    s_waitcnt lgkmcnt(4)
    v_mfma_f32_16x16x32_bf16 v[128:131], v[76:79], v[172:175], v[128:131]
    v_mfma_f32_16x16x32_bf16 v[132:135], v[76:79], v[188:191], v[132:135]
    s_waitcnt lgkmcnt(3)
    v_mfma_f32_16x16x32_bf16 v[136:139], v[80:83], v[160:163], v[40:43]
    v_mfma_f32_16x16x32_bf16 v[140:143], v[80:83], v[176:179], v[44:47]
    s_waitcnt lgkmcnt(2)
    v_mfma_f32_16x16x32_bf16 v[136:139], v[84:87], v[164:167], v[136:139]
    v_mfma_f32_16x16x32_bf16 v[140:143], v[84:87], v[180:183], v[140:143]
    s_waitcnt lgkmcnt(1)
    v_mfma_f32_16x16x32_bf16 v[136:139], v[88:91], v[168:171], v[136:139]
    v_mfma_f32_16x16x32_bf16 v[140:143], v[88:91], v[184:187], v[140:143]
    s_waitcnt lgkmcnt(0)
    v_mfma_f32_16x16x32_bf16 v[136:139], v[92:95], v[172:175], v[136:139]
    v_mfma_f32_16x16x32_bf16 v[140:143], v[92:95], v[188:191], v[140:143]
    ds_read_b128 v[192:195], v2 offset:16384
    ds_read_b128 v[196:199], v2 offset:17408
    ds_read_b128 v[200:203], v2 offset:18432
    ds_read_b128 v[204:207], v2 offset:19456
    ds_read_b128 v[208:211], v2 offset:20480
    ds_read_b128 v[212:215], v2 offset:21504
    ds_read_b128 v[216:219], v2 offset:22528
    ds_read_b128 v[220:223], v2 offset:23552
    v_mov_b64 v[96:97], 0
    v_mov_b64 v[98:99], 0
    v_mov_b64 v[100:101], 0
    v_mov_b64 v[102:103], 0
    v_mov_b64 v[104:105], 0
    v_mov_b64 v[106:107], 0
    v_mov_b64 v[108:109], 0
    v_mov_b64 v[110:111], 0
    v_mov_b64 v[112:113], 0
    v_mov_b64 v[114:115], 0
    v_mov_b64 v[116:117], 0
    v_mov_b64 v[118:119], 0
    v_mov_b64 v[120:121], 0
    v_mov_b64 v[122:123], 0
    v_mov_b64 v[124:125], 0
    v_mov_b64 v[126:127], 0
    v_mov_b64 v[64:65], 0
    v_mov_b64 v[66:67], 0
    v_mov_b64 v[68:69], 0
    v_mov_b64 v[70:71], 0
    v_mov_b64 v[72:73], 0
    v_mov_b64 v[74:75], 0
    v_mov_b64 v[76:77], 0
    v_mov_b64 v[78:79], 0
    v_mov_b64 v[80:81], 0
    v_mov_b64 v[82:83], 0
    v_mov_b64 v[84:85], 0
    v_mov_b64 v[86:87], 0
    v_mov_b64 v[88:89], 0
    v_mov_b64 v[90:91], 0
    v_mov_b64 v[92:93], 0
    v_mov_b64 v[94:95], 0
    v_max3_f32 v7, v128, v129, v130
    v_max3_f32 v7, v7, v131, v136
    v_max3_f32 v7, v7, v137, v138
    v_max_f32 v7, v7, v139
    v_max3_f32 v8, v132, v133, v134
    v_max3_f32 v8, v8, v135, v140
    v_max3_f32 v8, v8, v141, v142
    v_max_f32 v8, v8, v143
    v_mov_b32 v9, v7
    v_mov_b32 v10, v8
    s_nop 1
    v_permlane32_swap_b32 v7, v9
    v_permlane32_swap_b32 v8, v10
    s_nop 1
    v_max_f32 v7, v7, v9
    v_max_f32 v8, v8, v10
    v_mov_b32 v9, v7
    v_mov_b32 v10, v8
    s_nop 1
    v_permlane16_swap_b32 v7, v9
    v_permlane16_swap_b32 v8, v10
    s_nop 1
    v_max_f32 v7, v7, v9
    v_max_f32 v8, v8, v10
    v_sub_f32 v4, 0xc2b40000, v7
    v_sub_f32 v5, 0xc2b40000, v8
    v_add_f32 v128, v4, v128
    v_mov_b32 v32, v4
    v_add_f32 v129, v4, v129
    v_mov_b32 v33, v4
    v_add_f32 v130, v4, v130
    v_mov_b32 v34, v4
    v_add_f32 v131, v4, v131
    v_mov_b32 v35, v4
    v_add_f32 v132, v5, v132
    v_mov_b32 v36, v5
    v_add_f32 v133, v5, v133
    v_mov_b32 v37, v5
    v_add_f32 v134, v5, v134
    v_mov_b32 v38, v5
    v_add_f32 v135, v5, v135
    v_mov_b32 v39, v5
    v_add_f32 v136, v4, v136
    v_mov_b32 v40, v4
    v_add_f32 v137, v4, v137
    v_mov_b32 v41, v4
    v_add_f32 v138, v4, v138
    v_mov_b32 v42, v4
    v_add_f32 v139, v4, v139
    v_mov_b32 v43, v4
    v_add_f32 v140, v5, v140
    v_mov_b32 v44, v5
    v_add_f32 v141, v5, v141
    v_mov_b32 v45, v5
    v_add_f32 v142, v5, v142
    v_mov_b32 v46, v5
    v_add_f32 v143, v5, v143
    v_mov_b32 v47, v5
    v_exp_f32 v128, v128
    v_exp_f32 v129, v129
    v_exp_f32 v130, v130
    v_exp_f32 v131, v131
    v_exp_f32 v132, v132
    v_exp_f32 v133, v133
    v_exp_f32 v134, v134
    v_exp_f32 v135, v135
    v_exp_f32 v136, v136
    v_exp_f32 v137, v137
    v_exp_f32 v138, v138
    s_nop 0
    v_cvt_pk_bf16_f32 v48, v128, v129
    v_cvt_pk_bf16_f32 v49, v130, v131
    v_cvt_pk_bf16_f32 v52, v132, v133
    v_cvt_pk_bf16_f32 v53, v134, v135
    v_cvt_pk_bf16_f32 v50, v136, v137
    s_cmp_eq_u32 s19, 0
    s_cselect_b32 s24, 1, 0
    s_max_u32 s21, s19, 1
    s_sub_u32 s21, s21, 1
    s_sub_u32 s21, s21, 1
    s_cbranch_scc1 b_FIX_P
b_BACK_P:
    s_lshr_b32 s20, s20, 1
    s_sub_u32 s31, s20, 2
    s_cselect_b32 s31, 0, s31
    s_sub_u32 s20, s20, s31
    s_lshl_b32 s25, s31, 2
    s_sub_u32 s21, s21, s25
    s_waitcnt lgkmcnt(5)
    s_cmp_ge_u32 s18, 4
    s_cbranch_scc1 b_LO_START
    s_cmp_eq_u32 s31, 0
    s_cbranch_scc1 b_FIXL_H
    s_sub_u32 s31, s31, 1
b_LOOP_H:
    v_mfma_f32_16x16x32_bf16 v[144:147], v[192:195], v[160:163], v[32:35]
    v_exp_f32 v139, v139
    v_mfma_f32_16x16x32_bf16 v[148:151], v[192:195], v[176:179], v[36:39]
    s_waitcnt lgkmcnt(5)
    ds_read_b128 v[192:195], v2 offset:8192
    v_mfma_f32_16x16x32_bf16 v[144:147], v[196:199], v[164:167], v[144:147]
    v_exp_f32 v140, v140
    v_mfma_f32_16x16x32_bf16 v[148:151], v[196:199], v[180:183], v[148:151]
    ds_read_b128 v[196:199], v2 offset:9216
    v_cvt_pk_bf16_f32 v51, v138, v139
    v_mfma_f32_16x16x32_bf16 v[144:147], v[200:203], v[168:171], v[144:147]
    v_exp_f32 v141, v141
    v_mfma_f32_16x16x32_bf16 v[148:151], v[200:203], v[184:187], v[148:151]
    s_waitcnt lgkmcnt(5)
    ds_read_b128 v[200:203], v2 offset:10240
    v_mfma_f32_16x16x32_bf16 v[144:147], v[204:207], v[172:175], v[144:147]
    v_exp_f32 v142, v142
    v_mfma_f32_16x16x32_bf16 v[148:151], v[204:207], v[188:191], v[148:151]
    ds_read_b128 v[204:207], v2 offset:11264
    v_cvt_pk_bf16_f32 v54, v140, v141
    v_mfma_f32_16x16x32_bf16 v[152:155], v[208:211], v[160:163], v[40:43]
    v_exp_f32 v143, v143
    v_mfma_f32_16x16x32_bf16 v[156:159], v[208:211], v[176:179], v[44:47]
    s_waitcnt lgkmcnt(5)
    ds_read_b128 v[208:211], v2 offset:12288
    v_mfma_f32_16x16x32_bf16 v[152:155], v[212:215], v[164:167], v[152:155]
    v_mfma_f32_16x16x32_bf16 v[156:159], v[212:215], v[180:183], v[156:159]
    ds_read_b128 v[212:215], v2 offset:13312
    v_cvt_pk_bf16_f32 v55, v142, v143
    v_mfma_f32_16x16x32_bf16 v[152:155], v[216:219], v[168:171], v[152:155]
    v_exp_f32 v144, v144
    v_mfma_f32_16x16x32_bf16 v[156:159], v[216:219], v[184:187], v[156:159]
    s_waitcnt lgkmcnt(4)
    ds_read_b128 v[216:219], v2 offset:14336
    v_mfma_f32_16x16x32_bf16 v[152:155], v[220:223], v[172:175], v[152:155]
    v_exp_f32 v145, v145
    v_mfma_f32_16x16x32_bf16 v[156:159], v[220:223], v[188:191], v[156:159]
    ds_read_b128 v[220:223], v2 offset:15360
    v_mfma_f32_16x16x32_bf16 v[64:67], v[192:195], v[48:51], v[64:67]
    v_exp_f32 v146, v146
    v_mfma_f32_16x16x32_bf16 v[68:71], v[192:195], v[52:55], v[68:71]
    s_barrier
    ds_read_b128 v[192:195], v3 offset:0
    v_cvt_pk_bf16_f32 v56, v144, v145
    v_mfma_f32_16x16x32_bf16 v[72:75], v[196:199], v[48:51], v[72:75]
    v_exp_f32 v147, v147
    v_mfma_f32_16x16x32_bf16 v[76:79], v[196:199], v[52:55], v[76:79]
    s_waitcnt lgkmcnt(5)
    ds_read_b128 v[196:199], v3 offset:1024
    v_mfma_f32_16x16x32_bf16 v[80:83], v[200:203], v[48:51], v[80:83]
    v_exp_f32 v148, v148
    v_mfma_f32_16x16x32_bf16 v[84:87], v[200:203], v[52:55], v[84:87]
    ds_read_b128 v[200:203], v3 offset:2048
    v_cvt_pk_bf16_f32 v57, v146, v147
    v_mfma_f32_16x16x32_bf16 v[88:91], v[204:207], v[48:51], v[88:91]
    v_exp_f32 v149, v149
    v_mfma_f32_16x16x32_bf16 v[92:95], v[204:207], v[52:55], v[92:95]
    s_waitcnt lgkmcnt(5)
    ds_read_b128 v[204:207], v3 offset:3072
    v_mfma_f32_16x16x32_bf16 v[96:99], v[208:211], v[48:51], v[96:99]
    v_exp_f32 v150, v150
    v_mfma_f32_16x16x32_bf16 v[100:103], v[208:211], v[52:55], v[100:103]
    ds_read_b128 v[208:211], v3 offset:4096
    v_cvt_pk_bf16_f32 v60, v148, v149
    v_mfma_f32_16x16x32_bf16 v[104:107], v[212:215], v[48:51], v[104:107]
    v_exp_f32 v151, v151
    v_mfma_f32_16x16x32_bf16 v[108:111], v[212:215], v[52:55], v[108:111]
    s_waitcnt lgkmcnt(5)
    ds_read_b128 v[212:215], v3 offset:5120
    v_mfma_f32_16x16x32_bf16 v[112:115], v[216:219], v[48:51], v[112:115]
    v_exp_f32 v152, v152
    v_mfma_f32_16x16x32_bf16 v[116:119], v[216:219], v[52:55], v[116:119]
    ds_read_b128 v[216:219], v3 offset:6144
    v_cvt_pk_bf16_f32 v61, v150, v151
    v_mfma_f32_16x16x32_bf16 v[120:123], v[220:223], v[48:51], v[120:123]
    v_exp_f32 v153, v153
    v_mfma_f32_16x16x32_bf16 v[124:127], v[220:223], v[52:55], v[124:127]
    s_waitcnt lgkmcnt(6)
    ds_read_b128 v[220:223], v3 offset:7168
    v_mfma_f32_16x16x32_bf16 v[20:23], v[16:19], v[48:51], v[20:23]
    v_exp_f32 v154, v154
    v_mfma_f32_16x16x32_bf16 v[24:27], v[16:19], v[52:55], v[24:27]
    v_cvt_pk_bf16_f32 v58, v152, v153
    v_mfma_f32_16x16x32_bf16 v[128:131], v[192:195], v[160:163], v[32:35]
    v_exp_f32 v155, v155
    v_mfma_f32_16x16x32_bf16 v[132:135], v[192:195], v[176:179], v[36:39]
    s_waitcnt lgkmcnt(5)
    ds_read_b128 v[192:195], v2 offset:24576
    v_mfma_f32_16x16x32_bf16 v[128:131], v[196:199], v[164:167], v[128:131]
    v_exp_f32 v156, v156
    v_mfma_f32_16x16x32_bf16 v[132:135], v[196:199], v[180:183], v[132:135]
    ds_read_b128 v[196:199], v2 offset:25600
    v_cvt_pk_bf16_f32 v59, v154, v155
    v_mfma_f32_16x16x32_bf16 v[128:131], v[200:203], v[168:171], v[128:131]
    v_exp_f32 v157, v157
    v_mfma_f32_16x16x32_bf16 v[132:135], v[200:203], v[184:187], v[132:135]
    s_waitcnt lgkmcnt(5)
    ds_read_b128 v[200:203], v2 offset:26624
    v_mfma_f32_16x16x32_bf16 v[128:131], v[204:207], v[172:175], v[128:131]
    v_exp_f32 v158, v158
    v_mfma_f32_16x16x32_bf16 v[132:135], v[204:207], v[188:191], v[132:135]
    ds_read_b128 v[204:207], v2 offset:27648
    v_cvt_pk_bf16_f32 v62, v156, v157
    v_mfma_f32_16x16x32_bf16 v[136:139], v[208:211], v[160:163], v[40:43]
    v_exp_f32 v159, v159
    v_mfma_f32_16x16x32_bf16 v[140:143], v[208:211], v[176:179], v[44:47]
    s_waitcnt lgkmcnt(5)
    ds_read_b128 v[208:211], v2 offset:28672
    v_mfma_f32_16x16x32_bf16 v[136:139], v[212:215], v[164:167], v[136:139]
    v_mfma_f32_16x16x32_bf16 v[140:143], v[212:215], v[180:183], v[140:143]
    ds_read_b128 v[212:215], v2 offset:29696
    v_cvt_pk_bf16_f32 v63, v158, v159
    v_mfma_f32_16x16x32_bf16 v[136:139], v[216:219], v[168:171], v[136:139]
    v_exp_f32 v128, v128
    v_mfma_f32_16x16x32_bf16 v[140:143], v[216:219], v[184:187], v[140:143]
    s_waitcnt lgkmcnt(4)
    ds_read_b128 v[216:219], v2 offset:30720
    v_mfma_f32_16x16x32_bf16 v[136:139], v[220:223], v[172:175], v[136:139]
    v_exp_f32 v129, v129
    v_mfma_f32_16x16x32_bf16 v[140:143], v[220:223], v[188:191], v[140:143]
    ds_read_b128 v[220:223], v2 offset:31744
    v_mfma_f32_16x16x32_bf16 v[64:67], v[192:195], v[56:59], v[64:67]
    v_exp_f32 v130, v130
    v_mfma_f32_16x16x32_bf16 v[68:71], v[192:195], v[60:63], v[68:71]
    ds_read_b128 v[192:195], v3 offset:16384
    v_cvt_pk_bf16_f32 v48, v128, v129
    v_mfma_f32_16x16x32_bf16 v[72:75], v[196:199], v[56:59], v[72:75]
    v_exp_f32 v131, v131
    v_mfma_f32_16x16x32_bf16 v[76:79], v[196:199], v[60:63], v[76:79]
    s_waitcnt lgkmcnt(5)
    ds_read_b128 v[196:199], v3 offset:17408
    v_mfma_f32_16x16x32_bf16 v[80:83], v[200:203], v[56:59], v[80:83]
    v_exp_f32 v132, v132
    v_mfma_f32_16x16x32_bf16 v[84:87], v[200:203], v[60:63], v[84:87]
    ds_read_b128 v[200:203], v3 offset:18432
    v_cvt_pk_bf16_f32 v49, v130, v131
    v_mfma_f32_16x16x32_bf16 v[88:91], v[204:207], v[56:59], v[88:91]
    v_exp_f32 v133, v133
    v_mfma_f32_16x16x32_bf16 v[92:95], v[204:207], v[60:63], v[92:95]
    s_waitcnt lgkmcnt(5)
    ds_read_b128 v[204:207], v3 offset:19456
    v_mfma_f32_16x16x32_bf16 v[96:99], v[208:211], v[56:59], v[96:99]
    v_exp_f32 v134, v134
    v_mfma_f32_16x16x32_bf16 v[100:103], v[208:211], v[60:63], v[100:103]
    ds_read_b128 v[208:211], v3 offset:20480
    v_cvt_pk_bf16_f32 v52, v132, v133
    v_mfma_f32_16x16x32_bf16 v[104:107], v[212:215], v[56:59], v[104:107]
    v_exp_f32 v135, v135
    v_mfma_f32_16x16x32_bf16 v[108:111], v[212:215], v[60:63], v[108:111]
    s_waitcnt lgkmcnt(5)
    ds_read_b128 v[212:215], v3 offset:21504
    v_mfma_f32_16x16x32_bf16 v[112:115], v[216:219], v[56:59], v[112:115]
    v_exp_f32 v136, v136
    v_mfma_f32_16x16x32_bf16 v[116:119], v[216:219], v[60:63], v[116:119]
    ds_read_b128 v[216:219], v3 offset:22528
    v_cvt_pk_bf16_f32 v53, v134, v135
    v_mfma_f32_16x16x32_bf16 v[120:123], v[220:223], v[56:59], v[120:123]
    v_exp_f32 v137, v137
    v_mfma_f32_16x16x32_bf16 v[124:127], v[220:223], v[60:63], v[124:127]
    s_waitcnt lgkmcnt(6)
    ds_read_b128 v[220:223], v3 offset:23552
    v_mfma_f32_16x16x32_bf16 v[20:23], v[16:19], v[56:59], v[20:23]
    v_exp_f32 v138, v138
    v_mfma_f32_16x16x32_bf16 v[24:27], v[16:19], v[60:63], v[24:27]
    v_cvt_pk_bf16_f32 v50, v136, v137
    v_xor_b32 v2, 65536, v2
    v_mfma_f32_16x16x32_bf16 v[144:147], v[192:195], v[160:163], v[32:35]
    v_exp_f32 v139, v139
    v_mfma_f32_16x16x32_bf16 v[148:151], v[192:195], v[176:179], v[36:39]
    s_waitcnt lgkmcnt(5)
    ds_read_b128 v[192:195], v3 offset:8192
    v_mfma_f32_16x16x32_bf16 v[144:147], v[196:199], v[164:167], v[144:147]
    v_exp_f32 v140, v140
    v_mfma_f32_16x16x32_bf16 v[148:151], v[196:199], v[180:183], v[148:151]
    ds_read_b128 v[196:199], v3 offset:9216
    v_cvt_pk_bf16_f32 v51, v138, v139
    v_mfma_f32_16x16x32_bf16 v[144:147], v[200:203], v[168:171], v[144:147]
    v_exp_f32 v141, v141
    v_mfma_f32_16x16x32_bf16 v[148:151], v[200:203], v[184:187], v[148:151]
    s_waitcnt lgkmcnt(5)
    ds_read_b128 v[200:203], v3 offset:10240
    v_mfma_f32_16x16x32_bf16 v[144:147], v[204:207], v[172:175], v[144:147]
    v_exp_f32 v142, v142
    v_mfma_f32_16x16x32_bf16 v[148:151], v[204:207], v[188:191], v[148:151]
    ds_read_b128 v[204:207], v3 offset:11264
    v_cvt_pk_bf16_f32 v54, v140, v141
    v_mfma_f32_16x16x32_bf16 v[152:155], v[208:211], v[160:163], v[40:43]
    v_exp_f32 v143, v143
    v_mfma_f32_16x16x32_bf16 v[156:159], v[208:211], v[176:179], v[44:47]
    s_waitcnt lgkmcnt(5)
    ds_read_b128 v[208:211], v3 offset:12288
    v_mfma_f32_16x16x32_bf16 v[152:155], v[212:215], v[164:167], v[152:155]
    v_mfma_f32_16x16x32_bf16 v[156:159], v[212:215], v[180:183], v[156:159]
    ds_read_b128 v[212:215], v3 offset:13312
    v_cvt_pk_bf16_f32 v55, v142, v143
    v_mfma_f32_16x16x32_bf16 v[152:155], v[216:219], v[168:171], v[152:155]
    v_exp_f32 v144, v144
    v_mfma_f32_16x16x32_bf16 v[156:159], v[216:219], v[184:187], v[156:159]
    s_waitcnt lgkmcnt(4)
    ds_read_b128 v[216:219], v3 offset:14336
    v_mfma_f32_16x16x32_bf16 v[152:155], v[220:223], v[172:175], v[152:155]
    v_exp_f32 v145, v145
    v_mfma_f32_16x16x32_bf16 v[156:159], v[220:223], v[188:191], v[156:159]
    ds_read_b128 v[220:223], v3 offset:15360
    v_mfma_f32_16x16x32_bf16 v[64:67], v[192:195], v[48:51], v[64:67]
    v_exp_f32 v146, v146
    v_mfma_f32_16x16x32_bf16 v[68:71], v[192:195], v[52:55], v[68:71]
    s_barrier
    ds_read_b128 v[192:195], v2 offset:0
    v_cvt_pk_bf16_f32 v56, v144, v145
    v_mfma_f32_16x16x32_bf16 v[72:75], v[196:199], v[48:51], v[72:75]
    v_exp_f32 v147, v147
    v_mfma_f32_16x16x32_bf16 v[76:79], v[196:199], v[52:55], v[76:79]
    s_waitcnt lgkmcnt(5)
    ds_read_b128 v[196:199], v2 offset:1024
    v_mfma_f32_16x16x32_bf16 v[80:83], v[200:203], v[48:51], v[80:83]
    v_exp_f32 v148, v148
    v_mfma_f32_16x16x32_bf16 v[84:87], v[200:203], v[52:55], v[84:87]
    ds_read_b128 v[200:203], v2 offset:2048
    v_cvt_pk_bf16_f32 v57, v146, v147
    v_mfma_f32_16x16x32_bf16 v[88:91], v[204:207], v[48:51], v[88:91]
    v_exp_f32 v149, v149
    v_mfma_f32_16x16x32_bf16 v[92:95], v[204:207], v[52:55], v[92:95]
    s_waitcnt lgkmcnt(5)
    ds_read_b128 v[204:207], v2 offset:3072
    v_mfma_f32_16x16x32_bf16 v[96:99], v[208:211], v[48:51], v[96:99]
    v_exp_f32 v150, v150
    v_mfma_f32_16x16x32_bf16 v[100:103], v[208:211], v[52:55], v[100:103]
    ds_read_b128 v[208:211], v2 offset:4096
    v_cvt_pk_bf16_f32 v60, v148, v149
    v_mfma_f32_16x16x32_bf16 v[104:107], v[212:215], v[48:51], v[104:107]
    v_exp_f32 v151, v151
    v_mfma_f32_16x16x32_bf16 v[108:111], v[212:215], v[52:55], v[108:111]
    s_waitcnt lgkmcnt(5)
    ds_read_b128 v[212:215], v2 offset:5120
    v_mfma_f32_16x16x32_bf16 v[112:115], v[216:219], v[48:51], v[112:115]
    v_exp_f32 v152, v152
    v_mfma_f32_16x16x32_bf16 v[116:119], v[216:219], v[52:55], v[116:119]
    ds_read_b128 v[216:219], v2 offset:6144
    v_cvt_pk_bf16_f32 v61, v150, v151
    v_mfma_f32_16x16x32_bf16 v[120:123], v[220:223], v[48:51], v[120:123]
    v_exp_f32 v153, v153
    v_mfma_f32_16x16x32_bf16 v[124:127], v[220:223], v[52:55], v[124:127]
    s_waitcnt lgkmcnt(6)
    ds_read_b128 v[220:223], v2 offset:7168
    v_mfma_f32_16x16x32_bf16 v[20:23], v[16:19], v[48:51], v[20:23]
    v_exp_f32 v154, v154
    v_mfma_f32_16x16x32_bf16 v[24:27], v[16:19], v[52:55], v[24:27]
    v_cvt_pk_bf16_f32 v58, v152, v153
    v_mfma_f32_16x16x32_bf16 v[128:131], v[192:195], v[160:163], v[32:35]
    v_exp_f32 v155, v155
    v_mfma_f32_16x16x32_bf16 v[132:135], v[192:195], v[176:179], v[36:39]
    s_waitcnt lgkmcnt(5)
    ds_read_b128 v[192:195], v3 offset:24576
    v_mfma_f32_16x16x32_bf16 v[128:131], v[196:199], v[164:167], v[128:131]
    v_exp_f32 v156, v156
    v_mfma_f32_16x16x32_bf16 v[132:135], v[196:199], v[180:183], v[132:135]
    ds_read_b128 v[196:199], v3 offset:25600
    v_cvt_pk_bf16_f32 v59, v154, v155
    v_mfma_f32_16x16x32_bf16 v[128:131], v[200:203], v[168:171], v[128:131]
    v_exp_f32 v157, v157
    v_mfma_f32_16x16x32_bf16 v[132:135], v[200:203], v[184:187], v[132:135]
    s_waitcnt lgkmcnt(5)
    ds_read_b128 v[200:203], v3 offset:26624
    v_mfma_f32_16x16x32_bf16 v[128:131], v[204:207], v[172:175], v[128:131]
    v_exp_f32 v158, v158
    v_mfma_f32_16x16x32_bf16 v[132:135], v[204:207], v[188:191], v[132:135]
    ds_read_b128 v[204:207], v3 offset:27648
    v_cvt_pk_bf16_f32 v62, v156, v157
    v_mfma_f32_16x16x32_bf16 v[136:139], v[208:211], v[160:163], v[40:43]
    v_exp_f32 v159, v159
    v_mfma_f32_16x16x32_bf16 v[140:143], v[208:211], v[176:179], v[44:47]
    s_waitcnt lgkmcnt(5)
    ds_read_b128 v[208:211], v3 offset:28672
    v_mfma_f32_16x16x32_bf16 v[136:139], v[212:215], v[164:167], v[136:139]
    v_mfma_f32_16x16x32_bf16 v[140:143], v[212:215], v[180:183], v[140:143]
    ds_read_b128 v[212:215], v3 offset:29696
    v_cvt_pk_bf16_f32 v63, v158, v159
    v_mfma_f32_16x16x32_bf16 v[136:139], v[216:219], v[168:171], v[136:139]
    v_exp_f32 v128, v128
    v_mfma_f32_16x16x32_bf16 v[140:143], v[216:219], v[184:187], v[140:143]
    s_waitcnt lgkmcnt(4)
    ds_read_b128 v[216:219], v3 offset:30720
    v_mfma_f32_16x16x32_bf16 v[136:139], v[220:223], v[172:175], v[136:139]
    v_exp_f32 v129, v129
    v_mfma_f32_16x16x32_bf16 v[140:143], v[220:223], v[188:191], v[140:143]
    ds_read_b128 v[220:223], v3 offset:31744
    v_mfma_f32_16x16x32_bf16 v[64:67], v[192:195], v[56:59], v[64:67]
    v_exp_f32 v130, v130
    v_mfma_f32_16x16x32_bf16 v[68:71], v[192:195], v[60:63], v[68:71]
    ds_read_b128 v[192:195], v2 offset:16384
    v_cvt_pk_bf16_f32 v48, v128, v129
    v_mfma_f32_16x16x32_bf16 v[72:75], v[196:199], v[56:59], v[72:75]
    v_exp_f32 v131, v131
    v_mfma_f32_16x16x32_bf16 v[76:79], v[196:199], v[60:63], v[76:79]
    s_waitcnt lgkmcnt(5)
    ds_read_b128 v[196:199], v2 offset:17408
    v_mfma_f32_16x16x32_bf16 v[80:83], v[200:203], v[56:59], v[80:83]
    v_exp_f32 v132, v132
    v_mfma_f32_16x16x32_bf16 v[84:87], v[200:203], v[60:63], v[84:87]
    ds_read_b128 v[200:203], v2 offset:18432
    v_cvt_pk_bf16_f32 v49, v130, v131
    v_mfma_f32_16x16x32_bf16 v[88:91], v[204:207], v[56:59], v[88:91]
    v_exp_f32 v133, v133
    v_mfma_f32_16x16x32_bf16 v[92:95], v[204:207], v[60:63], v[92:95]
    s_waitcnt lgkmcnt(5)
    ds_read_b128 v[204:207], v2 offset:19456
    v_mfma_f32_16x16x32_bf16 v[96:99], v[208:211], v[56:59], v[96:99]
    v_exp_f32 v134, v134
    v_mfma_f32_16x16x32_bf16 v[100:103], v[208:211], v[60:63], v[100:103]
    ds_read_b128 v[208:211], v2 offset:20480
    v_cvt_pk_bf16_f32 v52, v132, v133
    v_mfma_f32_16x16x32_bf16 v[104:107], v[212:215], v[56:59], v[104:107]
    v_exp_f32 v135, v135
    v_mfma_f32_16x16x32_bf16 v[108:111], v[212:215], v[60:63], v[108:111]
    s_waitcnt lgkmcnt(5)
    ds_read_b128 v[212:215], v2 offset:21504
    v_mfma_f32_16x16x32_bf16 v[112:115], v[216:219], v[56:59], v[112:115]
    v_exp_f32 v136, v136
    v_mfma_f32_16x16x32_bf16 v[116:119], v[216:219], v[60:63], v[116:119]
    ds_read_b128 v[216:219], v2 offset:22528
    v_cvt_pk_bf16_f32 v53, v134, v135
    v_mfma_f32_16x16x32_bf16 v[120:123], v[220:223], v[56:59], v[120:123]
    v_exp_f32 v137, v137
    v_mfma_f32_16x16x32_bf16 v[124:127], v[220:223], v[60:63], v[124:127]
    s_waitcnt lgkmcnt(6)
    ds_read_b128 v[220:223], v2 offset:23552
    v_mfma_f32_16x16x32_bf16 v[20:23], v[16:19], v[56:59], v[20:23]
    v_exp_f32 v138, v138
    v_mfma_f32_16x16x32_bf16 v[24:27], v[16:19], v[60:63], v[24:27]
    v_cvt_pk_bf16_f32 v50, v136, v137
    v_xor_b32 v3, 65536, v3
    s_sub_u32 s31, s31, 1
    s_cbranch_scc0 b_LOOP_H
b_FIXL_H:
    s_sub_u32 s20, s20, 1
b_LOOPF_H:
    v_mfma_f32_16x16x32_bf16 v[144:147], v[192:195], v[160:163], v[32:35]
    v_exp_f32 v139, v139
    v_mfma_f32_16x16x32_bf16 v[148:151], v[192:195], v[176:179], v[36:39]
    s_waitcnt lgkmcnt(5)
    ds_read_b128 v[192:195], v2 offset:8192
    v_mfma_f32_16x16x32_bf16 v[144:147], v[196:199], v[164:167], v[144:147]
    v_exp_f32 v140, v140
    v_mfma_f32_16x16x32_bf16 v[148:151], v[196:199], v[180:183], v[148:151]
    ds_read_b128 v[196:199], v2 offset:9216
    v_cvt_pk_bf16_f32 v51, v138, v139
    v_mfma_f32_16x16x32_bf16 v[144:147], v[200:203], v[168:171], v[144:147]
    v_exp_f32 v141, v141
    v_mfma_f32_16x16x32_bf16 v[148:151], v[200:203], v[184:187], v[148:151]
    s_waitcnt lgkmcnt(5)
    ds_read_b128 v[200:203], v2 offset:10240
    v_mfma_f32_16x16x32_bf16 v[144:147], v[204:207], v[172:175], v[144:147]
    v_exp_f32 v142, v142
    v_mfma_f32_16x16x32_bf16 v[148:151], v[204:207], v[188:191], v[148:151]
    ds_read_b128 v[204:207], v2 offset:11264
    v_cvt_pk_bf16_f32 v54, v140, v141
    v_mfma_f32_16x16x32_bf16 v[152:155], v[208:211], v[160:163], v[40:43]
    v_exp_f32 v143, v143
    v_mfma_f32_16x16x32_bf16 v[156:159], v[208:211], v[176:179], v[44:47]
    s_waitcnt lgkmcnt(5)
    ds_read_b128 v[208:211], v2 offset:12288
    v_mfma_f32_16x16x32_bf16 v[152:155], v[212:215], v[164:167], v[152:155]
    s_sub_u32 s21, s21, 1
    s_cbranch_scc1 b_FIX_H00
b_BACK_H00:
    v_mfma_f32_16x16x32_bf16 v[156:159], v[212:215], v[180:183], v[156:159]
    ds_read_b128 v[212:215], v2 offset:13312
    v_cvt_pk_bf16_f32 v55, v142, v143
    v_mfma_f32_16x16x32_bf16 v[152:155], v[216:219], v[168:171], v[152:155]
    v_exp_f32 v144, v144
    v_mfma_f32_16x16x32_bf16 v[156:159], v[216:219], v[184:187], v[156:159]
    s_waitcnt lgkmcnt(4)
    ds_read_b128 v[216:219], v2 offset:14336
    v_mfma_f32_16x16x32_bf16 v[152:155], v[220:223], v[172:175], v[152:155]
    v_exp_f32 v145, v145
    v_mfma_f32_16x16x32_bf16 v[156:159], v[220:223], v[188:191], v[156:159]
    ds_read_b128 v[220:223], v2 offset:15360
    v_mfma_f32_16x16x32_bf16 v[64:67], v[192:195], v[48:51], v[64:67]
    v_exp_f32 v146, v146
    v_mfma_f32_16x16x32_bf16 v[68:71], v[192:195], v[52:55], v[68:71]
    s_barrier
    ds_read_b128 v[192:195], v3 offset:0
    v_cvt_pk_bf16_f32 v56, v144, v145
    v_mfma_f32_16x16x32_bf16 v[72:75], v[196:199], v[48:51], v[72:75]
    v_exp_f32 v147, v147
    v_mfma_f32_16x16x32_bf16 v[76:79], v[196:199], v[52:55], v[76:79]
    s_waitcnt lgkmcnt(5)
    ds_read_b128 v[196:199], v3 offset:1024
    v_mfma_f32_16x16x32_bf16 v[80:83], v[200:203], v[48:51], v[80:83]
    v_exp_f32 v148, v148
    v_mfma_f32_16x16x32_bf16 v[84:87], v[200:203], v[52:55], v[84:87]
    ds_read_b128 v[200:203], v3 offset:2048
    v_cvt_pk_bf16_f32 v57, v146, v147
    v_mfma_f32_16x16x32_bf16 v[88:91], v[204:207], v[48:51], v[88:91]
    v_exp_f32 v149, v149
    v_mfma_f32_16x16x32_bf16 v[92:95], v[204:207], v[52:55], v[92:95]
    s_waitcnt lgkmcnt(5)
    ds_read_b128 v[204:207], v3 offset:3072
    v_mfma_f32_16x16x32_bf16 v[96:99], v[208:211], v[48:51], v[96:99]
    v_exp_f32 v150, v150
    v_mfma_f32_16x16x32_bf16 v[100:103], v[208:211], v[52:55], v[100:103]
    ds_read_b128 v[208:211], v3 offset:4096
    v_cvt_pk_bf16_f32 v60, v148, v149
    v_mfma_f32_16x16x32_bf16 v[104:107], v[212:215], v[48:51], v[104:107]
    v_exp_f32 v151, v151
    v_mfma_f32_16x16x32_bf16 v[108:111], v[212:215], v[52:55], v[108:111]
    s_waitcnt lgkmcnt(5)
    ds_read_b128 v[212:215], v3 offset:5120
    v_mfma_f32_16x16x32_bf16 v[112:115], v[216:219], v[48:51], v[112:115]
    v_exp_f32 v152, v152
    v_mfma_f32_16x16x32_bf16 v[116:119], v[216:219], v[52:55], v[116:119]
    ds_read_b128 v[216:219], v3 offset:6144
    v_cvt_pk_bf16_f32 v61, v150, v151
    v_mfma_f32_16x16x32_bf16 v[120:123], v[220:223], v[48:51], v[120:123]
    v_exp_f32 v153, v153
    v_mfma_f32_16x16x32_bf16 v[124:127], v[220:223], v[52:55], v[124:127]
    s_waitcnt lgkmcnt(6)
    ds_read_b128 v[220:223], v3 offset:7168
    v_mfma_f32_16x16x32_bf16 v[20:23], v[16:19], v[48:51], v[20:23]
    v_exp_f32 v154, v154
    v_mfma_f32_16x16x32_bf16 v[24:27], v[16:19], v[52:55], v[24:27]
    v_cvt_pk_bf16_f32 v58, v152, v153
    v_mfma_f32_16x16x32_bf16 v[128:131], v[192:195], v[160:163], v[32:35]
    v_exp_f32 v155, v155
    v_mfma_f32_16x16x32_bf16 v[132:135], v[192:195], v[176:179], v[36:39]
    s_waitcnt lgkmcnt(5)
    ds_read_b128 v[192:195], v2 offset:24576
    v_mfma_f32_16x16x32_bf16 v[128:131], v[196:199], v[164:167], v[128:131]
    v_exp_f32 v156, v156
    v_mfma_f32_16x16x32_bf16 v[132:135], v[196:199], v[180:183], v[132:135]
    ds_read_b128 v[196:199], v2 offset:25600
    v_cvt_pk_bf16_f32 v59, v154, v155
    v_mfma_f32_16x16x32_bf16 v[128:131], v[200:203], v[168:171], v[128:131]
    v_exp_f32 v157, v157
    v_mfma_f32_16x16x32_bf16 v[132:135], v[200:203], v[184:187], v[132:135]
    s_waitcnt lgkmcnt(5)
    ds_read_b128 v[200:203], v2 offset:26624
    v_mfma_f32_16x16x32_bf16 v[128:131], v[204:207], v[172:175], v[128:131]
    v_exp_f32 v158, v158
    v_mfma_f32_16x16x32_bf16 v[132:135], v[204:207], v[188:191], v[132:135]
    ds_read_b128 v[204:207], v2 offset:27648
    v_cvt_pk_bf16_f32 v62, v156, v157
    v_mfma_f32_16x16x32_bf16 v[136:139], v[208:211], v[160:163], v[40:43]
    v_exp_f32 v159, v159
    v_mfma_f32_16x16x32_bf16 v[140:143], v[208:211], v[176:179], v[44:47]
    s_waitcnt lgkmcnt(5)
    ds_read_b128 v[208:211], v2 offset:28672
    v_mfma_f32_16x16x32_bf16 v[136:139], v[212:215], v[164:167], v[136:139]
    s_sub_u32 s21, s21, 1
    s_cbranch_scc1 b_FIX_H01
b_BACK_H01:
    v_mfma_f32_16x16x32_bf16 v[140:143], v[212:215], v[180:183], v[140:143]
    ds_read_b128 v[212:215], v2 offset:29696
    v_cvt_pk_bf16_f32 v63, v158, v159
    v_mfma_f32_16x16x32_bf16 v[136:139], v[216:219], v[168:171], v[136:139]
    v_exp_f32 v128, v128
    v_mfma_f32_16x16x32_bf16 v[140:143], v[216:219], v[184:187], v[140:143]
    s_waitcnt lgkmcnt(4)
    ds_read_b128 v[216:219], v2 offset:30720
    v_mfma_f32_16x16x32_bf16 v[136:139], v[220:223], v[172:175], v[136:139]
    v_exp_f32 v129, v129
    v_mfma_f32_16x16x32_bf16 v[140:143], v[220:223], v[188:191], v[140:143]
    ds_read_b128 v[220:223], v2 offset:31744
    v_mfma_f32_16x16x32_bf16 v[64:67], v[192:195], v[56:59], v[64:67]
    v_exp_f32 v130, v130
    v_mfma_f32_16x16x32_bf16 v[68:71], v[192:195], v[60:63], v[68:71]
    ds_read_b128 v[192:195], v3 offset:16384
    v_cvt_pk_bf16_f32 v48, v128, v129
    v_mfma_f32_16x16x32_bf16 v[72:75], v[196:199], v[56:59], v[72:75]
    v_exp_f32 v131, v131
    v_mfma_f32_16x16x32_bf16 v[76:79], v[196:199], v[60:63], v[76:79]
    s_waitcnt lgkmcnt(5)
    ds_read_b128 v[196:199], v3 offset:17408
    v_mfma_f32_16x16x32_bf16 v[80:83], v[200:203], v[56:59], v[80:83]
    v_exp_f32 v132, v132
    v_mfma_f32_16x16x32_bf16 v[84:87], v[200:203], v[60:63], v[84:87]
    ds_read_b128 v[200:203], v3 offset:18432
    v_cvt_pk_bf16_f32 v49, v130, v131
    v_mfma_f32_16x16x32_bf16 v[88:91], v[204:207], v[56:59], v[88:91]
    v_exp_f32 v133, v133
    v_mfma_f32_16x16x32_bf16 v[92:95], v[204:207], v[60:63], v[92:95]
    s_waitcnt lgkmcnt(5)
    ds_read_b128 v[204:207], v3 offset:19456
    v_mfma_f32_16x16x32_bf16 v[96:99], v[208:211], v[56:59], v[96:99]
    v_exp_f32 v134, v134
    v_mfma_f32_16x16x32_bf16 v[100:103], v[208:211], v[60:63], v[100:103]
    ds_read_b128 v[208:211], v3 offset:20480
    v_cvt_pk_bf16_f32 v52, v132, v133
    v_mfma_f32_16x16x32_bf16 v[104:107], v[212:215], v[56:59], v[104:107]
    v_exp_f32 v135, v135
    v_mfma_f32_16x16x32_bf16 v[108:111], v[212:215], v[60:63], v[108:111]
    s_waitcnt lgkmcnt(5)
    ds_read_b128 v[212:215], v3 offset:21504
    v_mfma_f32_16x16x32_bf16 v[112:115], v[216:219], v[56:59], v[112:115]
    v_exp_f32 v136, v136
    v_mfma_f32_16x16x32_bf16 v[116:119], v[216:219], v[60:63], v[116:119]
    ds_read_b128 v[216:219], v3 offset:22528
    v_cvt_pk_bf16_f32 v53, v134, v135
    v_mfma_f32_16x16x32_bf16 v[120:123], v[220:223], v[56:59], v[120:123]
    v_exp_f32 v137, v137
    v_mfma_f32_16x16x32_bf16 v[124:127], v[220:223], v[60:63], v[124:127]
    s_waitcnt lgkmcnt(6)
    ds_read_b128 v[220:223], v3 offset:23552
    v_mfma_f32_16x16x32_bf16 v[20:23], v[16:19], v[56:59], v[20:23]
    v_exp_f32 v138, v138
    v_mfma_f32_16x16x32_bf16 v[24:27], v[16:19], v[60:63], v[24:27]
    v_cvt_pk_bf16_f32 v50, v136, v137
    v_xor_b32 v2, 65536, v2
    v_mfma_f32_16x16x32_bf16 v[144:147], v[192:195], v[160:163], v[32:35]
    v_exp_f32 v139, v139
    v_mfma_f32_16x16x32_bf16 v[148:151], v[192:195], v[176:179], v[36:39]
    s_waitcnt lgkmcnt(5)
    ds_read_b128 v[192:195], v3 offset:8192
    v_mfma_f32_16x16x32_bf16 v[144:147], v[196:199], v[164:167], v[144:147]
    v_exp_f32 v140, v140
    v_mfma_f32_16x16x32_bf16 v[148:151], v[196:199], v[180:183], v[148:151]
    ds_read_b128 v[196:199], v3 offset:9216
    v_cvt_pk_bf16_f32 v51, v138, v139
    v_mfma_f32_16x16x32_bf16 v[144:147], v[200:203], v[168:171], v[144:147]
    v_exp_f32 v141, v141
    v_mfma_f32_16x16x32_bf16 v[148:151], v[200:203], v[184:187], v[148:151]
    s_waitcnt lgkmcnt(5)
    ds_read_b128 v[200:203], v3 offset:10240
    v_mfma_f32_16x16x32_bf16 v[144:147], v[204:207], v[172:175], v[144:147]
    v_exp_f32 v142, v142
    v_mfma_f32_16x16x32_bf16 v[148:151], v[204:207], v[188:191], v[148:151]
    ds_read_b128 v[204:207], v3 offset:11264
    v_cvt_pk_bf16_f32 v54, v140, v141
    v_mfma_f32_16x16x32_bf16 v[152:155], v[208:211], v[160:163], v[40:43]
    v_exp_f32 v143, v143
    v_mfma_f32_16x16x32_bf16 v[156:159], v[208:211], v[176:179], v[44:47]
    s_waitcnt lgkmcnt(5)
    ds_read_b128 v[208:211], v3 offset:12288
    v_mfma_f32_16x16x32_bf16 v[152:155], v[212:215], v[164:167], v[152:155]
    s_sub_u32 s21, s21, 1
    s_cbranch_scc1 b_FIX_H10
b_BACK_H10:
    v_mfma_f32_16x16x32_bf16 v[156:159], v[212:215], v[180:183], v[156:159]
    ds_read_b128 v[212:215], v3 offset:13312
    v_cvt_pk_bf16_f32 v55, v142, v143
    v_mfma_f32_16x16x32_bf16 v[152:155], v[216:219], v[168:171], v[152:155]
    v_exp_f32 v144, v144
    v_mfma_f32_16x16x32_bf16 v[156:159], v[216:219], v[184:187], v[156:159]
    s_waitcnt lgkmcnt(4)
    ds_read_b128 v[216:219], v3 offset:14336
    v_mfma_f32_16x16x32_bf16 v[152:155], v[220:223], v[172:175], v[152:155]
    v_exp_f32 v145, v145
    v_mfma_f32_16x16x32_bf16 v[156:159], v[220:223], v[188:191], v[156:159]
    ds_read_b128 v[220:223], v3 offset:15360
    v_mfma_f32_16x16x32_bf16 v[64:67], v[192:195], v[48:51], v[64:67]
    v_exp_f32 v146, v146
    v_mfma_f32_16x16x32_bf16 v[68:71], v[192:195], v[52:55], v[68:71]
    s_barrier
    ds_read_b128 v[192:195], v2 offset:0
    v_cvt_pk_bf16_f32 v56, v144, v145
    v_mfma_f32_16x16x32_bf16 v[72:75], v[196:199], v[48:51], v[72:75]
    v_exp_f32 v147, v147
    v_mfma_f32_16x16x32_bf16 v[76:79], v[196:199], v[52:55], v[76:79]
    s_waitcnt lgkmcnt(5)
    ds_read_b128 v[196:199], v2 offset:1024
    v_mfma_f32_16x16x32_bf16 v[80:83], v[200:203], v[48:51], v[80:83]
    v_exp_f32 v148, v148
    v_mfma_f32_16x16x32_bf16 v[84:87], v[200:203], v[52:55], v[84:87]
    ds_read_b128 v[200:203], v2 offset:2048
    v_cvt_pk_bf16_f32 v57, v146, v147
    v_mfma_f32_16x16x32_bf16 v[88:91], v[204:207], v[48:51], v[88:91]
    v_exp_f32 v149, v149
    v_mfma_f32_16x16x32_bf16 v[92:95], v[204:207], v[52:55], v[92:95]
    s_waitcnt lgkmcnt(5)
    ds_read_b128 v[204:207], v2 offset:3072
    v_mfma_f32_16x16x32_bf16 v[96:99], v[208:211], v[48:51], v[96:99]
    v_exp_f32 v150, v150
    v_mfma_f32_16x16x32_bf16 v[100:103], v[208:211], v[52:55], v[100:103]
    ds_read_b128 v[208:211], v2 offset:4096
    v_cvt_pk_bf16_f32 v60, v148, v149
    v_mfma_f32_16x16x32_bf16 v[104:107], v[212:215], v[48:51], v[104:107]
    v_exp_f32 v151, v151
    v_mfma_f32_16x16x32_bf16 v[108:111], v[212:215], v[52:55], v[108:111]
    s_waitcnt lgkmcnt(5)
    ds_read_b128 v[212:215], v2 offset:5120
    v_mfma_f32_16x16x32_bf16 v[112:115], v[216:219], v[48:51], v[112:115]
    v_exp_f32 v152, v152
    v_mfma_f32_16x16x32_bf16 v[116:119], v[216:219], v[52:55], v[116:119]
    ds_read_b128 v[216:219], v2 offset:6144
    v_cvt_pk_bf16_f32 v61, v150, v151
    v_mfma_f32_16x16x32_bf16 v[120:123], v[220:223], v[48:51], v[120:123]
    v_exp_f32 v153, v153
    v_mfma_f32_16x16x32_bf16 v[124:127], v[220:223], v[52:55], v[124:127]
    s_waitcnt lgkmcnt(6)
    ds_read_b128 v[220:223], v2 offset:7168
    v_mfma_f32_16x16x32_bf16 v[20:23], v[16:19], v[48:51], v[20:23]
    v_exp_f32 v154, v154
    v_mfma_f32_16x16x32_bf16 v[24:27], v[16:19], v[52:55], v[24:27]
    v_cvt_pk_bf16_f32 v58, v152, v153
    v_mfma_f32_16x16x32_bf16 v[128:131], v[192:195], v[160:163], v[32:35]
    v_exp_f32 v155, v155
    v_mfma_f32_16x16x32_bf16 v[132:135], v[192:195], v[176:179], v[36:39]
    s_waitcnt lgkmcnt(5)
    ds_read_b128 v[192:195], v3 offset:24576
    v_mfma_f32_16x16x32_bf16 v[128:131], v[196:199], v[164:167], v[128:131]
    v_exp_f32 v156, v156
    v_mfma_f32_16x16x32_bf16 v[132:135], v[196:199], v[180:183], v[132:135]
    ds_read_b128 v[196:199], v3 offset:25600
    v_cvt_pk_bf16_f32 v59, v154, v155
    v_mfma_f32_16x16x32_bf16 v[128:131], v[200:203], v[168:171], v[128:131]
    v_exp_f32 v157, v157
    v_mfma_f32_16x16x32_bf16 v[132:135], v[200:203], v[184:187], v[132:135]
    s_waitcnt lgkmcnt(5)
    ds_read_b128 v[200:203], v3 offset:26624
    v_mfma_f32_16x16x32_bf16 v[128:131], v[204:207], v[172:175], v[128:131]
    v_exp_f32 v158, v158
    v_mfma_f32_16x16x32_bf16 v[132:135], v[204:207], v[188:191], v[132:135]
    ds_read_b128 v[204:207], v3 offset:27648
    v_cvt_pk_bf16_f32 v62, v156, v157
    v_mfma_f32_16x16x32_bf16 v[136:139], v[208:211], v[160:163], v[40:43]
    v_exp_f32 v159, v159
    v_mfma_f32_16x16x32_bf16 v[140:143], v[208:211], v[176:179], v[44:47]
    s_waitcnt lgkmcnt(5)
    ds_read_b128 v[208:211], v3 offset:28672
    v_mfma_f32_16x16x32_bf16 v[136:139], v[212:215], v[164:167], v[136:139]
    s_sub_u32 s21, s21, 1
    s_cbranch_scc1 b_FIX_H11
b_BACK_H11:
    v_mfma_f32_16x16x32_bf16 v[140:143], v[212:215], v[180:183], v[140:143]
    ds_read_b128 v[212:215], v3 offset:29696
    v_cvt_pk_bf16_f32 v63, v158, v159
    v_mfma_f32_16x16x32_bf16 v[136:139], v[216:219], v[168:171], v[136:139]
    v_exp_f32 v128, v128
    v_mfma_f32_16x16x32_bf16 v[140:143], v[216:219], v[184:187], v[140:143]
    s_waitcnt lgkmcnt(4)
    ds_read_b128 v[216:219], v3 offset:30720
    v_mfma_f32_16x16x32_bf16 v[136:139], v[220:223], v[172:175], v[136:139]
    v_exp_f32 v129, v129
    v_mfma_f32_16x16x32_bf16 v[140:143], v[220:223], v[188:191], v[140:143]
    ds_read_b128 v[220:223], v3 offset:31744
    v_mfma_f32_16x16x32_bf16 v[64:67], v[192:195], v[56:59], v[64:67]
    v_exp_f32 v130, v130
    v_mfma_f32_16x16x32_bf16 v[68:71], v[192:195], v[60:63], v[68:71]
    ds_read_b128 v[192:195], v2 offset:16384
    v_cvt_pk_bf16_f32 v48, v128, v129
    v_mfma_f32_16x16x32_bf16 v[72:75], v[196:199], v[56:59], v[72:75]
    v_exp_f32 v131, v131
    v_mfma_f32_16x16x32_bf16 v[76:79], v[196:199], v[60:63], v[76:79]
    s_waitcnt lgkmcnt(5)
    ds_read_b128 v[196:199], v2 offset:17408
    v_mfma_f32_16x16x32_bf16 v[80:83], v[200:203], v[56:59], v[80:83]
    v_exp_f32 v132, v132
    v_mfma_f32_16x16x32_bf16 v[84:87], v[200:203], v[60:63], v[84:87]
    ds_read_b128 v[200:203], v2 offset:18432
    v_cvt_pk_bf16_f32 v49, v130, v131
    v_mfma_f32_16x16x32_bf16 v[88:91], v[204:207], v[56:59], v[88:91]
    v_exp_f32 v133, v133
    v_mfma_f32_16x16x32_bf16 v[92:95], v[204:207], v[60:63], v[92:95]
    s_waitcnt lgkmcnt(5)
    ds_read_b128 v[204:207], v2 offset:19456
    v_mfma_f32_16x16x32_bf16 v[96:99], v[208:211], v[56:59], v[96:99]
    v_exp_f32 v134, v134
    v_mfma_f32_16x16x32_bf16 v[100:103], v[208:211], v[60:63], v[100:103]
    ds_read_b128 v[208:211], v2 offset:20480
    v_cvt_pk_bf16_f32 v52, v132, v133
    v_mfma_f32_16x16x32_bf16 v[104:107], v[212:215], v[56:59], v[104:107]
    v_exp_f32 v135, v135
    v_mfma_f32_16x16x32_bf16 v[108:111], v[212:215], v[60:63], v[108:111]
    s_waitcnt lgkmcnt(5)
    ds_read_b128 v[212:215], v2 offset:21504
    v_mfma_f32_16x16x32_bf16 v[112:115], v[216:219], v[56:59], v[112:115]
    v_exp_f32 v136, v136
    v_mfma_f32_16x16x32_bf16 v[116:119], v[216:219], v[60:63], v[116:119]
    ds_read_b128 v[216:219], v2 offset:22528
    v_cvt_pk_bf16_f32 v53, v134, v135
    v_mfma_f32_16x16x32_bf16 v[120:123], v[220:223], v[56:59], v[120:123]
    v_exp_f32 v137, v137
    v_mfma_f32_16x16x32_bf16 v[124:127], v[220:223], v[60:63], v[124:127]
    s_waitcnt lgkmcnt(6)
    ds_read_b128 v[220:223], v2 offset:23552
    v_mfma_f32_16x16x32_bf16 v[20:23], v[16:19], v[56:59], v[20:23]
    v_exp_f32 v138, v138
    v_mfma_f32_16x16x32_bf16 v[24:27], v[16:19], v[60:63], v[24:27]
    v_cvt_pk_bf16_f32 v50, v136, v137
    v_xor_b32 v3, 65536, v3
    s_sub_u32 s20, s20, 1
    s_cbranch_scc0 b_LOOPF_H
    s_branch b_EPI
b_LO_START:
    s_cmp_eq_u32 s31, 0
    s_cbranch_scc1 b_FIXL_L
    s_sub_u32 s31, s31, 1
b_LOOP_L:
    v_mfma_f32_16x16x32_bf16 v[144:147], v[192:195], v[160:163], v[32:35]
    v_exp_f32 v139, v139
    v_mfma_f32_16x16x32_bf16 v[148:151], v[192:195], v[176:179], v[36:39]
    s_waitcnt lgkmcnt(5)
    ds_read_b128 v[192:195], v2 offset:8192
    v_mfma_f32_16x16x32_bf16 v[144:147], v[196:199], v[164:167], v[144:147]
    v_exp_f32 v140, v140
    v_mfma_f32_16x16x32_bf16 v[148:151], v[196:199], v[180:183], v[148:151]
    ds_read_b128 v[196:199], v2 offset:9216
    v_cvt_pk_bf16_f32 v51, v138, v139
    v_mfma_f32_16x16x32_bf16 v[144:147], v[200:203], v[168:171], v[144:147]
    v_exp_f32 v141, v141
    v_mfma_f32_16x16x32_bf16 v[148:151], v[200:203], v[184:187], v[148:151]
    s_waitcnt lgkmcnt(5)
    ds_read_b128 v[200:203], v2 offset:10240
    v_mfma_f32_16x16x32_bf16 v[144:147], v[204:207], v[172:175], v[144:147]
    v_exp_f32 v142, v142
    v_mfma_f32_16x16x32_bf16 v[148:151], v[204:207], v[188:191], v[148:151]
    ds_read_b128 v[204:207], v2 offset:11264
    v_cvt_pk_bf16_f32 v54, v140, v141
    v_mfma_f32_16x16x32_bf16 v[152:155], v[208:211], v[160:163], v[40:43]
    v_exp_f32 v143, v143
    v_mfma_f32_16x16x32_bf16 v[156:159], v[208:211], v[176:179], v[44:47]
    s_waitcnt lgkmcnt(5)
    ds_read_b128 v[208:211], v2 offset:12288
    v_mfma_f32_16x16x32_bf16 v[152:155], v[212:215], v[164:167], v[152:155]
    v_mfma_f32_16x16x32_bf16 v[156:159], v[212:215], v[180:183], v[156:159]
    ds_read_b128 v[212:215], v2 offset:13312
    v_cvt_pk_bf16_f32 v55, v142, v143
    v_mfma_f32_16x16x32_bf16 v[152:155], v[216:219], v[168:171], v[152:155]
    v_exp_f32 v144, v144
    v_mfma_f32_16x16x32_bf16 v[156:159], v[216:219], v[184:187], v[156:159]
    s_waitcnt lgkmcnt(4)
    ds_read_b128 v[216:219], v2 offset:14336
    v_mfma_f32_16x16x32_bf16 v[152:155], v[220:223], v[172:175], v[152:155]
    v_exp_f32 v145, v145
    v_mfma_f32_16x16x32_bf16 v[156:159], v[220:223], v[188:191], v[156:159]
    ds_read_b128 v[220:223], v2 offset:15360
    v_mfma_f32_16x16x32_bf16 v[64:67], v[192:195], v[48:51], v[64:67]
    v_exp_f32 v146, v146
    v_mfma_f32_16x16x32_bf16 v[68:71], v[192:195], v[52:55], v[68:71]
    s_waitcnt vmcnt(8)
    s_barrier
    s_mov_b32 m0, s23
    ds_read_b128 v[192:195], v3 offset:0
    v_cvt_pk_bf16_f32 v56, v144, v145
    v_mfma_f32_16x16x32_bf16 v[72:75], v[196:199], v[48:51], v[72:75]
    v_exp_f32 v147, v147
    v_mfma_f32_16x16x32_bf16 v[76:79], v[196:199], v[52:55], v[76:79]
    s_waitcnt lgkmcnt(5)
    buffer_load_dwordx4 v11, s[4:7], s22 offen offset:0 sc1 lds
    ds_read_b128 v[196:199], v3 offset:1024
    v_mfma_f32_16x16x32_bf16 v[80:83], v[200:203], v[48:51], v[80:83]
    v_exp_f32 v148, v148
    v_mfma_f32_16x16x32_bf16 v[84:87], v[200:203], v[52:55], v[84:87]
    buffer_load_dwordx4 v11, s[4:7], s22 offen offset:1024 sc1 lds
    ds_read_b128 v[200:203], v3 offset:2048
    v_cvt_pk_bf16_f32 v57, v146, v147
    v_mfma_f32_16x16x32_bf16 v[88:91], v[204:207], v[48:51], v[88:91]
    v_exp_f32 v149, v149
    v_mfma_f32_16x16x32_bf16 v[92:95], v[204:207], v[52:55], v[92:95]
    s_waitcnt lgkmcnt(5)
    buffer_load_dwordx4 v11, s[4:7], s22 offen offset:2048 sc1 lds
    ds_read_b128 v[204:207], v3 offset:3072
    v_mfma_f32_16x16x32_bf16 v[96:99], v[208:211], v[48:51], v[96:99]
    v_exp_f32 v150, v150
    v_mfma_f32_16x16x32_bf16 v[100:103], v[208:211], v[52:55], v[100:103]
    buffer_load_dwordx4 v11, s[4:7], s22 offen offset:3072 sc1 lds
    ds_read_b128 v[208:211], v3 offset:4096
    s_add_u32 m0, s23, 4096
    v_cvt_pk_bf16_f32 v60, v148, v149
    v_mfma_f32_16x16x32_bf16 v[104:107], v[212:215], v[48:51], v[104:107]
    v_exp_f32 v151, v151
    v_mfma_f32_16x16x32_bf16 v[108:111], v[212:215], v[52:55], v[108:111]
    s_waitcnt lgkmcnt(5)
    ds_read_b128 v[212:215], v3 offset:5120
    v_mfma_f32_16x16x32_bf16 v[112:115], v[216:219], v[48:51], v[112:115]
    v_exp_f32 v152, v152
    v_mfma_f32_16x16x32_bf16 v[116:119], v[216:219], v[52:55], v[116:119]
    ds_read_b128 v[216:219], v3 offset:6144
    v_cvt_pk_bf16_f32 v61, v150, v151
    v_mfma_f32_16x16x32_bf16 v[120:123], v[220:223], v[48:51], v[120:123]
    v_exp_f32 v153, v153
    v_mfma_f32_16x16x32_bf16 v[124:127], v[220:223], v[52:55], v[124:127]
    s_waitcnt lgkmcnt(6)
    ds_read_b128 v[220:223], v3 offset:7168
    v_mfma_f32_16x16x32_bf16 v[20:23], v[16:19], v[48:51], v[20:23]
    v_exp_f32 v154, v154
    v_mfma_f32_16x16x32_bf16 v[24:27], v[16:19], v[52:55], v[24:27]
    v_cvt_pk_bf16_f32 v58, v152, v153
    v_mfma_f32_16x16x32_bf16 v[128:131], v[192:195], v[160:163], v[32:35]
    v_exp_f32 v155, v155
    v_mfma_f32_16x16x32_bf16 v[132:135], v[192:195], v[176:179], v[36:39]
    s_waitcnt lgkmcnt(5)
    buffer_load_dwordx4 v12, s[4:7], s22 offen offset:0 sc1 lds
    ds_read_b128 v[192:195], v2 offset:24576
    v_mfma_f32_16x16x32_bf16 v[128:131], v[196:199], v[164:167], v[128:131]
    v_exp_f32 v156, v156
    v_mfma_f32_16x16x32_bf16 v[132:135], v[196:199], v[180:183], v[132:135]
    buffer_load_dwordx4 v12, s[4:7], s22 offen offset:1024 sc1 lds
    ds_read_b128 v[196:199], v2 offset:25600
    v_cvt_pk_bf16_f32 v59, v154, v155
    v_mfma_f32_16x16x32_bf16 v[128:131], v[200:203], v[168:171], v[128:131]
    v_exp_f32 v157, v157
    v_mfma_f32_16x16x32_bf16 v[132:135], v[200:203], v[184:187], v[132:135]
    s_waitcnt lgkmcnt(5)
    buffer_load_dwordx4 v12, s[4:7], s22 offen offset:2048 sc1 lds
    ds_read_b128 v[200:203], v2 offset:26624
    v_mfma_f32_16x16x32_bf16 v[128:131], v[204:207], v[172:175], v[128:131]
    v_exp_f32 v158, v158
    v_mfma_f32_16x16x32_bf16 v[132:135], v[204:207], v[188:191], v[132:135]
    buffer_load_dwordx4 v12, s[4:7], s22 offen offset:3072 sc1 lds
    ds_read_b128 v[204:207], v2 offset:27648
    v_cvt_pk_bf16_f32 v62, v156, v157
    v_mfma_f32_16x16x32_bf16 v[136:139], v[208:211], v[160:163], v[40:43]
    v_exp_f32 v159, v159
    v_mfma_f32_16x16x32_bf16 v[140:143], v[208:211], v[176:179], v[44:47]
    s_waitcnt lgkmcnt(5)
    ds_read_b128 v[208:211], v2 offset:28672
    v_mfma_f32_16x16x32_bf16 v[136:139], v[212:215], v[164:167], v[136:139]
    v_mfma_f32_16x16x32_bf16 v[140:143], v[212:215], v[180:183], v[140:143]
    ds_read_b128 v[212:215], v2 offset:29696
    v_cvt_pk_bf16_f32 v63, v158, v159
    v_mfma_f32_16x16x32_bf16 v[136:139], v[216:219], v[168:171], v[136:139]
    v_exp_f32 v128, v128
    v_mfma_f32_16x16x32_bf16 v[140:143], v[216:219], v[184:187], v[140:143]
    s_waitcnt lgkmcnt(4)
    ds_read_b128 v[216:219], v2 offset:30720
    s_add_u32 s22, s22, 32768
    s_add_u32 s23, s23, 32768
    s_and_b32 s23, s23, 131071
    v_mfma_f32_16x16x32_bf16 v[136:139], v[220:223], v[172:175], v[136:139]
    v_exp_f32 v129, v129
    v_mfma_f32_16x16x32_bf16 v[140:143], v[220:223], v[188:191], v[140:143]
    ds_read_b128 v[220:223], v2 offset:31744
    v_mfma_f32_16x16x32_bf16 v[64:67], v[192:195], v[56:59], v[64:67]
    v_exp_f32 v130, v130
    v_mfma_f32_16x16x32_bf16 v[68:71], v[192:195], v[60:63], v[68:71]
    ds_read_b128 v[192:195], v3 offset:16384
    v_cvt_pk_bf16_f32 v48, v128, v129
    v_mfma_f32_16x16x32_bf16 v[72:75], v[196:199], v[56:59], v[72:75]
    v_exp_f32 v131, v131
    v_mfma_f32_16x16x32_bf16 v[76:79], v[196:199], v[60:63], v[76:79]
    s_waitcnt lgkmcnt(5)
    ds_read_b128 v[196:199], v3 offset:17408
    v_mfma_f32_16x16x32_bf16 v[80:83], v[200:203], v[56:59], v[80:83]
    v_exp_f32 v132, v132
    v_mfma_f32_16x16x32_bf16 v[84:87], v[200:203], v[60:63], v[84:87]
    ds_read_b128 v[200:203], v3 offset:18432
    v_cvt_pk_bf16_f32 v49, v130, v131
    v_mfma_f32_16x16x32_bf16 v[88:91], v[204:207], v[56:59], v[88:91]
    v_exp_f32 v133, v133
    v_mfma_f32_16x16x32_bf16 v[92:95], v[204:207], v[60:63], v[92:95]
    s_waitcnt lgkmcnt(5)
    ds_read_b128 v[204:207], v3 offset:19456
    v_mfma_f32_16x16x32_bf16 v[96:99], v[208:211], v[56:59], v[96:99]
    v_exp_f32 v134, v134
    v_mfma_f32_16x16x32_bf16 v[100:103], v[208:211], v[60:63], v[100:103]
    ds_read_b128 v[208:211], v3 offset:20480
    v_cvt_pk_bf16_f32 v52, v132, v133
    v_mfma_f32_16x16x32_bf16 v[104:107], v[212:215], v[56:59], v[104:107]
    v_exp_f32 v135, v135
    v_mfma_f32_16x16x32_bf16 v[108:111], v[212:215], v[60:63], v[108:111]
    s_waitcnt lgkmcnt(5)
    ds_read_b128 v[212:215], v3 offset:21504
    v_mfma_f32_16x16x32_bf16 v[112:115], v[216:219], v[56:59], v[112:115]
    v_exp_f32 v136, v136
    v_mfma_f32_16x16x32_bf16 v[116:119], v[216:219], v[60:63], v[116:119]
    ds_read_b128 v[216:219], v3 offset:22528
    v_cvt_pk_bf16_f32 v53, v134, v135
    v_mfma_f32_16x16x32_bf16 v[120:123], v[220:223], v[56:59], v[120:123]
    v_exp_f32 v137, v137
    v_mfma_f32_16x16x32_bf16 v[124:127], v[220:223], v[60:63], v[124:127]
    s_waitcnt lgkmcnt(6)
    ds_read_b128 v[220:223], v3 offset:23552
    v_mfma_f32_16x16x32_bf16 v[20:23], v[16:19], v[56:59], v[20:23]
    v_exp_f32 v138, v138
    v_mfma_f32_16x16x32_bf16 v[24:27], v[16:19], v[60:63], v[24:27]
    v_cvt_pk_bf16_f32 v50, v136, v137
    v_xor_b32 v2, 65536, v2
    v_mfma_f32_16x16x32_bf16 v[144:147], v[192:195], v[160:163], v[32:35]
    v_exp_f32 v139, v139
    v_mfma_f32_16x16x32_bf16 v[148:151], v[192:195], v[176:179], v[36:39]
    s_waitcnt lgkmcnt(5)
    ds_read_b128 v[192:195], v3 offset:8192
    v_mfma_f32_16x16x32_bf16 v[144:147], v[196:199], v[164:167], v[144:147]
    v_exp_f32 v140, v140
    v_mfma_f32_16x16x32_bf16 v[148:151], v[196:199], v[180:183], v[148:151]
    ds_read_b128 v[196:199], v3 offset:9216
    v_cvt_pk_bf16_f32 v51, v138, v139
    v_mfma_f32_16x16x32_bf16 v[144:147], v[200:203], v[168:171], v[144:147]
    v_exp_f32 v141, v141
    v_mfma_f32_16x16x32_bf16 v[148:151], v[200:203], v[184:187], v[148:151]
    s_waitcnt lgkmcnt(5)
    ds_read_b128 v[200:203], v3 offset:10240
    v_mfma_f32_16x16x32_bf16 v[144:147], v[204:207], v[172:175], v[144:147]
    v_exp_f32 v142, v142
    v_mfma_f32_16x16x32_bf16 v[148:151], v[204:207], v[188:191], v[148:151]
    ds_read_b128 v[204:207], v3 offset:11264
    v_cvt_pk_bf16_f32 v54, v140, v141
    v_mfma_f32_16x16x32_bf16 v[152:155], v[208:211], v[160:163], v[40:43]
    v_exp_f32 v143, v143
    v_mfma_f32_16x16x32_bf16 v[156:159], v[208:211], v[176:179], v[44:47]
    s_waitcnt lgkmcnt(5)
    ds_read_b128 v[208:211], v3 offset:12288
    v_mfma_f32_16x16x32_bf16 v[152:155], v[212:215], v[164:167], v[152:155]
    v_mfma_f32_16x16x32_bf16 v[156:159], v[212:215], v[180:183], v[156:159]
    ds_read_b128 v[212:215], v3 offset:13312
    v_cvt_pk_bf16_f32 v55, v142, v143
    v_mfma_f32_16x16x32_bf16 v[152:155], v[216:219], v[168:171], v[152:155]
    v_exp_f32 v144, v144
    v_mfma_f32_16x16x32_bf16 v[156:159], v[216:219], v[184:187], v[156:159]
    s_waitcnt lgkmcnt(4)
    ds_read_b128 v[216:219], v3 offset:14336
    v_mfma_f32_16x16x32_bf16 v[152:155], v[220:223], v[172:175], v[152:155]
    v_exp_f32 v145, v145
    v_mfma_f32_16x16x32_bf16 v[156:159], v[220:223], v[188:191], v[156:159]
    ds_read_b128 v[220:223], v3 offset:15360
    v_mfma_f32_16x16x32_bf16 v[64:67], v[192:195], v[48:51], v[64:67]
    v_exp_f32 v146, v146
    v_mfma_f32_16x16x32_bf16 v[68:71], v[192:195], v[52:55], v[68:71]
    s_waitcnt vmcnt(8)
    s_barrier
    s_mov_b32 m0, s23
    ds_read_b128 v[192:195], v2 offset:0
    v_cvt_pk_bf16_f32 v56, v144, v145
    v_mfma_f32_16x16x32_bf16 v[72:75], v[196:199], v[48:51], v[72:75]
    v_exp_f32 v147, v147
    v_mfma_f32_16x16x32_bf16 v[76:79], v[196:199], v[52:55], v[76:79]
    s_waitcnt lgkmcnt(5)
    buffer_load_dwordx4 v11, s[4:7], s22 offen offset:0 sc1 lds
    ds_read_b128 v[196:199], v2 offset:1024
    v_mfma_f32_16x16x32_bf16 v[80:83], v[200:203], v[48:51], v[80:83]
    v_exp_f32 v148, v148
    v_mfma_f32_16x16x32_bf16 v[84:87], v[200:203], v[52:55], v[84:87]
    buffer_load_dwordx4 v11, s[4:7], s22 offen offset:1024 sc1 lds
    ds_read_b128 v[200:203], v2 offset:2048
    v_cvt_pk_bf16_f32 v57, v146, v147
    v_mfma_f32_16x16x32_bf16 v[88:91], v[204:207], v[48:51], v[88:91]
    v_exp_f32 v149, v149
    v_mfma_f32_16x16x32_bf16 v[92:95], v[204:207], v[52:55], v[92:95]
    s_waitcnt lgkmcnt(5)
    buffer_load_dwordx4 v11, s[4:7], s22 offen offset:2048 sc1 lds
    ds_read_b128 v[204:207], v2 offset:3072
    v_mfma_f32_16x16x32_bf16 v[96:99], v[208:211], v[48:51], v[96:99]
    v_exp_f32 v150, v150
    v_mfma_f32_16x16x32_bf16 v[100:103], v[208:211], v[52:55], v[100:103]
    buffer_load_dwordx4 v11, s[4:7], s22 offen offset:3072 sc1 lds
    ds_read_b128 v[208:211], v2 offset:4096
    s_add_u32 m0, s23, 4096
    v_cvt_pk_bf16_f32 v60, v148, v149
    v_mfma_f32_16x16x32_bf16 v[104:107], v[212:215], v[48:51], v[104:107]
    v_exp_f32 v151, v151
    v_mfma_f32_16x16x32_bf16 v[108:111], v[212:215], v[52:55], v[108:111]
    s_waitcnt lgkmcnt(5)
    ds_read_b128 v[212:215], v2 offset:5120
    v_mfma_f32_16x16x32_bf16 v[112:115], v[216:219], v[48:51], v[112:115]
    v_exp_f32 v152, v152
    v_mfma_f32_16x16x32_bf16 v[116:119], v[216:219], v[52:55], v[116:119]
    ds_read_b128 v[216:219], v2 offset:6144
    v_cvt_pk_bf16_f32 v61, v150, v151
    v_mfma_f32_16x16x32_bf16 v[120:123], v[220:223], v[48:51], v[120:123]
    v_exp_f32 v153, v153
    v_mfma_f32_16x16x32_bf16 v[124:127], v[220:223], v[52:55], v[124:127]
    s_waitcnt lgkmcnt(6)
    ds_read_b128 v[220:223], v2 offset:7168
    v_mfma_f32_16x16x32_bf16 v[20:23], v[16:19], v[48:51], v[20:23]
    v_exp_f32 v154, v154
    v_mfma_f32_16x16x32_bf16 v[24:27], v[16:19], v[52:55], v[24:27]
    v_cvt_pk_bf16_f32 v58, v152, v153
    v_mfma_f32_16x16x32_bf16 v[128:131], v[192:195], v[160:163], v[32:35]
    v_exp_f32 v155, v155
    v_mfma_f32_16x16x32_bf16 v[132:135], v[192:195], v[176:179], v[36:39]
    s_waitcnt lgkmcnt(5)
    buffer_load_dwordx4 v12, s[4:7], s22 offen offset:0 sc1 lds
    ds_read_b128 v[192:195], v3 offset:24576
    v_mfma_f32_16x16x32_bf16 v[128:131], v[196:199], v[164:167], v[128:131]
    v_exp_f32 v156, v156
    v_mfma_f32_16x16x32_bf16 v[132:135], v[196:199], v[180:183], v[132:135]
    buffer_load_dwordx4 v12, s[4:7], s22 offen offset:1024 sc1 lds
    ds_read_b128 v[196:199], v3 offset:25600
    v_cvt_pk_bf16_f32 v59, v154, v155
    v_mfma_f32_16x16x32_bf16 v[128:131], v[200:203], v[168:171], v[128:131]
    v_exp_f32 v157, v157
    v_mfma_f32_16x16x32_bf16 v[132:135], v[200:203], v[184:187], v[132:135]
    s_waitcnt lgkmcnt(5)
    buffer_load_dwordx4 v12, s[4:7], s22 offen offset:2048 sc1 lds
    ds_read_b128 v[200:203], v3 offset:26624
    v_mfma_f32_16x16x32_bf16 v[128:131], v[204:207], v[172:175], v[128:131]
    v_exp_f32 v158, v158
    v_mfma_f32_16x16x32_bf16 v[132:135], v[204:207], v[188:191], v[132:135]
    buffer_load_dwordx4 v12, s[4:7], s22 offen offset:3072 sc1 lds
    ds_read_b128 v[204:207], v3 offset:27648
    v_cvt_pk_bf16_f32 v62, v156, v157
    v_mfma_f32_16x16x32_bf16 v[136:139], v[208:211], v[160:163], v[40:43]
    v_exp_f32 v159, v159
    v_mfma_f32_16x16x32_bf16 v[140:143], v[208:211], v[176:179], v[44:47]
    s_waitcnt lgkmcnt(5)
    ds_read_b128 v[208:211], v3 offset:28672
    v_mfma_f32_16x16x32_bf16 v[136:139], v[212:215], v[164:167], v[136:139]
    v_mfma_f32_16x16x32_bf16 v[140:143], v[212:215], v[180:183], v[140:143]
    ds_read_b128 v[212:215], v3 offset:29696
    v_cvt_pk_bf16_f32 v63, v158, v159
    v_mfma_f32_16x16x32_bf16 v[136:139], v[216:219], v[168:171], v[136:139]
    v_exp_f32 v128, v128
    v_mfma_f32_16x16x32_bf16 v[140:143], v[216:219], v[184:187], v[140:143]
    s_waitcnt lgkmcnt(4)
    ds_read_b128 v[216:219], v3 offset:30720
    s_add_u32 s22, s22, 32768
    s_add_u32 s23, s23, 32768
    s_and_b32 s23, s23, 131071
    v_mfma_f32_16x16x32_bf16 v[136:139], v[220:223], v[172:175], v[136:139]
    v_exp_f32 v129, v129
    v_mfma_f32_16x16x32_bf16 v[140:143], v[220:223], v[188:191], v[140:143]
    ds_read_b128 v[220:223], v3 offset:31744
    v_mfma_f32_16x16x32_bf16 v[64:67], v[192:195], v[56:59], v[64:67]
    v_exp_f32 v130, v130
    v_mfma_f32_16x16x32_bf16 v[68:71], v[192:195], v[60:63], v[68:71]
    ds_read_b128 v[192:195], v2 offset:16384
    v_cvt_pk_bf16_f32 v48, v128, v129
    v_mfma_f32_16x16x32_bf16 v[72:75], v[196:199], v[56:59], v[72:75]
    v_exp_f32 v131, v131
    v_mfma_f32_16x16x32_bf16 v[76:79], v[196:199], v[60:63], v[76:79]
    s_waitcnt lgkmcnt(5)
    ds_read_b128 v[196:199], v2 offset:17408
    v_mfma_f32_16x16x32_bf16 v[80:83], v[200:203], v[56:59], v[80:83]
    v_exp_f32 v132, v132
    v_mfma_f32_16x16x32_bf16 v[84:87], v[200:203], v[60:63], v[84:87]
    ds_read_b128 v[200:203], v2 offset:18432
    v_cvt_pk_bf16_f32 v49, v130, v131
    v_mfma_f32_16x16x32_bf16 v[88:91], v[204:207], v[56:59], v[88:91]
    v_exp_f32 v133, v133
    v_mfma_f32_16x16x32_bf16 v[92:95], v[204:207], v[60:63], v[92:95]
    s_waitcnt lgkmcnt(5)
    ds_read_b128 v[204:207], v2 offset:19456
    v_mfma_f32_16x16x32_bf16 v[96:99], v[208:211], v[56:59], v[96:99]
    v_exp_f32 v134, v134
    v_mfma_f32_16x16x32_bf16 v[100:103], v[208:211], v[60:63], v[100:103]
    ds_read_b128 v[208:211], v2 offset:20480
    v_cvt_pk_bf16_f32 v52, v132, v133
    v_mfma_f32_16x16x32_bf16 v[104:107], v[212:215], v[56:59], v[104:107]
    v_exp_f32 v135, v135
    v_mfma_f32_16x16x32_bf16 v[108:111], v[212:215], v[60:63], v[108:111]
    s_waitcnt lgkmcnt(5)
    ds_read_b128 v[212:215], v2 offset:21504
    v_mfma_f32_16x16x32_bf16 v[112:115], v[216:219], v[56:59], v[112:115]
    v_exp_f32 v136, v136
    v_mfma_f32_16x16x32_bf16 v[116:119], v[216:219], v[60:63], v[116:119]
    ds_read_b128 v[216:219], v2 offset:22528
    v_cvt_pk_bf16_f32 v53, v134, v135
    v_mfma_f32_16x16x32_bf16 v[120:123], v[220:223], v[56:59], v[120:123]
    v_exp_f32 v137, v137
    v_mfma_f32_16x16x32_bf16 v[124:127], v[220:223], v[60:63], v[124:127]
    s_waitcnt lgkmcnt(6)
    ds_read_b128 v[220:223], v2 offset:23552
    v_mfma_f32_16x16x32_bf16 v[20:23], v[16:19], v[56:59], v[20:23]
    v_exp_f32 v138, v138
    v_mfma_f32_16x16x32_bf16 v[24:27], v[16:19], v[60:63], v[24:27]
    v_cvt_pk_bf16_f32 v50, v136, v137
    v_xor_b32 v3, 65536, v3
    s_sub_u32 s31, s31, 1
    s_cbranch_scc0 b_LOOP_L
b_FIXL_L:
    s_waitcnt vmcnt(8)
    s_lshl_b32 s25, s17, 2
    s_add_u32 s25, s25, s30
    s_add_u32 s25, s25, 32
    s_lshl_b32 s60, s25, 7
    s_lshl_b32 s61, s16, 2
    s_add_u32 s60, s60, s61
    v_and_b32 v30, 63, v0
    v_lshlrev_b32 v30, 16, v30
    v_mov_b32 v31, s63
    buffer_store_dword v31, v30, s[56:59], s60 offen sc1
    s_sub_u32 s20, s20, 1
b_LOOPF_L:
    v_mfma_f32_16x16x32_bf16 v[144:147], v[192:195], v[160:163], v[32:35]
    v_exp_f32 v139, v139
    v_mfma_f32_16x16x32_bf16 v[148:151], v[192:195], v[176:179], v[36:39]
    s_waitcnt lgkmcnt(5)
    ds_read_b128 v[192:195], v2 offset:8192
    v_mfma_f32_16x16x32_bf16 v[144:147], v[196:199], v[164:167], v[144:147]
    v_exp_f32 v140, v140
    v_mfma_f32_16x16x32_bf16 v[148:151], v[196:199], v[180:183], v[148:151]
    ds_read_b128 v[196:199], v2 offset:9216
    v_cvt_pk_bf16_f32 v51, v138, v139
    v_mfma_f32_16x16x32_bf16 v[144:147], v[200:203], v[168:171], v[144:147]
    v_exp_f32 v141, v141
    v_mfma_f32_16x16x32_bf16 v[148:151], v[200:203], v[184:187], v[148:151]
    s_waitcnt lgkmcnt(5)
    ds_read_b128 v[200:203], v2 offset:10240
    v_mfma_f32_16x16x32_bf16 v[144:147], v[204:207], v[172:175], v[144:147]
    v_exp_f32 v142, v142
    v_mfma_f32_16x16x32_bf16 v[148:151], v[204:207], v[188:191], v[148:151]
    ds_read_b128 v[204:207], v2 offset:11264
    v_cvt_pk_bf16_f32 v54, v140, v141
    v_mfma_f32_16x16x32_bf16 v[152:155], v[208:211], v[160:163], v[40:43]
    v_exp_f32 v143, v143
    v_mfma_f32_16x16x32_bf16 v[156:159], v[208:211], v[176:179], v[44:47]
    s_waitcnt lgkmcnt(5)
    ds_read_b128 v[208:211], v2 offset:12288
    v_mfma_f32_16x16x32_bf16 v[152:155], v[212:215], v[164:167], v[152:155]
    s_sub_u32 s21, s21, 1
    s_cbranch_scc1 b_FIX_L00
b_BACK_L00:
    v_mfma_f32_16x16x32_bf16 v[156:159], v[212:215], v[180:183], v[156:159]
    ds_read_b128 v[212:215], v2 offset:13312
    v_cvt_pk_bf16_f32 v55, v142, v143
    v_mfma_f32_16x16x32_bf16 v[152:155], v[216:219], v[168:171], v[152:155]
    v_exp_f32 v144, v144
    v_mfma_f32_16x16x32_bf16 v[156:159], v[216:219], v[184:187], v[156:159]
    s_waitcnt lgkmcnt(4)
    ds_read_b128 v[216:219], v2 offset:14336
    v_mfma_f32_16x16x32_bf16 v[152:155], v[220:223], v[172:175], v[152:155]
    v_exp_f32 v145, v145
    v_mfma_f32_16x16x32_bf16 v[156:159], v[220:223], v[188:191], v[156:159]
    ds_read_b128 v[220:223], v2 offset:15360
    v_mfma_f32_16x16x32_bf16 v[64:67], v[192:195], v[48:51], v[64:67]
    v_exp_f32 v146, v146
    v_mfma_f32_16x16x32_bf16 v[68:71], v[192:195], v[52:55], v[68:71]
    s_waitcnt vmcnt(8)
    s_barrier
    s_mov_b32 m0, s23
    ds_read_b128 v[192:195], v3 offset:0
    v_cvt_pk_bf16_f32 v56, v144, v145
    v_mfma_f32_16x16x32_bf16 v[72:75], v[196:199], v[48:51], v[72:75]
    v_exp_f32 v147, v147
    v_mfma_f32_16x16x32_bf16 v[76:79], v[196:199], v[52:55], v[76:79]
    s_waitcnt lgkmcnt(5)
    buffer_load_dwordx4 v11, s[4:7], s22 offen offset:0 sc1 lds
    ds_read_b128 v[196:199], v3 offset:1024
    v_mfma_f32_16x16x32_bf16 v[80:83], v[200:203], v[48:51], v[80:83]
    v_exp_f32 v148, v148
    v_mfma_f32_16x16x32_bf16 v[84:87], v[200:203], v[52:55], v[84:87]
    buffer_load_dwordx4 v11, s[4:7], s22 offen offset:1024 sc1 lds
    ds_read_b128 v[200:203], v3 offset:2048
    v_cvt_pk_bf16_f32 v57, v146, v147
    v_mfma_f32_16x16x32_bf16 v[88:91], v[204:207], v[48:51], v[88:91]
    v_exp_f32 v149, v149
    v_mfma_f32_16x16x32_bf16 v[92:95], v[204:207], v[52:55], v[92:95]
    s_waitcnt lgkmcnt(5)
    buffer_load_dwordx4 v11, s[4:7], s22 offen offset:2048 sc1 lds
    ds_read_b128 v[204:207], v3 offset:3072
    v_mfma_f32_16x16x32_bf16 v[96:99], v[208:211], v[48:51], v[96:99]
    v_exp_f32 v150, v150
    v_mfma_f32_16x16x32_bf16 v[100:103], v[208:211], v[52:55], v[100:103]
    buffer_load_dwordx4 v11, s[4:7], s22 offen offset:3072 sc1 lds
    ds_read_b128 v[208:211], v3 offset:4096
    s_add_u32 m0, s23, 4096
    v_cvt_pk_bf16_f32 v60, v148, v149
    v_mfma_f32_16x16x32_bf16 v[104:107], v[212:215], v[48:51], v[104:107]
    v_exp_f32 v151, v151
    v_mfma_f32_16x16x32_bf16 v[108:111], v[212:215], v[52:55], v[108:111]
    s_waitcnt lgkmcnt(5)
    ds_read_b128 v[212:215], v3 offset:5120
    v_mfma_f32_16x16x32_bf16 v[112:115], v[216:219], v[48:51], v[112:115]
    v_exp_f32 v152, v152
    v_mfma_f32_16x16x32_bf16 v[116:119], v[216:219], v[52:55], v[116:119]
    ds_read_b128 v[216:219], v3 offset:6144
    v_cvt_pk_bf16_f32 v61, v150, v151
    v_mfma_f32_16x16x32_bf16 v[120:123], v[220:223], v[48:51], v[120:123]
    v_exp_f32 v153, v153
    v_mfma_f32_16x16x32_bf16 v[124:127], v[220:223], v[52:55], v[124:127]
    s_waitcnt lgkmcnt(6)
    ds_read_b128 v[220:223], v3 offset:7168
    v_mfma_f32_16x16x32_bf16 v[20:23], v[16:19], v[48:51], v[20:23]
    v_exp_f32 v154, v154
    v_mfma_f32_16x16x32_bf16 v[24:27], v[16:19], v[52:55], v[24:27]
    v_cvt_pk_bf16_f32 v58, v152, v153
    v_mfma_f32_16x16x32_bf16 v[128:131], v[192:195], v[160:163], v[32:35]
    v_exp_f32 v155, v155
    v_mfma_f32_16x16x32_bf16 v[132:135], v[192:195], v[176:179], v[36:39]
    s_waitcnt lgkmcnt(5)
    buffer_load_dwordx4 v12, s[4:7], s22 offen offset:0 sc1 lds
    ds_read_b128 v[192:195], v2 offset:24576
    v_mfma_f32_16x16x32_bf16 v[128:131], v[196:199], v[164:167], v[128:131]
    v_exp_f32 v156, v156
    v_mfma_f32_16x16x32_bf16 v[132:135], v[196:199], v[180:183], v[132:135]
    buffer_load_dwordx4 v12, s[4:7], s22 offen offset:1024 sc1 lds
    ds_read_b128 v[196:199], v2 offset:25600
    v_cvt_pk_bf16_f32 v59, v154, v155
    v_mfma_f32_16x16x32_bf16 v[128:131], v[200:203], v[168:171], v[128:131]
    v_exp_f32 v157, v157
    v_mfma_f32_16x16x32_bf16 v[132:135], v[200:203], v[184:187], v[132:135]
    s_waitcnt lgkmcnt(5)
    buffer_load_dwordx4 v12, s[4:7], s22 offen offset:2048 sc1 lds
    ds_read_b128 v[200:203], v2 offset:26624
    v_mfma_f32_16x16x32_bf16 v[128:131], v[204:207], v[172:175], v[128:131]
    v_exp_f32 v158, v158
    v_mfma_f32_16x16x32_bf16 v[132:135], v[204:207], v[188:191], v[132:135]
    buffer_load_dwordx4 v12, s[4:7], s22 offen offset:3072 sc1 lds
    ds_read_b128 v[204:207], v2 offset:27648
    v_cvt_pk_bf16_f32 v62, v156, v157
    v_mfma_f32_16x16x32_bf16 v[136:139], v[208:211], v[160:163], v[40:43]
    v_exp_f32 v159, v159
    v_mfma_f32_16x16x32_bf16 v[140:143], v[208:211], v[176:179], v[44:47]
    s_waitcnt lgkmcnt(5)
    ds_read_b128 v[208:211], v2 offset:28672
    v_mfma_f32_16x16x32_bf16 v[136:139], v[212:215], v[164:167], v[136:139]
    s_sub_u32 s21, s21, 1
    s_cbranch_scc1 b_FIX_L01
b_BACK_L01:
    v_mfma_f32_16x16x32_bf16 v[140:143], v[212:215], v[180:183], v[140:143]
    ds_read_b128 v[212:215], v2 offset:29696
    v_cvt_pk_bf16_f32 v63, v158, v159
    v_mfma_f32_16x16x32_bf16 v[136:139], v[216:219], v[168:171], v[136:139]
    v_exp_f32 v128, v128
    v_mfma_f32_16x16x32_bf16 v[140:143], v[216:219], v[184:187], v[140:143]
    s_waitcnt lgkmcnt(4)
    ds_read_b128 v[216:219], v2 offset:30720
    s_add_u32 s22, s22, 32768
    s_add_u32 s23, s23, 32768
    s_and_b32 s23, s23, 131071
    v_mfma_f32_16x16x32_bf16 v[136:139], v[220:223], v[172:175], v[136:139]
    v_exp_f32 v129, v129
    v_mfma_f32_16x16x32_bf16 v[140:143], v[220:223], v[188:191], v[140:143]
    ds_read_b128 v[220:223], v2 offset:31744
    v_mfma_f32_16x16x32_bf16 v[64:67], v[192:195], v[56:59], v[64:67]
    v_exp_f32 v130, v130
    v_mfma_f32_16x16x32_bf16 v[68:71], v[192:195], v[60:63], v[68:71]
    ds_read_b128 v[192:195], v3 offset:16384
    v_cvt_pk_bf16_f32 v48, v128, v129
    v_mfma_f32_16x16x32_bf16 v[72:75], v[196:199], v[56:59], v[72:75]
    v_exp_f32 v131, v131
    v_mfma_f32_16x16x32_bf16 v[76:79], v[196:199], v[60:63], v[76:79]
    s_waitcnt lgkmcnt(5)
    ds_read_b128 v[196:199], v3 offset:17408
    v_mfma_f32_16x16x32_bf16 v[80:83], v[200:203], v[56:59], v[80:83]
    v_exp_f32 v132, v132
    v_mfma_f32_16x16x32_bf16 v[84:87], v[200:203], v[60:63], v[84:87]
    ds_read_b128 v[200:203], v3 offset:18432
    v_cvt_pk_bf16_f32 v49, v130, v131
    v_mfma_f32_16x16x32_bf16 v[88:91], v[204:207], v[56:59], v[88:91]
    v_exp_f32 v133, v133
    v_mfma_f32_16x16x32_bf16 v[92:95], v[204:207], v[60:63], v[92:95]
    s_waitcnt lgkmcnt(5)
    ds_read_b128 v[204:207], v3 offset:19456
    v_mfma_f32_16x16x32_bf16 v[96:99], v[208:211], v[56:59], v[96:99]
    v_exp_f32 v134, v134
    v_mfma_f32_16x16x32_bf16 v[100:103], v[208:211], v[60:63], v[100:103]
    ds_read_b128 v[208:211], v3 offset:20480
    v_cvt_pk_bf16_f32 v52, v132, v133
    v_mfma_f32_16x16x32_bf16 v[104:107], v[212:215], v[56:59], v[104:107]
    v_exp_f32 v135, v135
    v_mfma_f32_16x16x32_bf16 v[108:111], v[212:215], v[60:63], v[108:111]
    s_waitcnt lgkmcnt(5)
    ds_read_b128 v[212:215], v3 offset:21504
    v_mfma_f32_16x16x32_bf16 v[112:115], v[216:219], v[56:59], v[112:115]
    v_exp_f32 v136, v136
    v_mfma_f32_16x16x32_bf16 v[116:119], v[216:219], v[60:63], v[116:119]
    ds_read_b128 v[216:219], v3 offset:22528
    v_cvt_pk_bf16_f32 v53, v134, v135
    v_mfma_f32_16x16x32_bf16 v[120:123], v[220:223], v[56:59], v[120:123]
    v_exp_f32 v137, v137
    v_mfma_f32_16x16x32_bf16 v[124:127], v[220:223], v[60:63], v[124:127]
    s_waitcnt lgkmcnt(6)
    ds_read_b128 v[220:223], v3 offset:23552
    v_mfma_f32_16x16x32_bf16 v[20:23], v[16:19], v[56:59], v[20:23]
    v_exp_f32 v138, v138
    v_mfma_f32_16x16x32_bf16 v[24:27], v[16:19], v[60:63], v[24:27]
    v_cvt_pk_bf16_f32 v50, v136, v137
    v_xor_b32 v2, 65536, v2
    v_mfma_f32_16x16x32_bf16 v[144:147], v[192:195], v[160:163], v[32:35]
    v_exp_f32 v139, v139
    v_mfma_f32_16x16x32_bf16 v[148:151], v[192:195], v[176:179], v[36:39]
    s_waitcnt lgkmcnt(5)
    ds_read_b128 v[192:195], v3 offset:8192
    v_mfma_f32_16x16x32_bf16 v[144:147], v[196:199], v[164:167], v[144:147]
    v_exp_f32 v140, v140
    v_mfma_f32_16x16x32_bf16 v[148:151], v[196:199], v[180:183], v[148:151]
    ds_read_b128 v[196:199], v3 offset:9216
    v_cvt_pk_bf16_f32 v51, v138, v139
    v_mfma_f32_16x16x32_bf16 v[144:147], v[200:203], v[168:171], v[144:147]
    v_exp_f32 v141, v141
    v_mfma_f32_16x16x32_bf16 v[148:151], v[200:203], v[184:187], v[148:151]
    s_waitcnt lgkmcnt(5)
    ds_read_b128 v[200:203], v3 offset:10240
    v_mfma_f32_16x16x32_bf16 v[144:147], v[204:207], v[172:175], v[144:147]
    v_exp_f32 v142, v142
    v_mfma_f32_16x16x32_bf16 v[148:151], v[204:207], v[188:191], v[148:151]
    ds_read_b128 v[204:207], v3 offset:11264
    v_cvt_pk_bf16_f32 v54, v140, v141
    v_mfma_f32_16x16x32_bf16 v[152:155], v[208:211], v[160:163], v[40:43]
    v_exp_f32 v143, v143
    v_mfma_f32_16x16x32_bf16 v[156:159], v[208:211], v[176:179], v[44:47]
    s_waitcnt lgkmcnt(5)
    ds_read_b128 v[208:211], v3 offset:12288
    v_mfma_f32_16x16x32_bf16 v[152:155], v[212:215], v[164:167], v[152:155]
    s_sub_u32 s21, s21, 1
    s_cbranch_scc1 b_FIX_L10
b_BACK_L10:
    v_mfma_f32_16x16x32_bf16 v[156:159], v[212:215], v[180:183], v[156:159]
    ds_read_b128 v[212:215], v3 offset:13312
    v_cvt_pk_bf16_f32 v55, v142, v143
    v_mfma_f32_16x16x32_bf16 v[152:155], v[216:219], v[168:171], v[152:155]
    v_exp_f32 v144, v144
    v_mfma_f32_16x16x32_bf16 v[156:159], v[216:219], v[184:187], v[156:159]
    s_waitcnt lgkmcnt(4)
    ds_read_b128 v[216:219], v3 offset:14336
    v_mfma_f32_16x16x32_bf16 v[152:155], v[220:223], v[172:175], v[152:155]
    v_exp_f32 v145, v145
    v_mfma_f32_16x16x32_bf16 v[156:159], v[220:223], v[188:191], v[156:159]
    ds_read_b128 v[220:223], v3 offset:15360
    v_mfma_f32_16x16x32_bf16 v[64:67], v[192:195], v[48:51], v[64:67]
    v_exp_f32 v146, v146
    v_mfma_f32_16x16x32_bf16 v[68:71], v[192:195], v[52:55], v[68:71]
    s_waitcnt vmcnt(8)
    s_barrier
    s_mov_b32 m0, s23
    ds_read_b128 v[192:195], v2 offset:0
    v_cvt_pk_bf16_f32 v56, v144, v145
    v_mfma_f32_16x16x32_bf16 v[72:75], v[196:199], v[48:51], v[72:75]
    v_exp_f32 v147, v147
    v_mfma_f32_16x16x32_bf16 v[76:79], v[196:199], v[52:55], v[76:79]
    s_waitcnt lgkmcnt(5)
    buffer_load_dwordx4 v11, s[4:7], s22 offen offset:0 sc1 lds
    ds_read_b128 v[196:199], v2 offset:1024
    v_mfma_f32_16x16x32_bf16 v[80:83], v[200:203], v[48:51], v[80:83]
    v_exp_f32 v148, v148
    v_mfma_f32_16x16x32_bf16 v[84:87], v[200:203], v[52:55], v[84:87]
    buffer_load_dwordx4 v11, s[4:7], s22 offen offset:1024 sc1 lds
    ds_read_b128 v[200:203], v2 offset:2048
    v_cvt_pk_bf16_f32 v57, v146, v147
    v_mfma_f32_16x16x32_bf16 v[88:91], v[204:207], v[48:51], v[88:91]
    v_exp_f32 v149, v149
    v_mfma_f32_16x16x32_bf16 v[92:95], v[204:207], v[52:55], v[92:95]
    s_waitcnt lgkmcnt(5)
    buffer_load_dwordx4 v11, s[4:7], s22 offen offset:2048 sc1 lds
    ds_read_b128 v[204:207], v2 offset:3072
    v_mfma_f32_16x16x32_bf16 v[96:99], v[208:211], v[48:51], v[96:99]
    v_exp_f32 v150, v150
    v_mfma_f32_16x16x32_bf16 v[100:103], v[208:211], v[52:55], v[100:103]
    buffer_load_dwordx4 v11, s[4:7], s22 offen offset:3072 sc1 lds
    ds_read_b128 v[208:211], v2 offset:4096
    s_add_u32 m0, s23, 4096
    v_cvt_pk_bf16_f32 v60, v148, v149
    v_mfma_f32_16x16x32_bf16 v[104:107], v[212:215], v[48:51], v[104:107]
    v_exp_f32 v151, v151
    v_mfma_f32_16x16x32_bf16 v[108:111], v[212:215], v[52:55], v[108:111]
    s_waitcnt lgkmcnt(5)
    ds_read_b128 v[212:215], v2 offset:5120
    v_mfma_f32_16x16x32_bf16 v[112:115], v[216:219], v[48:51], v[112:115]
    v_exp_f32 v152, v152
    v_mfma_f32_16x16x32_bf16 v[116:119], v[216:219], v[52:55], v[116:119]
    ds_read_b128 v[216:219], v2 offset:6144
    v_cvt_pk_bf16_f32 v61, v150, v151
    v_mfma_f32_16x16x32_bf16 v[120:123], v[220:223], v[48:51], v[120:123]
    v_exp_f32 v153, v153
    v_mfma_f32_16x16x32_bf16 v[124:127], v[220:223], v[52:55], v[124:127]
    s_waitcnt lgkmcnt(6)
    ds_read_b128 v[220:223], v2 offset:7168
    v_mfma_f32_16x16x32_bf16 v[20:23], v[16:19], v[48:51], v[20:23]
    v_exp_f32 v154, v154
    v_mfma_f32_16x16x32_bf16 v[24:27], v[16:19], v[52:55], v[24:27]
    v_cvt_pk_bf16_f32 v58, v152, v153
    v_mfma_f32_16x16x32_bf16 v[128:131], v[192:195], v[160:163], v[32:35]
    v_exp_f32 v155, v155
    v_mfma_f32_16x16x32_bf16 v[132:135], v[192:195], v[176:179], v[36:39]
    s_waitcnt lgkmcnt(5)
    buffer_load_dwordx4 v12, s[4:7], s22 offen offset:0 sc1 lds
    ds_read_b128 v[192:195], v3 offset:24576
    v_mfma_f32_16x16x32_bf16 v[128:131], v[196:199], v[164:167], v[128:131]
    v_exp_f32 v156, v156
    v_mfma_f32_16x16x32_bf16 v[132:135], v[196:199], v[180:183], v[132:135]
    buffer_load_dwordx4 v12, s[4:7], s22 offen offset:1024 sc1 lds
    ds_read_b128 v[196:199], v3 offset:25600
    v_cvt_pk_bf16_f32 v59, v154, v155
    v_mfma_f32_16x16x32_bf16 v[128:131], v[200:203], v[168:171], v[128:131]
    v_exp_f32 v157, v157
    v_mfma_f32_16x16x32_bf16 v[132:135], v[200:203], v[184:187], v[132:135]
    s_waitcnt lgkmcnt(5)
    buffer_load_dwordx4 v12, s[4:7], s22 offen offset:2048 sc1 lds
    ds_read_b128 v[200:203], v3 offset:26624
    v_mfma_f32_16x16x32_bf16 v[128:131], v[204:207], v[172:175], v[128:131]
    v_exp_f32 v158, v158
    v_mfma_f32_16x16x32_bf16 v[132:135], v[204:207], v[188:191], v[132:135]
    buffer_load_dwordx4 v12, s[4:7], s22 offen offset:3072 sc1 lds
    ds_read_b128 v[204:207], v3 offset:27648
    v_cvt_pk_bf16_f32 v62, v156, v157
    v_mfma_f32_16x16x32_bf16 v[136:139], v[208:211], v[160:163], v[40:43]
    v_exp_f32 v159, v159
    v_mfma_f32_16x16x32_bf16 v[140:143], v[208:211], v[176:179], v[44:47]
    s_waitcnt lgkmcnt(5)
    ds_read_b128 v[208:211], v3 offset:28672
    v_mfma_f32_16x16x32_bf16 v[136:139], v[212:215], v[164:167], v[136:139]
    s_sub_u32 s21, s21, 1
    s_cbranch_scc1 b_FIX_L11
b_BACK_L11:
    v_mfma_f32_16x16x32_bf16 v[140:143], v[212:215], v[180:183], v[140:143]
    ds_read_b128 v[212:215], v3 offset:29696
    v_cvt_pk_bf16_f32 v63, v158, v159
    v_mfma_f32_16x16x32_bf16 v[136:139], v[216:219], v[168:171], v[136:139]
    v_exp_f32 v128, v128
    v_mfma_f32_16x16x32_bf16 v[140:143], v[216:219], v[184:187], v[140:143]
    s_waitcnt lgkmcnt(4)
    ds_read_b128 v[216:219], v3 offset:30720
    s_add_u32 s22, s22, 32768
    s_add_u32 s23, s23, 32768
    s_and_b32 s23, s23, 131071
    v_mfma_f32_16x16x32_bf16 v[136:139], v[220:223], v[172:175], v[136:139]
    v_exp_f32 v129, v129
    v_mfma_f32_16x16x32_bf16 v[140:143], v[220:223], v[188:191], v[140:143]
    ds_read_b128 v[220:223], v3 offset:31744
    v_mfma_f32_16x16x32_bf16 v[64:67], v[192:195], v[56:59], v[64:67]
    v_exp_f32 v130, v130
    v_mfma_f32_16x16x32_bf16 v[68:71], v[192:195], v[60:63], v[68:71]
    ds_read_b128 v[192:195], v2 offset:16384
    v_cvt_pk_bf16_f32 v48, v128, v129
    v_mfma_f32_16x16x32_bf16 v[72:75], v[196:199], v[56:59], v[72:75]
    v_exp_f32 v131, v131
    v_mfma_f32_16x16x32_bf16 v[76:79], v[196:199], v[60:63], v[76:79]
    s_waitcnt lgkmcnt(5)
    ds_read_b128 v[196:199], v2 offset:17408
    v_mfma_f32_16x16x32_bf16 v[80:83], v[200:203], v[56:59], v[80:83]
    v_exp_f32 v132, v132
    v_mfma_f32_16x16x32_bf16 v[84:87], v[200:203], v[60:63], v[84:87]
    ds_read_b128 v[200:203], v2 offset:18432
    v_cvt_pk_bf16_f32 v49, v130, v131
    v_mfma_f32_16x16x32_bf16 v[88:91], v[204:207], v[56:59], v[88:91]
    v_exp_f32 v133, v133
    v_mfma_f32_16x16x32_bf16 v[92:95], v[204:207], v[60:63], v[92:95]
    s_waitcnt lgkmcnt(5)
    ds_read_b128 v[204:207], v2 offset:19456
    v_mfma_f32_16x16x32_bf16 v[96:99], v[208:211], v[56:59], v[96:99]
    v_exp_f32 v134, v134
    v_mfma_f32_16x16x32_bf16 v[100:103], v[208:211], v[60:63], v[100:103]
    ds_read_b128 v[208:211], v2 offset:20480
    v_cvt_pk_bf16_f32 v52, v132, v133
    v_mfma_f32_16x16x32_bf16 v[104:107], v[212:215], v[56:59], v[104:107]
    v_exp_f32 v135, v135
    v_mfma_f32_16x16x32_bf16 v[108:111], v[212:215], v[60:63], v[108:111]
    s_waitcnt lgkmcnt(5)
    ds_read_b128 v[212:215], v2 offset:21504
    v_mfma_f32_16x16x32_bf16 v[112:115], v[216:219], v[56:59], v[112:115]
    v_exp_f32 v136, v136
    v_mfma_f32_16x16x32_bf16 v[116:119], v[216:219], v[60:63], v[116:119]
    ds_read_b128 v[216:219], v2 offset:22528
    v_cvt_pk_bf16_f32 v53, v134, v135
    v_mfma_f32_16x16x32_bf16 v[120:123], v[220:223], v[56:59], v[120:123]
    v_exp_f32 v137, v137
    v_mfma_f32_16x16x32_bf16 v[124:127], v[220:223], v[60:63], v[124:127]
    s_waitcnt lgkmcnt(6)
    ds_read_b128 v[220:223], v2 offset:23552
    v_mfma_f32_16x16x32_bf16 v[20:23], v[16:19], v[56:59], v[20:23]
    v_exp_f32 v138, v138
    v_mfma_f32_16x16x32_bf16 v[24:27], v[16:19], v[60:63], v[24:27]
    v_cvt_pk_bf16_f32 v50, v136, v137
    v_xor_b32 v3, 65536, v3
    s_sub_u32 s20, s20, 1
    s_cbranch_scc0 b_LOOPF_L
    s_waitcnt vmcnt(8)
    s_barrier
    s_mov_b32 m0, s23
    s_nop 0
    buffer_load_dwordx4 v11, s[4:7], s22 offen offset:0 sc1 lds
    buffer_load_dwordx4 v11, s[4:7], s22 offen offset:1024 sc1 lds
    buffer_load_dwordx4 v11, s[4:7], s22 offen offset:2048 sc1 lds
    buffer_load_dwordx4 v11, s[4:7], s22 offen offset:3072 sc1 lds
    s_add_u32 m0, s23, 4096
    s_nop 0
    buffer_load_dwordx4 v12, s[4:7], s22 offen offset:0 sc1 lds
    buffer_load_dwordx4 v12, s[4:7], s22 offen offset:1024 sc1 lds
    buffer_load_dwordx4 v12, s[4:7], s22 offen offset:2048 sc1 lds
    buffer_load_dwordx4 v12, s[4:7], s22 offen offset:3072 sc1 lds
    s_add_u32 s22, s22, 32768
    s_add_u32 s23, s23, 32768
    s_and_b32 s23, s23, 131071
    s_sub_u32 s28, s28, 1
b_EPI:
    s_waitcnt lgkmcnt(0)
    v_mov_b32 v8, s29
    s_nop 4
    v_cmp_nlt_f32 vcc, v20, v8
    v_cmp_nlt_f32 s[38:39], v24, v8
    s_nop 1
    s_or_b64 vcc, vcc, s[38:39]
    s_nop 4
    s_cbranch_vccnz b_SETFAIL
    v_rcp_f32 v7, v20
    v_rcp_f32 v8, v24
    s_lshl_b32 s27, s19, 5
    s_add_u32 s27, s27, s16
    s_lshl_b32 s27, s27, 13
    v_mul_f32 v64, v7, v64
    v_mul_f32 v65, v7, v65
    v_mul_f32 v66, v7, v66
    v_mul_f32 v67, v7, v67
    v_cvt_pk_bf16_f32 v128, v64, v65
    v_cvt_pk_bf16_f32 v129, v66, v67
    v_mul_f32 v72, v7, v72
    v_mul_f32 v73, v7, v73
    v_mul_f32 v74, v7, v74
    v_mul_f32 v75, v7, v75
    v_cvt_pk_bf16_f32 v130, v72, v73
    v_cvt_pk_bf16_f32 v131, v74, v75
    buffer_store_dwordx4 v[128:131], v1, s[12:15], s27 offen offset:0 sc1
    v_mul_f32 v80, v7, v80
    v_mul_f32 v81, v7, v81
    v_mul_f32 v82, v7, v82
    v_mul_f32 v83, v7, v83
    v_cvt_pk_bf16_f32 v132, v80, v81
    v_cvt_pk_bf16_f32 v133, v82, v83
    v_mul_f32 v88, v7, v88
    v_mul_f32 v89, v7, v89
    v_mul_f32 v90, v7, v90
    v_mul_f32 v91, v7, v91
    v_cvt_pk_bf16_f32 v134, v88, v89
    v_cvt_pk_bf16_f32 v135, v90, v91
    buffer_store_dwordx4 v[132:135], v1, s[12:15], s27 offen offset:1024 sc1
    v_mul_f32 v96, v7, v96
    v_mul_f32 v97, v7, v97
    v_mul_f32 v98, v7, v98
    v_mul_f32 v99, v7, v99
    v_cvt_pk_bf16_f32 v136, v96, v97
    v_cvt_pk_bf16_f32 v137, v98, v99
    v_mul_f32 v104, v7, v104
    v_mul_f32 v105, v7, v105
    v_mul_f32 v106, v7, v106
    v_mul_f32 v107, v7, v107
    v_cvt_pk_bf16_f32 v138, v104, v105
    v_cvt_pk_bf16_f32 v139, v106, v107
    buffer_store_dwordx4 v[136:139], v1, s[12:15], s27 offen offset:2048 sc1
    v_mul_f32 v112, v7, v112
    v_mul_f32 v113, v7, v113
    v_mul_f32 v114, v7, v114
    v_mul_f32 v115, v7, v115
    v_cvt_pk_bf16_f32 v140, v112, v113
    v_cvt_pk_bf16_f32 v141, v114, v115
    v_mul_f32 v120, v7, v120
    v_mul_f32 v121, v7, v121
    v_mul_f32 v122, v7, v122
    v_mul_f32 v123, v7, v123
    v_cvt_pk_bf16_f32 v142, v120, v121
    v_cvt_pk_bf16_f32 v143, v122, v123
    buffer_store_dwordx4 v[140:143], v1, s[12:15], s27 offen offset:3072 sc1
    v_mul_f32 v68, v8, v68
    v_mul_f32 v69, v8, v69
    v_mul_f32 v70, v8, v70
    v_mul_f32 v71, v8, v71
    v_cvt_pk_bf16_f32 v144, v68, v69
    v_cvt_pk_bf16_f32 v145, v70, v71
    v_mul_f32 v76, v8, v76
    v_mul_f32 v77, v8, v77
    v_mul_f32 v78, v8, v78
    v_mul_f32 v79, v8, v79
    v_cvt_pk_bf16_f32 v146, v76, v77
    v_cvt_pk_bf16_f32 v147, v78, v79
    s_add_u32 s27, s27, 4096
    buffer_store_dwordx4 v[144:147], v1, s[12:15], s27 offen offset:0 sc1
    v_mul_f32 v84, v8, v84
    v_mul_f32 v85, v8, v85
    v_mul_f32 v86, v8, v86
    v_mul_f32 v87, v8, v87
    v_cvt_pk_bf16_f32 v148, v84, v85
    v_cvt_pk_bf16_f32 v149, v86, v87
    v_mul_f32 v92, v8, v92
    v_mul_f32 v93, v8, v93
    v_mul_f32 v94, v8, v94
    v_mul_f32 v95, v8, v95
    v_cvt_pk_bf16_f32 v150, v92, v93
    v_cvt_pk_bf16_f32 v151, v94, v95
    buffer_store_dwordx4 v[148:151], v1, s[12:15], s27 offen offset:1024 sc1
    v_mul_f32 v100, v8, v100
    v_mul_f32 v101, v8, v101
    v_mul_f32 v102, v8, v102
    v_mul_f32 v103, v8, v103
    v_cvt_pk_bf16_f32 v152, v100, v101
    v_cvt_pk_bf16_f32 v153, v102, v103
    v_mul_f32 v108, v8, v108
    v_mul_f32 v109, v8, v109
    v_mul_f32 v110, v8, v110
    v_mul_f32 v111, v8, v111
    v_cvt_pk_bf16_f32 v154, v108, v109
    v_cvt_pk_bf16_f32 v155, v110, v111
    buffer_store_dwordx4 v[152:155], v1, s[12:15], s27 offen offset:2048 sc1
    v_mul_f32 v116, v8, v116
    v_mul_f32 v117, v8, v117
    v_mul_f32 v118, v8, v118
    v_mul_f32 v119, v8, v119
    v_cvt_pk_bf16_f32 v156, v116, v117
    v_cvt_pk_bf16_f32 v157, v118, v119
    v_mul_f32 v124, v8, v124
    v_mul_f32 v125, v8, v125
    v_mul_f32 v126, v8, v126
    v_mul_f32 v127, v8, v127
    v_cvt_pk_bf16_f32 v158, v124, v125
    v_cvt_pk_bf16_f32 v159, v126, v127
    buffer_store_dwordx4 v[156:159], v1, s[12:15], s27 offen offset:3072 sc1
b_FAILBACK:
    s_cmp_ge_u32 s18, 4
    s_cbranch_scc0 b_DONE
    s_cmp_eq_u32 s28, 0
    s_cbranch_scc1 b_DONE
b_LOADER:
    s_waitcnt vmcnt(8)
    s_barrier
    s_mov_b32 m0, s23
    s_nop 0
    buffer_load_dwordx4 v11, s[4:7], s22 offen offset:0 sc1 lds
    buffer_load_dwordx4 v11, s[4:7], s22 offen offset:1024 sc1 lds
    buffer_load_dwordx4 v11, s[4:7], s22 offen offset:2048 sc1 lds
    buffer_load_dwordx4 v11, s[4:7], s22 offen offset:3072 sc1 lds
    s_add_u32 m0, s23, 4096
    s_nop 0
    buffer_load_dwordx4 v12, s[4:7], s22 offen offset:0 sc1 lds
    buffer_load_dwordx4 v12, s[4:7], s22 offen offset:1024 sc1 lds
    buffer_load_dwordx4 v12, s[4:7], s22 offen offset:2048 sc1 lds
    buffer_load_dwordx4 v12, s[4:7], s22 offen offset:3072 sc1 lds
    s_add_u32 s22, s22, 32768
    s_add_u32 s23, s23, 32768
    s_and_b32 s23, s23, 131071
    s_sub_u32 s28, s28, 1
    s_cmp_lg_u32 s28, 0
    s_cbranch_scc1 b_LOADER
b_DONE:
    s_cmp_eq_u32 s18, 4
    s_cbranch_scc0 b_DONE_A
    s_add_u32 s25, s16, 32
    v_and_b32 v30, 31, v0
    v_lshlrev_b32 v30, 2, v30
    s_lshl_b32 s62, s25, 7
    s_mov_b32 s61, 0
b_W_A:
    buffer_load_dword v31, v30, s[56:59], s62 offen sc1
    s_waitcnt vmcnt(0)
    v_cmp_ne_u32 vcc, s63, v31
    s_nop 4
    s_cbranch_vccz b_WOK_A
    s_sleep 8
    s_add_u32 s61, s61, 1
    s_cmp_lt_u32 s61, 65536
    s_cbranch_scc1 b_W_A
b_WOK_A:
b_DONE_A:
    s_cmp_eq_u32 s49, 0
    s_cbranch_scc0 b_SLOW
b_DONE2:
    s_waitcnt lgkmcnt(0)
    s_branch K3_ENTRY
b_P0_TRI:
    v_cmp_le_i32 vcc, 0, v6
    v_mov_b32 v36, v14
    v_mov_b32 v40, v13
    v_cndmask_b32 v32, v13, v14, vcc
    v_cndmask_b32 v44, v13, v14, vcc
    v_cmp_le_i32 vcc, 1, v6
    v_mov_b32 v37, v14
    v_mov_b32 v41, v13
    v_cndmask_b32 v33, v13, v14, vcc
    v_cndmask_b32 v45, v13, v14, vcc
    v_cmp_le_i32 vcc, 2, v6
    v_mov_b32 v38, v14
    v_mov_b32 v42, v13
    v_cndmask_b32 v34, v13, v14, vcc
    v_cndmask_b32 v46, v13, v14, vcc
    v_cmp_le_i32 vcc, 3, v6
    v_mov_b32 v39, v14
    v_mov_b32 v43, v13
    v_cndmask_b32 v35, v13, v14, vcc
    v_cndmask_b32 v47, v13, v14, vcc
    s_branch b_P0_GO
b_FIX_H00:
    s_cmp_eq_u32 s24, 0
    s_cbranch_scc1 b_FIXT_H00
    v_mov_b32 v32, v13
    v_mov_b32 v33, v13
    v_mov_b32 v34, v13
    v_mov_b32 v35, v13
    v_mov_b32 v36, v13
    v_mov_b32 v37, v13
    v_mov_b32 v38, v13
    v_mov_b32 v39, v13
    v_mov_b32 v40, v13
    v_mov_b32 v41, v13
    v_mov_b32 v42, v13
    v_mov_b32 v43, v13
    v_mov_b32 v44, v13
    v_mov_b32 v45, v13
    v_mov_b32 v46, v13
    v_mov_b32 v47, v13
    s_mov_b32 s21, 1000
    s_nop 1
    s_branch b_BACK_H00
b_FIXT_H00:
    v_cmp_le_i32 vcc, 0, v6
    v_mov_b32 v36, v5
    v_mov_b32 v40, v13
    v_cndmask_b32 v32, v13, v4, vcc
    v_cndmask_b32 v44, v13, v5, vcc
    v_cmp_le_i32 vcc, 1, v6
    v_mov_b32 v37, v5
    v_mov_b32 v41, v13
    v_cndmask_b32 v33, v13, v4, vcc
    v_cndmask_b32 v45, v13, v5, vcc
    v_cmp_le_i32 vcc, 2, v6
    v_mov_b32 v38, v5
    v_mov_b32 v42, v13
    v_cndmask_b32 v34, v13, v4, vcc
    v_cndmask_b32 v46, v13, v5, vcc
    v_cmp_le_i32 vcc, 3, v6
    v_mov_b32 v39, v5
    v_mov_b32 v43, v13
    v_cndmask_b32 v35, v13, v4, vcc
    v_cndmask_b32 v47, v13, v5, vcc
    s_mov_b32 s21, 0
    s_mov_b32 s24, 1
    s_nop 1
    s_branch b_BACK_H00
b_FIX_H01:
    s_cmp_eq_u32 s24, 0
    s_cbranch_scc1 b_FIXT_H01
    v_mov_b32 v32, v13
    v_mov_b32 v33, v13
    v_mov_b32 v34, v13
    v_mov_b32 v35, v13
    v_mov_b32 v36, v13
    v_mov_b32 v37, v13
    v_mov_b32 v38, v13
    v_mov_b32 v39, v13
    v_mov_b32 v40, v13
    v_mov_b32 v41, v13
    v_mov_b32 v42, v13
    v_mov_b32 v43, v13
    v_mov_b32 v44, v13
    v_mov_b32 v45, v13
    v_mov_b32 v46, v13
    v_mov_b32 v47, v13
    s_mov_b32 s21, 1000
    s_nop 1
    s_branch b_BACK_H01
b_FIXT_H01:
    v_cmp_le_i32 vcc, 0, v6
    v_mov_b32 v36, v5
    v_mov_b32 v40, v13
    v_cndmask_b32 v32, v13, v4, vcc
    v_cndmask_b32 v44, v13, v5, vcc
    v_cmp_le_i32 vcc, 1, v6
    v_mov_b32 v37, v5
    v_mov_b32 v41, v13
    v_cndmask_b32 v33, v13, v4, vcc
    v_cndmask_b32 v45, v13, v5, vcc
    v_cmp_le_i32 vcc, 2, v6
    v_mov_b32 v38, v5
    v_mov_b32 v42, v13
    v_cndmask_b32 v34, v13, v4, vcc
    v_cndmask_b32 v46, v13, v5, vcc
    v_cmp_le_i32 vcc, 3, v6
    v_mov_b32 v39, v5
    v_mov_b32 v43, v13
    v_cndmask_b32 v35, v13, v4, vcc
    v_cndmask_b32 v47, v13, v5, vcc
    s_mov_b32 s21, 0
    s_mov_b32 s24, 1
    s_nop 1
    s_branch b_BACK_H01
b_FIX_H10:
    s_cmp_eq_u32 s24, 0
    s_cbranch_scc1 b_FIXT_H10
    v_mov_b32 v32, v13
    v_mov_b32 v33, v13
    v_mov_b32 v34, v13
    v_mov_b32 v35, v13
    v_mov_b32 v36, v13
    v_mov_b32 v37, v13
    v_mov_b32 v38, v13
    v_mov_b32 v39, v13
    v_mov_b32 v40, v13
    v_mov_b32 v41, v13
    v_mov_b32 v42, v13
    v_mov_b32 v43, v13
    v_mov_b32 v44, v13
    v_mov_b32 v45, v13
    v_mov_b32 v46, v13
    v_mov_b32 v47, v13
    s_mov_b32 s21, 1000
    s_nop 1
    s_branch b_BACK_H10
b_FIXT_H10:
    v_cmp_le_i32 vcc, 0, v6
    v_mov_b32 v36, v5
    v_mov_b32 v40, v13
    v_cndmask_b32 v32, v13, v4, vcc
    v_cndmask_b32 v44, v13, v5, vcc
    v_cmp_le_i32 vcc, 1, v6
    v_mov_b32 v37, v5
    v_mov_b32 v41, v13
    v_cndmask_b32 v33, v13, v4, vcc
    v_cndmask_b32 v45, v13, v5, vcc
    v_cmp_le_i32 vcc, 2, v6
    v_mov_b32 v38, v5
    v_mov_b32 v42, v13
    v_cndmask_b32 v34, v13, v4, vcc
    v_cndmask_b32 v46, v13, v5, vcc
    v_cmp_le_i32 vcc, 3, v6
    v_mov_b32 v39, v5
    v_mov_b32 v43, v13
    v_cndmask_b32 v35, v13, v4, vcc
    v_cndmask_b32 v47, v13, v5, vcc
    s_mov_b32 s21, 0
    s_mov_b32 s24, 1
    s_nop 1
    s_branch b_BACK_H10
b_FIX_H11:
    s_cmp_eq_u32 s24, 0
    s_cbranch_scc1 b_FIXT_H11
    v_mov_b32 v32, v13
    v_mov_b32 v33, v13
    v_mov_b32 v34, v13
    v_mov_b32 v35, v13
    v_mov_b32 v36, v13
    v_mov_b32 v37, v13
    v_mov_b32 v38, v13
    v_mov_b32 v39, v13
    v_mov_b32 v40, v13
    v_mov_b32 v41, v13
    v_mov_b32 v42, v13
    v_mov_b32 v43, v13
    v_mov_b32 v44, v13
    v_mov_b32 v45, v13
    v_mov_b32 v46, v13
    v_mov_b32 v47, v13
    s_mov_b32 s21, 1000
    s_nop 1
    s_branch b_BACK_H11
b_FIXT_H11:
    v_cmp_le_i32 vcc, 0, v6
    v_mov_b32 v36, v5
    v_mov_b32 v40, v13
    v_cndmask_b32 v32, v13, v4, vcc
    v_cndmask_b32 v44, v13, v5, vcc
    v_cmp_le_i32 vcc, 1, v6
    v_mov_b32 v37, v5
    v_mov_b32 v41, v13
    v_cndmask_b32 v33, v13, v4, vcc
    v_cndmask_b32 v45, v13, v5, vcc
    v_cmp_le_i32 vcc, 2, v6
    v_mov_b32 v38, v5
    v_mov_b32 v42, v13
    v_cndmask_b32 v34, v13, v4, vcc
    v_cndmask_b32 v46, v13, v5, vcc
    v_cmp_le_i32 vcc, 3, v6
    v_mov_b32 v39, v5
    v_mov_b32 v43, v13
    v_cndmask_b32 v35, v13, v4, vcc
    v_cndmask_b32 v47, v13, v5, vcc
    s_mov_b32 s21, 0
    s_mov_b32 s24, 1
    s_nop 1
    s_branch b_BACK_H11
b_FIX_L00:
    s_cmp_eq_u32 s24, 0
    s_cbranch_scc1 b_FIXT_L00
    v_mov_b32 v32, v13
    v_mov_b32 v33, v13
    v_mov_b32 v34, v13
    v_mov_b32 v35, v13
    v_mov_b32 v36, v13
    v_mov_b32 v37, v13
    v_mov_b32 v38, v13
    v_mov_b32 v39, v13
    v_mov_b32 v40, v13
    v_mov_b32 v41, v13
    v_mov_b32 v42, v13
    v_mov_b32 v43, v13
    v_mov_b32 v44, v13
    v_mov_b32 v45, v13
    v_mov_b32 v46, v13
    v_mov_b32 v47, v13
    s_mov_b32 s21, 1000
    s_nop 1
    s_branch b_BACK_L00
b_FIXT_L00:
    v_cmp_le_i32 vcc, 0, v6
    v_mov_b32 v36, v5
    v_mov_b32 v40, v13
    v_cndmask_b32 v32, v13, v4, vcc
    v_cndmask_b32 v44, v13, v5, vcc
    v_cmp_le_i32 vcc, 1, v6
    v_mov_b32 v37, v5
    v_mov_b32 v41, v13
    v_cndmask_b32 v33, v13, v4, vcc
    v_cndmask_b32 v45, v13, v5, vcc
    v_cmp_le_i32 vcc, 2, v6
    v_mov_b32 v38, v5
    v_mov_b32 v42, v13
    v_cndmask_b32 v34, v13, v4, vcc
    v_cndmask_b32 v46, v13, v5, vcc
    v_cmp_le_i32 vcc, 3, v6
    v_mov_b32 v39, v5
    v_mov_b32 v43, v13
    v_cndmask_b32 v35, v13, v4, vcc
    v_cndmask_b32 v47, v13, v5, vcc
    s_mov_b32 s21, 0
    s_mov_b32 s24, 1
    s_nop 1
    s_branch b_BACK_L00
b_FIX_L01:
    s_cmp_eq_u32 s24, 0
    s_cbranch_scc1 b_FIXT_L01
    v_mov_b32 v32, v13
    v_mov_b32 v33, v13
    v_mov_b32 v34, v13
    v_mov_b32 v35, v13
    v_mov_b32 v36, v13
    v_mov_b32 v37, v13
    v_mov_b32 v38, v13
    v_mov_b32 v39, v13
    v_mov_b32 v40, v13
    v_mov_b32 v41, v13
    v_mov_b32 v42, v13
    v_mov_b32 v43, v13
    v_mov_b32 v44, v13
    v_mov_b32 v45, v13
    v_mov_b32 v46, v13
    v_mov_b32 v47, v13
    s_mov_b32 s21, 1000
    s_nop 1
    s_branch b_BACK_L01
b_FIXT_L01:
    v_cmp_le_i32 vcc, 0, v6
    v_mov_b32 v36, v5
    v_mov_b32 v40, v13
    v_cndmask_b32 v32, v13, v4, vcc
    v_cndmask_b32 v44, v13, v5, vcc
    v_cmp_le_i32 vcc, 1, v6
    v_mov_b32 v37, v5
    v_mov_b32 v41, v13
    v_cndmask_b32 v33, v13, v4, vcc
    v_cndmask_b32 v45, v13, v5, vcc
    v_cmp_le_i32 vcc, 2, v6
    v_mov_b32 v38, v5
    v_mov_b32 v42, v13
    v_cndmask_b32 v34, v13, v4, vcc
    v_cndmask_b32 v46, v13, v5, vcc
    v_cmp_le_i32 vcc, 3, v6
    v_mov_b32 v39, v5
    v_mov_b32 v43, v13
    v_cndmask_b32 v35, v13, v4, vcc
    v_cndmask_b32 v47, v13, v5, vcc
    s_mov_b32 s21, 0
    s_mov_b32 s24, 1
    s_nop 1
    s_branch b_BACK_L01
b_FIX_L10:
    s_cmp_eq_u32 s24, 0
    s_cbranch_scc1 b_FIXT_L10
    v_mov_b32 v32, v13
    v_mov_b32 v33, v13
    v_mov_b32 v34, v13
    v_mov_b32 v35, v13
    v_mov_b32 v36, v13
    v_mov_b32 v37, v13
    v_mov_b32 v38, v13
    v_mov_b32 v39, v13
    v_mov_b32 v40, v13
    v_mov_b32 v41, v13
    v_mov_b32 v42, v13
    v_mov_b32 v43, v13
    v_mov_b32 v44, v13
    v_mov_b32 v45, v13
    v_mov_b32 v46, v13
    v_mov_b32 v47, v13
    s_mov_b32 s21, 1000
    s_nop 1
    s_branch b_BACK_L10
b_FIXT_L10:
    v_cmp_le_i32 vcc, 0, v6
    v_mov_b32 v36, v5
    v_mov_b32 v40, v13
    v_cndmask_b32 v32, v13, v4, vcc
    v_cndmask_b32 v44, v13, v5, vcc
    v_cmp_le_i32 vcc, 1, v6
    v_mov_b32 v37, v5
    v_mov_b32 v41, v13
    v_cndmask_b32 v33, v13, v4, vcc
    v_cndmask_b32 v45, v13, v5, vcc
    v_cmp_le_i32 vcc, 2, v6
    v_mov_b32 v38, v5
    v_mov_b32 v42, v13
    v_cndmask_b32 v34, v13, v4, vcc
    v_cndmask_b32 v46, v13, v5, vcc
    v_cmp_le_i32 vcc, 3, v6
    v_mov_b32 v39, v5
    v_mov_b32 v43, v13
    v_cndmask_b32 v35, v13, v4, vcc
    v_cndmask_b32 v47, v13, v5, vcc
    s_mov_b32 s21, 0
    s_mov_b32 s24, 1
    s_nop 1
    s_branch b_BACK_L10
b_FIX_L11:
    s_cmp_eq_u32 s24, 0
    s_cbranch_scc1 b_FIXT_L11
    v_mov_b32 v32, v13
    v_mov_b32 v33, v13
    v_mov_b32 v34, v13
    v_mov_b32 v35, v13
    v_mov_b32 v36, v13
    v_mov_b32 v37, v13
    v_mov_b32 v38, v13
    v_mov_b32 v39, v13
    v_mov_b32 v40, v13
    v_mov_b32 v41, v13
    v_mov_b32 v42, v13
    v_mov_b32 v43, v13
    v_mov_b32 v44, v13
    v_mov_b32 v45, v13
    v_mov_b32 v46, v13
    v_mov_b32 v47, v13
    s_mov_b32 s21, 1000
    s_nop 1
    s_branch b_BACK_L11
b_FIXT_L11:
    v_cmp_le_i32 vcc, 0, v6
    v_mov_b32 v36, v5
    v_mov_b32 v40, v13
    v_cndmask_b32 v32, v13, v4, vcc
    v_cndmask_b32 v44, v13, v5, vcc
    v_cmp_le_i32 vcc, 1, v6
    v_mov_b32 v37, v5
    v_mov_b32 v41, v13
    v_cndmask_b32 v33, v13, v4, vcc
    v_cndmask_b32 v45, v13, v5, vcc
    v_cmp_le_i32 vcc, 2, v6
    v_mov_b32 v38, v5
    v_mov_b32 v42, v13
    v_cndmask_b32 v34, v13, v4, vcc
    v_cndmask_b32 v46, v13, v5, vcc
    v_cmp_le_i32 vcc, 3, v6
    v_mov_b32 v39, v5
    v_mov_b32 v43, v13
    v_cndmask_b32 v35, v13, v4, vcc
    v_cndmask_b32 v47, v13, v5, vcc
    s_mov_b32 s21, 0
    s_mov_b32 s24, 1
    s_nop 1
    s_branch b_BACK_L11
b_FIX_P:
    s_cmp_eq_u32 s24, 0
    s_cbranch_scc1 b_FIXT_P
    v_mov_b32 v32, v13
    v_mov_b32 v33, v13
    v_mov_b32 v34, v13
    v_mov_b32 v35, v13
    v_mov_b32 v36, v13
    v_mov_b32 v37, v13
    v_mov_b32 v38, v13
    v_mov_b32 v39, v13
    v_mov_b32 v40, v13
    v_mov_b32 v41, v13
    v_mov_b32 v42, v13
    v_mov_b32 v43, v13
    v_mov_b32 v44, v13
    v_mov_b32 v45, v13
    v_mov_b32 v46, v13
    v_mov_b32 v47, v13
    s_mov_b32 s21, 1000
    s_nop 1
    s_branch b_BACK_P
b_FIXT_P:
    v_cmp_le_i32 vcc, 0, v6
    v_mov_b32 v36, v5
    v_mov_b32 v40, v13
    v_cndmask_b32 v32, v13, v4, vcc
    v_cndmask_b32 v44, v13, v5, vcc
    v_cmp_le_i32 vcc, 1, v6
    v_mov_b32 v37, v5
    v_mov_b32 v41, v13
    v_cndmask_b32 v33, v13, v4, vcc
    v_cndmask_b32 v45, v13, v5, vcc
    v_cmp_le_i32 vcc, 2, v6
    v_mov_b32 v38, v5
    v_mov_b32 v42, v13
    v_cndmask_b32 v34, v13, v4, vcc
    v_cndmask_b32 v46, v13, v5, vcc
    v_cmp_le_i32 vcc, 3, v6
    v_mov_b32 v39, v5
    v_mov_b32 v43, v13
    v_cndmask_b32 v35, v13, v4, vcc
    v_cndmask_b32 v47, v13, v5, vcc
    s_mov_b32 s21, 0
    s_mov_b32 s24, 1
    s_nop 1
    s_branch b_BACK_P
b_SETFAIL:
    s_mov_b32 s49, 1
    s_branch b_FAILBACK
b_SLOW:
    s_waitcnt vmcnt(0) lgkmcnt(0)
    s_mov_b32 s24, 0
    v_mov_b32 v4, 0
    v_mov_b32 v5, 0
    v_mov_b32 v7, v13
    v_mov_b32 v8, v13
b_SLOW_PASS:
    v_mov_b64 v[64:65], 0
    v_mov_b64 v[66:67], 0
    v_mov_b64 v[68:69], 0
    v_mov_b64 v[70:71], 0
    v_mov_b64 v[72:73], 0
    v_mov_b64 v[74:75], 0
    v_mov_b64 v[76:77], 0
    v_mov_b64 v[78:79], 0
    v_mov_b64 v[80:81], 0
    v_mov_b64 v[82:83], 0
    v_mov_b64 v[84:85], 0
    v_mov_b64 v[86:87], 0
    v_mov_b64 v[88:89], 0
    v_mov_b64 v[90:91], 0
    v_mov_b64 v[92:93], 0
    v_mov_b64 v[94:95], 0
    v_mov_b64 v[96:97], 0
    v_mov_b64 v[98:99], 0
    v_mov_b64 v[100:101], 0
    v_mov_b64 v[102:103], 0
    v_mov_b64 v[104:105], 0
    v_mov_b64 v[106:107], 0
    v_mov_b64 v[108:109], 0
    v_mov_b64 v[110:111], 0
    v_mov_b64 v[112:113], 0
    v_mov_b64 v[114:115], 0
    v_mov_b64 v[116:117], 0
    v_mov_b64 v[118:119], 0
    v_mov_b64 v[120:121], 0
    v_mov_b64 v[122:123], 0
    v_mov_b64 v[124:125], 0
    v_mov_b64 v[126:127], 0
    v_mov_b64 v[20:21], 0
    v_mov_b64 v[22:23], 0
    v_mov_b64 v[24:25], 0
    v_mov_b64 v[26:27], 0
    s_mov_b32 s21, 0
b_SLOW_TILE:
    s_lshl_b32 s25, s21, 14
    s_add_u32 s26, s25, 4096
    buffer_load_dwordx4 v[192:195], v1, s[4:7], s25 offen offset:0 sc1
    buffer_load_dwordx4 v[196:199], v1, s[4:7], s25 offen offset:1024 sc1
    buffer_load_dwordx4 v[200:203], v1, s[4:7], s25 offen offset:2048 sc1
    buffer_load_dwordx4 v[204:207], v1, s[4:7], s25 offen offset:3072 sc1
    buffer_load_dwordx4 v[208:211], v1, s[4:7], s26 offen offset:0 sc1
    buffer_load_dwordx4 v[212:215], v1, s[4:7], s26 offen offset:1024 sc1
    buffer_load_dwordx4 v[216:219], v1, s[4:7], s26 offen offset:2048 sc1
    buffer_load_dwordx4 v[220:223], v1, s[4:7], s26 offen offset:3072 sc1
    s_cmp_eq_u32 s21, s19
    s_cbranch_scc1 b_SLOW_TRI
    v_mov_b32 v32, v4
    v_mov_b32 v33, v4
    v_mov_b32 v34, v4
    v_mov_b32 v35, v4
    v_mov_b32 v36, v5
    v_mov_b32 v37, v5
    v_mov_b32 v38, v5
    v_mov_b32 v39, v5
    v_mov_b32 v40, v4
    v_mov_b32 v41, v4
    v_mov_b32 v42, v4
    v_mov_b32 v43, v4
    v_mov_b32 v44, v5
    v_mov_b32 v45, v5
    v_mov_b32 v46, v5
    v_mov_b32 v47, v5
    s_branch b_SLOW_QK
b_SLOW_TRI:
    v_cmp_le_i32 vcc, 0, v6
    v_mov_b32 v36, v5
    v_mov_b32 v40, v13
    v_cndmask_b32 v32, v13, v4, vcc
    v_cndmask_b32 v44, v13, v5, vcc
    v_cmp_le_i32 vcc, 1, v6
    v_mov_b32 v37, v5
    v_mov_b32 v41, v13
    v_cndmask_b32 v33, v13, v4, vcc
    v_cndmask_b32 v45, v13, v5, vcc
    v_cmp_le_i32 vcc, 2, v6
    v_mov_b32 v38, v5
    v_mov_b32 v42, v13
    v_cndmask_b32 v34, v13, v4, vcc
    v_cndmask_b32 v46, v13, v5, vcc
    v_cmp_le_i32 vcc, 3, v6
    v_mov_b32 v39, v5
    v_mov_b32 v43, v13
    v_cndmask_b32 v35, v13, v4, vcc
    v_cndmask_b32 v47, v13, v5, vcc
b_SLOW_QK:
    s_waitcnt vmcnt(0)
    s_nop 1
    v_mfma_f32_16x16x32_bf16 v[128:131], v[192:195], v[160:163], v[32:35]
    v_mfma_f32_16x16x32_bf16 v[132:135], v[192:195], v[176:179], v[36:39]
    v_mfma_f32_16x16x32_bf16 v[128:131], v[196:199], v[164:167], v[128:131]
    v_mfma_f32_16x16x32_bf16 v[132:135], v[196:199], v[180:183], v[132:135]
    v_mfma_f32_16x16x32_bf16 v[128:131], v[200:203], v[168:171], v[128:131]
    v_mfma_f32_16x16x32_bf16 v[132:135], v[200:203], v[184:187], v[132:135]
    v_mfma_f32_16x16x32_bf16 v[128:131], v[204:207], v[172:175], v[128:131]
    v_mfma_f32_16x16x32_bf16 v[132:135], v[204:207], v[188:191], v[132:135]
    v_mfma_f32_16x16x32_bf16 v[136:139], v[208:211], v[160:163], v[40:43]
    v_mfma_f32_16x16x32_bf16 v[140:143], v[208:211], v[176:179], v[44:47]
    v_mfma_f32_16x16x32_bf16 v[136:139], v[212:215], v[164:167], v[136:139]
    v_mfma_f32_16x16x32_bf16 v[140:143], v[212:215], v[180:183], v[140:143]
    v_mfma_f32_16x16x32_bf16 v[136:139], v[216:219], v[168:171], v[136:139]
    v_mfma_f32_16x16x32_bf16 v[140:143], v[216:219], v[184:187], v[140:143]
    v_mfma_f32_16x16x32_bf16 v[136:139], v[220:223], v[172:175], v[136:139]
    v_mfma_f32_16x16x32_bf16 v[140:143], v[220:223], v[188:191], v[140:143]
    s_nop 7
    s_nop 1
    s_cmp_eq_u32 s24, 0
    s_cbranch_scc0 b_SLOW_PV
    v_max3_f32 v7, v7, v128, v129
    v_max3_f32 v7, v7, v130, v131
    v_max3_f32 v7, v7, v136, v137
    v_max3_f32 v7, v7, v138, v139
    v_max3_f32 v8, v8, v132, v133
    v_max3_f32 v8, v8, v134, v135
    v_max3_f32 v8, v8, v140, v141
    v_max3_f32 v8, v8, v142, v143
    s_branch b_SLOW_NEXT
b_SLOW_PV:
    s_add_u32 s25, s25, 8192
    s_add_u32 s26, s25, 4096
    buffer_load_dwordx4 v[192:195], v1, s[4:7], s25 offen offset:0 sc1
    buffer_load_dwordx4 v[196:199], v1, s[4:7], s25 offen offset:1024 sc1
    buffer_load_dwordx4 v[200:203], v1, s[4:7], s25 offen offset:2048 sc1
    buffer_load_dwordx4 v[204:207], v1, s[4:7], s25 offen offset:3072 sc1
    buffer_load_dwordx4 v[208:211], v1, s[4:7], s26 offen offset:0 sc1
    buffer_load_dwordx4 v[212:215], v1, s[4:7], s26 offen offset:1024 sc1
    buffer_load_dwordx4 v[216:219], v1, s[4:7], s26 offen offset:2048 sc1
    buffer_load_dwordx4 v[220:223], v1, s[4:7], s26 offen offset:3072 sc1
    v_exp_f32 v128, v128
    v_exp_f32 v129, v129
    v_exp_f32 v130, v130
    v_exp_f32 v131, v131
    v_exp_f32 v132, v132
    v_exp_f32 v133, v133
    v_exp_f32 v134, v134
    v_exp_f32 v135, v135
    v_exp_f32 v136, v136
    v_exp_f32 v137, v137
    v_exp_f32 v138, v138
    v_exp_f32 v139, v139
    v_exp_f32 v140, v140
    v_exp_f32 v141, v141
    v_exp_f32 v142, v142
    v_exp_f32 v143, v143
    s_nop 0
    v_cvt_pk_bf16_f32 v48, v128, v129
    v_cvt_pk_bf16_f32 v49, v130, v131
    v_cvt_pk_bf16_f32 v50, v136, v137
    v_cvt_pk_bf16_f32 v51, v138, v139
    v_cvt_pk_bf16_f32 v52, v132, v133
    v_cvt_pk_bf16_f32 v53, v134, v135
    v_cvt_pk_bf16_f32 v54, v140, v141
    v_cvt_pk_bf16_f32 v55, v142, v143
    s_waitcnt vmcnt(0)
    s_nop 1
    v_mfma_f32_16x16x32_bf16 v[64:67], v[192:195], v[48:51], v[64:67]
    v_mfma_f32_16x16x32_bf16 v[68:71], v[192:195], v[52:55], v[68:71]
    v_mfma_f32_16x16x32_bf16 v[72:75], v[196:199], v[48:51], v[72:75]
    v_mfma_f32_16x16x32_bf16 v[76:79], v[196:199], v[52:55], v[76:79]
    v_mfma_f32_16x16x32_bf16 v[80:83], v[200:203], v[48:51], v[80:83]
    v_mfma_f32_16x16x32_bf16 v[84:87], v[200:203], v[52:55], v[84:87]
    v_mfma_f32_16x16x32_bf16 v[88:91], v[204:207], v[48:51], v[88:91]
    v_mfma_f32_16x16x32_bf16 v[92:95], v[204:207], v[52:55], v[92:95]
    v_mfma_f32_16x16x32_bf16 v[96:99], v[208:211], v[48:51], v[96:99]
    v_mfma_f32_16x16x32_bf16 v[100:103], v[208:211], v[52:55], v[100:103]
    v_mfma_f32_16x16x32_bf16 v[104:107], v[212:215], v[48:51], v[104:107]
    v_mfma_f32_16x16x32_bf16 v[108:111], v[212:215], v[52:55], v[108:111]
    v_mfma_f32_16x16x32_bf16 v[112:115], v[216:219], v[48:51], v[112:115]
    v_mfma_f32_16x16x32_bf16 v[116:119], v[216:219], v[52:55], v[116:119]
    v_mfma_f32_16x16x32_bf16 v[120:123], v[220:223], v[48:51], v[120:123]
    v_mfma_f32_16x16x32_bf16 v[124:127], v[220:223], v[52:55], v[124:127]
    v_mfma_f32_16x16x32_bf16 v[20:23], v[16:19], v[48:51], v[20:23]
    v_mfma_f32_16x16x32_bf16 v[24:27], v[16:19], v[52:55], v[24:27]
    s_nop 7
b_SLOW_NEXT:
    s_add_u32 s21, s21, 1
    s_cmp_le_u32 s21, s19
    s_cbranch_scc1 b_SLOW_TILE
    s_cmp_eq_u32 s24, 0
    s_cbranch_scc0 b_SLOW_DONE
    v_mov_b32 v9, v7
    v_mov_b32 v10, v8
    s_nop 1
    v_permlane32_swap_b32 v7, v9
    v_permlane32_swap_b32 v8, v10
    s_nop 1
    v_max_f32 v7, v7, v9
    v_max_f32 v8, v8, v10
    v_mov_b32 v9, v7
    v_mov_b32 v10, v8
    s_nop 1
    v_permlane16_swap_b32 v7, v9
    v_permlane16_swap_b32 v8, v10
    s_nop 1
    v_max_f32 v7, v7, v9
    v_max_f32 v8, v8, v10
    v_sub_f32 v4, 0, v7
    v_sub_f32 v5, 0, v8
    s_mov_b32 s24, 1
    s_branch b_SLOW_PASS
b_SLOW_DONE:
    s_nop 7
    v_rcp_f32 v7, v20
    v_rcp_f32 v8, v24
    s_lshl_b32 s27, s19, 5
    s_add_u32 s27, s27, s16
    s_lshl_b32 s27, s27, 13
    v_mul_f32 v64, v7, v64
    v_mul_f32 v65, v7, v65
    v_mul_f32 v66, v7, v66
    v_mul_f32 v67, v7, v67
    v_cvt_pk_bf16_f32 v128, v64, v65
    v_cvt_pk_bf16_f32 v129, v66, v67
    v_mul_f32 v72, v7, v72
    v_mul_f32 v73, v7, v73
    v_mul_f32 v74, v7, v74
    v_mul_f32 v75, v7, v75
    v_cvt_pk_bf16_f32 v130, v72, v73
    v_cvt_pk_bf16_f32 v131, v74, v75
    buffer_store_dwordx4 v[128:131], v1, s[12:15], s27 offen offset:0 sc1
    v_mul_f32 v80, v7, v80
    v_mul_f32 v81, v7, v81
    v_mul_f32 v82, v7, v82
    v_mul_f32 v83, v7, v83
    v_cvt_pk_bf16_f32 v132, v80, v81
    v_cvt_pk_bf16_f32 v133, v82, v83
    v_mul_f32 v88, v7, v88
    v_mul_f32 v89, v7, v89
    v_mul_f32 v90, v7, v90
    v_mul_f32 v91, v7, v91
    v_cvt_pk_bf16_f32 v134, v88, v89
    v_cvt_pk_bf16_f32 v135, v90, v91
    buffer_store_dwordx4 v[132:135], v1, s[12:15], s27 offen offset:1024 sc1
    v_mul_f32 v96, v7, v96
    v_mul_f32 v97, v7, v97
    v_mul_f32 v98, v7, v98
    v_mul_f32 v99, v7, v99
    v_cvt_pk_bf16_f32 v136, v96, v97
    v_cvt_pk_bf16_f32 v137, v98, v99
    v_mul_f32 v104, v7, v104
    v_mul_f32 v105, v7, v105
    v_mul_f32 v106, v7, v106
    v_mul_f32 v107, v7, v107
    v_cvt_pk_bf16_f32 v138, v104, v105
    v_cvt_pk_bf16_f32 v139, v106, v107
    buffer_store_dwordx4 v[136:139], v1, s[12:15], s27 offen offset:2048 sc1
    v_mul_f32 v112, v7, v112
    v_mul_f32 v113, v7, v113
    v_mul_f32 v114, v7, v114
    v_mul_f32 v115, v7, v115
    v_cvt_pk_bf16_f32 v140, v112, v113
    v_cvt_pk_bf16_f32 v141, v114, v115
    v_mul_f32 v120, v7, v120
    v_mul_f32 v121, v7, v121
    v_mul_f32 v122, v7, v122
    v_mul_f32 v123, v7, v123
    v_cvt_pk_bf16_f32 v142, v120, v121
    v_cvt_pk_bf16_f32 v143, v122, v123
    buffer_store_dwordx4 v[140:143], v1, s[12:15], s27 offen offset:3072 sc1
    v_mul_f32 v68, v8, v68
    v_mul_f32 v69, v8, v69
    v_mul_f32 v70, v8, v70
    v_mul_f32 v71, v8, v71
    v_cvt_pk_bf16_f32 v144, v68, v69
    v_cvt_pk_bf16_f32 v145, v70, v71
    v_mul_f32 v76, v8, v76
    v_mul_f32 v77, v8, v77
    v_mul_f32 v78, v8, v78
    v_mul_f32 v79, v8, v79
    v_cvt_pk_bf16_f32 v146, v76, v77
    v_cvt_pk_bf16_f32 v147, v78, v79
    s_add_u32 s27, s27, 4096
    buffer_store_dwordx4 v[144:147], v1, s[12:15], s27 offen offset:0 sc1
    v_mul_f32 v84, v8, v84
    v_mul_f32 v85, v8, v85
    v_mul_f32 v86, v8, v86
    v_mul_f32 v87, v8, v87
    v_cvt_pk_bf16_f32 v148, v84, v85
    v_cvt_pk_bf16_f32 v149, v86, v87
    v_mul_f32 v92, v8, v92
    v_mul_f32 v93, v8, v93
    v_mul_f32 v94, v8, v94
    v_mul_f32 v95, v8, v95
    v_cvt_pk_bf16_f32 v150, v92, v93
    v_cvt_pk_bf16_f32 v151, v94, v95
    buffer_store_dwordx4 v[148:151], v1, s[12:15], s27 offen offset:1024 sc1
    v_mul_f32 v100, v8, v100
    v_mul_f32 v101, v8, v101
    v_mul_f32 v102, v8, v102
    v_mul_f32 v103, v8, v103
    v_cvt_pk_bf16_f32 v152, v100, v101
    v_cvt_pk_bf16_f32 v153, v102, v103
    v_mul_f32 v108, v8, v108
    v_mul_f32 v109, v8, v109
    v_mul_f32 v110, v8, v110
    v_mul_f32 v111, v8, v111
    v_cvt_pk_bf16_f32 v154, v108, v109
    v_cvt_pk_bf16_f32 v155, v110, v111
    buffer_store_dwordx4 v[152:155], v1, s[12:15], s27 offen offset:2048 sc1
    v_mul_f32 v116, v8, v116
    v_mul_f32 v117, v8, v117
    v_mul_f32 v118, v8, v118
    v_mul_f32 v119, v8, v119
    v_cvt_pk_bf16_f32 v156, v116, v117
    v_cvt_pk_bf16_f32 v157, v118, v119
    v_mul_f32 v124, v8, v124
    v_mul_f32 v125, v8, v125
    v_mul_f32 v126, v8, v126
    v_mul_f32 v127, v8, v127
    v_cvt_pk_bf16_f32 v158, v124, v125
    v_cvt_pk_bf16_f32 v159, v126, v127
    buffer_store_dwordx4 v[156:159], v1, s[12:15], s27 offen offset:3072 sc1
    s_branch b_DONE2
K3_ENTRY:
    s_barrier
    v_and_b32 v1, 0x3ff, v0
    v_lshrrev_b32 v1, 6, v1
    s_nop 0
    v_readfirstlane_b32 s18, v1
    s_nop 3
    s_cmp_ge_u32 s18, 4
    s_cbranch_scc1 c_M_B
    s_setprio 1
    s_load_dwordx2 s[34:35], s[0:1], 88
    v_and_b32 v4, 63, v0
    v_lshlrev_b32 v1, 4, v4
    v_and_b32 v5, 0x3ff, v0
    v_lshrrev_b32 v5, 6, v5
    s_and_b32 s23, s2, 7
    s_lshl_b32 s23, s23, 2
    v_readfirstlane_b32 s18, v5
    s_bfe_u32 s16, s2, 0x20003
    s_add_u32 s16, s16, s23
    s_lshr_b32 s17, s2, 5
    v_mov_b32 v11, 0
    s_mov_b32 s25, 0x53800000
    s_mul_i32 s23, s18, 3072
    v_add_u32 v8, s23, v1
    s_waitcnt lgkmcnt(0)
    s_mul_i32 s24, s16, 196608
    s_add_u32 s24, s24, 69206016
    s_add_u32 s4, s34, s24
    s_addc_u32 s5, s35, 0
    s_mov_b32 s6, 196608
    s_mov_b32 s7, 0x20000
    s_add_u32 s8, s34, 67108864
    s_addc_u32 s9, s35, 0
    s_mov_b32 s10, 2097152
    s_mov_b32 s11, 0x20000
    s_add_u32 s12, s34, 75497472
    s_addc_u32 s13, s35, 0
    s_mov_b32 s14, 2097152
    s_mov_b32 s15, 0x20000
    s_mul_i32 s21, s18, 3072
    s_mov_b32 s20, 0
    s_mov_b32 m0, s21
    s_nop 0
    buffer_load_dwordx4 v8, s[4:7], s20 offen offset:0 sc1 lds
    buffer_load_dwordx4 v8, s[4:7], s20 offen offset:1024 sc1 lds
    buffer_load_dwordx4 v8, s[4:7], s20 offen offset:2048 sc1 lds
    s_add_u32 s20, s20, 12288
    s_add_u32 s21, s21, 12288
    s_lshl_b32 s23, s16, 6
    s_lshl_b32 s24, s17, 3
    s_add_u32 s23, s23, s24
    s_lshl_b32 s24, s18, 1
    s_add_u32 s23, s23, s24
    s_lshl_b32 s23, s23, 10
    buffer_load_dwordx4 v[12:15], v1, s[8:11], s23 offen sc1
    buffer_load_dwordx4 v[16:19], v1, s[8:11], s23 offen offset:1024 sc1
    s_mov_b32 m0, s21
    s_nop 0
    buffer_load_dwordx4 v8, s[4:7], s20 offen offset:0 sc1 lds
    buffer_load_dwordx4 v8, s[4:7], s20 offen offset:1024 sc1 lds
    buffer_load_dwordx4 v8, s[4:7], s20 offen offset:2048 sc1 lds
    s_add_u32 s20, s20, 12288
    s_add_u32 s21, s21, 12288
    s_mov_b32 m0, s21
    s_nop 0
    buffer_load_dwordx4 v8, s[4:7], s20 offen offset:0 sc1 lds
    buffer_load_dwordx4 v8, s[4:7], s20 offen offset:1024 sc1 lds
    buffer_load_dwordx4 v8, s[4:7], s20 offen offset:2048 sc1 lds
    s_add_u32 s20, s20, 12288
    s_add_u32 s21, s21, 12288
    s_mul_i32 s23, s18, 3072
    s_add_u32 s24, s23, 49152
    v_mov_b32 v2, v1
    v_add_u32 v3, 12288, v1
    s_mov_b32 s22, 12288
    v_mov_b32 v64, 0
    v_mov_b32 v65, 0
    v_mov_b32 v66, 0
    v_mov_b32 v67, 0
    v_mov_b32 v68, 0
    v_mov_b32 v69, 0
    v_mov_b32 v70, 0
    v_mov_b32 v71, 0
    v_mov_b32 v72, 0
    v_mov_b32 v73, 0
    v_mov_b32 v74, 0
    v_mov_b32 v75, 0
    v_mov_b32 v76, 0
    v_mov_b32 v77, 0
    v_mov_b32 v78, 0
    v_mov_b32 v79, 0
    v_mov_b32 v80, 0
    v_mov_b32 v81, 0
    v_mov_b32 v82, 0
    v_mov_b32 v83, 0
    v_mov_b32 v84, 0
    v_mov_b32 v85, 0
    v_mov_b32 v86, 0
    v_mov_b32 v87, 0
    v_mov_b32 v88, 0
    v_mov_b32 v89, 0
    v_mov_b32 v90, 0
    v_mov_b32 v91, 0
    v_mov_b32 v92, 0
    v_mov_b32 v93, 0
    v_mov_b32 v94, 0
    v_mov_b32 v95, 0
    v_and_b32 v60, 63, v0
    v_lshlrev_b32 v60, 2, v60
    v_add_u32 v60, 49152, v60
    v_mov_b32 v63, 1
    ds_write_b32 v60, v11
    ds_write_b32 v60, v11 offset:256
    ds_write_b32 v60, v11 offset:512
    s_mov_b32 s26, 4
    s_mov_b32 s27, 0
    s_waitcnt vmcnt(6) lgkmcnt(0)
    s_barrier
    s_waitcnt vmcnt(3)
    ds_add_u32 v60, v63 offset:0
    ds_read_b128 v[20:23], v2 offset:0
    ds_read_b128 v[24:27], v2 offset:3072
    ds_read_b128 v[28:31], v2 offset:1024
    ds_read_b128 v[32:35], v2 offset:2048
    s_waitcnt lgkmcnt(2)
    v_mfma_f32_32x32x16_bf16 v[128:143], v[20:23], v[12:15], 0
    v_mfma_f32_32x32x16_bf16 v[144:159], v[20:23], v[16:19], 0
    v_mfma_f32_32x32x16_bf16 v[160:175], v[24:27], v[12:15], 0
    v_mfma_f32_32x32x16_bf16 v[176:191], v[24:27], v[16:19], 0
    s_nop 7
    s_nop 7
    v_max3_f32 v4, v128, v129, v130
    v_max3_f32 v4, v4, v131, v132
    v_max3_f32 v4, v4, v133, v134
    v_max3_f32 v4, v4, v135, v136
    v_max3_f32 v4, v4, v137, v138
    v_max3_f32 v4, v4, v139, v140
    v_max3_f32 v4, v4, v141, v142
    v_max3_f32 v4, v4, v143, v160
    v_max3_f32 v4, v4, v161, v162
    v_max3_f32 v4, v4, v163, v164
    v_max3_f32 v4, v4, v165, v166
    v_max3_f32 v4, v4, v167, v168
    v_max3_f32 v4, v4, v169, v170
    v_max3_f32 v4, v4, v171, v172
    v_max3_f32 v4, v4, v173, v174
    v_max_f32 v4, v4, v175
    v_max3_f32 v5, v144, v145, v146
    v_max3_f32 v5, v5, v147, v148
    v_max3_f32 v5, v5, v149, v150
    v_max3_f32 v5, v5, v151, v152
    v_max3_f32 v5, v5, v153, v154
    v_max3_f32 v5, v5, v155, v156
    v_max3_f32 v5, v5, v157, v158
    v_max3_f32 v5, v5, v159, v176
    v_max3_f32 v5, v5, v177, v178
    v_max3_f32 v5, v5, v179, v180
    v_max3_f32 v5, v5, v181, v182
    v_max3_f32 v5, v5, v183, v184
    v_max3_f32 v5, v5, v185, v186
    v_max3_f32 v5, v5, v187, v188
    v_max3_f32 v5, v5, v189, v190
    v_max_f32 v5, v5, v191
    v_mov_b32 v6, v4
    v_mov_b32 v7, v5
    s_nop 1
    v_permlane32_swap_b32 v4, v6
    v_permlane32_swap_b32 v5, v7
    s_nop 1
    v_max_f32 v4, v4, v6
    v_max_f32 v5, v5, v7
    v_sub_f32 v9, 0xc2b40000, v4
    v_sub_f32 v10, 0xc2b40000, v5
c_A_START:
    v_add_f32 v128, v9, v128
    v_mov_b32 v96, v9
    v_add_f32 v129, v9, v129
    v_mov_b32 v97, v9
    v_add_f32 v130, v9, v130
    v_mov_b32 v98, v9
    v_add_f32 v131, v9, v131
    v_mov_b32 v99, v9
    v_add_f32 v132, v9, v132
    v_mov_b32 v100, v9
    v_add_f32 v133, v9, v133
    v_mov_b32 v101, v9
    v_add_f32 v134, v9, v134
    v_mov_b32 v102, v9
    v_add_f32 v135, v9, v135
    v_mov_b32 v103, v9
    v_add_f32 v136, v9, v136
    v_mov_b32 v104, v9
    v_add_f32 v137, v9, v137
    v_mov_b32 v105, v9
    v_add_f32 v138, v9, v138
    v_mov_b32 v106, v9
    v_add_f32 v139, v9, v139
    v_mov_b32 v107, v9
    v_add_f32 v140, v9, v140
    v_mov_b32 v108, v9
    v_add_f32 v141, v9, v141
    v_mov_b32 v109, v9
    v_add_f32 v142, v9, v142
    v_mov_b32 v110, v9
    v_add_f32 v143, v9, v143
    v_mov_b32 v111, v9
    v_add_f32 v144, v10, v144
    v_mov_b32 v112, v10
    v_add_f32 v145, v10, v145
    v_mov_b32 v113, v10
    v_add_f32 v146, v10, v146
    v_mov_b32 v114, v10
    v_add_f32 v147, v10, v147
    v_mov_b32 v115, v10
    v_add_f32 v148, v10, v148
    v_mov_b32 v116, v10
    v_add_f32 v149, v10, v149
    v_mov_b32 v117, v10
    v_add_f32 v150, v10, v150
    v_mov_b32 v118, v10
    v_add_f32 v151, v10, v151
    v_mov_b32 v119, v10
    v_add_f32 v152, v10, v152
    v_mov_b32 v120, v10
    v_add_f32 v153, v10, v153
    v_mov_b32 v121, v10
    v_add_f32 v154, v10, v154
    v_mov_b32 v122, v10
    v_add_f32 v155, v10, v155
    v_mov_b32 v123, v10
    v_add_f32 v156, v10, v156
    v_mov_b32 v124, v10
    v_add_f32 v157, v10, v157
    v_mov_b32 v125, v10
    v_add_f32 v158, v10, v158
    v_mov_b32 v126, v10
    v_add_f32 v159, v10, v159
    v_mov_b32 v127, v10
    v_mov_b32 v188, 0
    v_mov_b32 v189, 0
    v_mov_b32 v190, 0
    v_mov_b32 v191, 0
    v_mov_b32 v56, 0
    v_mov_b32 v57, 0
    v_mov_b32 v40, 0
    v_mov_b32 v41, 0
    v_mov_b32 v42, 0
    v_mov_b32 v43, 0
    s_mov_b32 s19, 15
    s_waitcnt lgkmcnt(0)
c_A_LOOP:
    v_exp_f32 v128, v128
    v_cvt_pk_bf16_f32 v58, v188, v189
    v_exp_f32 v129, v129
    v_cvt_pk_bf16_f32 v59, v190, v191
    v_exp_f32 v130, v130
    s_waitcnt lgkmcnt(3)
    v_mfma_f32_32x32x16_bf16 v[160:175], v[24:27], v[12:15], v[96:111]
    v_exp_f32 v131, v131
    v_exp_f32 v132, v132
    v_cvt_pk_bf16_f32 v44, v128, v129
    v_exp_f32 v133, v133
    v_mfma_f32_32x32x16_bf16 v[80:95], v[40:43], v[56:59], v[80:95]
    v_exp_f32 v134, v134
    v_cvt_pk_bf16_f32 v45, v130, v131
    v_exp_f32 v135, v135
    v_mfma_f32_32x32x16_bf16 v[176:191], v[24:27], v[16:19], v[112:127]
    ds_read_b128 v[20:23], v2 offset:6144
    v_exp_f32 v136, v136
    v_cvt_pk_bf16_f32 v46, v132, v133
    v_exp_f32 v137, v137
    v_exp_f32 v138, v138
    v_cvt_pk_bf16_f32 v47, v134, v135
    v_exp_f32 v139, v139
    v_exp_f32 v140, v140
    v_cvt_pk_bf16_f32 v48, v136, v137
    v_exp_f32 v141, v141
    s_waitcnt lgkmcnt(1)
    v_mfma_f32_32x32x16_bf16 v[64:79], v[28:31], v[44:47], v[64:79]
    ds_read_b128 v[36:39], v2 offset:4096
    v_exp_f32 v142, v142
    v_cvt_pk_bf16_f32 v49, v138, v139
    v_exp_f32 v143, v143
    v_exp_f32 v144, v144
    v_cvt_pk_bf16_f32 v50, v140, v141
    v_exp_f32 v145, v145
    v_exp_f32 v146, v146
    v_cvt_pk_bf16_f32 v51, v142, v143
    v_exp_f32 v147, v147
    v_exp_f32 v148, v148
    v_cvt_pk_bf16_f32 v52, v144, v145
    v_exp_f32 v149, v149
    v_mfma_f32_32x32x16_bf16 v[64:79], v[32:35], v[48:51], v[64:79]
    ds_read_b128 v[40:43], v2 offset:5120
    v_exp_f32 v150, v150
    v_cvt_pk_bf16_f32 v53, v146, v147
    v_exp_f32 v151, v151
    v_exp_f32 v152, v152
    v_cvt_pk_bf16_f32 v54, v148, v149
    v_exp_f32 v153, v153
    v_exp_f32 v154, v154
    v_cvt_pk_bf16_f32 v55, v150, v151
    v_exp_f32 v155, v155
    v_exp_f32 v156, v156
    v_cvt_pk_bf16_f32 v56, v152, v153
    v_exp_f32 v157, v157
    v_mfma_f32_32x32x16_bf16 v[80:95], v[28:31], v[52:55], v[80:95]
    v_exp_f32 v158, v158
    v_cvt_pk_bf16_f32 v57, v154, v155
    v_exp_f32 v159, v159
    v_exp_f32 v160, v160
    v_cvt_pk_bf16_f32 v58, v156, v157
    v_exp_f32 v161, v161
    v_cvt_pk_bf16_f32 v59, v158, v159
    v_exp_f32 v162, v162
    s_waitcnt lgkmcnt(2)
    v_mfma_f32_32x32x16_bf16 v[128:143], v[20:23], v[12:15], v[96:111]
    v_exp_f32 v163, v163
    v_exp_f32 v164, v164
    v_cvt_pk_bf16_f32 v44, v160, v161
    v_exp_f32 v165, v165
    v_mfma_f32_32x32x16_bf16 v[80:95], v[32:35], v[56:59], v[80:95]
    v_exp_f32 v166, v166
    v_cvt_pk_bf16_f32 v45, v162, v163
    v_exp_f32 v167, v167
    v_mfma_f32_32x32x16_bf16 v[144:159], v[20:23], v[16:19], v[112:127]
    ds_read_b128 v[24:27], v2 offset:9216
    v_exp_f32 v168, v168
    v_cvt_pk_bf16_f32 v46, v164, v165
    v_exp_f32 v169, v169
    v_exp_f32 v170, v170
    v_cvt_pk_bf16_f32 v47, v166, v167
    v_exp_f32 v171, v171
    v_exp_f32 v172, v172
    v_cvt_pk_bf16_f32 v48, v168, v169
    v_exp_f32 v173, v173
    s_waitcnt lgkmcnt(1)
    v_mfma_f32_32x32x16_bf16 v[64:79], v[36:39], v[44:47], v[64:79]
    ds_read_b128 v[28:31], v2 offset:7168
    ds_read_b32 v61, v60 offset:0
    v_exp_f32 v174, v174
    v_cvt_pk_bf16_f32 v49, v170, v171
    v_exp_f32 v175, v175
    v_exp_f32 v176, v176
    v_cvt_pk_bf16_f32 v50, v172, v173
    v_exp_f32 v177, v177
    v_exp_f32 v178, v178
    v_cvt_pk_bf16_f32 v51, v174, v175
    v_exp_f32 v179, v179
    v_exp_f32 v180, v180
    v_cvt_pk_bf16_f32 v52, v176, v177
    v_exp_f32 v181, v181
    v_mfma_f32_32x32x16_bf16 v[64:79], v[40:43], v[48:51], v[64:79]
    ds_read_b128 v[32:35], v2 offset:8192
    ds_read_b32 v62, v60 offset:256
    v_exp_f32 v182, v182
    v_cvt_pk_bf16_f32 v53, v178, v179
    v_exp_f32 v183, v183
    v_exp_f32 v184, v184
    v_cvt_pk_bf16_f32 v54, v180, v181
    v_exp_f32 v185, v185
    v_exp_f32 v186, v186
    v_cvt_pk_bf16_f32 v55, v182, v183
    v_exp_f32 v187, v187
    v_exp_f32 v188, v188
    v_cvt_pk_bf16_f32 v56, v184, v185
    v_exp_f32 v189, v189
    v_mfma_f32_32x32x16_bf16 v[80:95], v[36:39], v[52:55], v[80:95]
    v_exp_f32 v190, v190
    v_cvt_pk_bf16_f32 v57, v186, v187
    v_exp_f32 v191, v191
    v_exp_f32 v128, v128
    v_cvt_pk_bf16_f32 v58, v188, v189
    v_exp_f32 v129, v129
    v_cvt_pk_bf16_f32 v59, v190, v191
    v_exp_f32 v130, v130
    s_waitcnt lgkmcnt(4)
    v_mfma_f32_32x32x16_bf16 v[160:175], v[24:27], v[12:15], v[96:111]
    v_exp_f32 v131, v131
    v_exp_f32 v132, v132
    v_cvt_pk_bf16_f32 v44, v128, v129
    v_exp_f32 v133, v133
    v_mfma_f32_32x32x16_bf16 v[80:95], v[40:43], v[56:59], v[80:95]
    s_waitcnt lgkmcnt(0)
    v_cmp_gt_u32 vcc, s26, v61
    s_cbranch_vccnz c_ASPIN_R
c_ASPB_R:
    v_cmp_gt_u32 vcc, s27, v62
    s_cbranch_vccnz c_ASPIN_D
c_ASPB_D:
    s_mov_b32 m0, s21
    v_exp_f32 v134, v134
    v_cvt_pk_bf16_f32 v45, v130, v131
    v_exp_f32 v135, v135
    v_mfma_f32_32x32x16_bf16 v[176:191], v[24:27], v[16:19], v[112:127]
    ds_read_b128 v[20:23], v3 offset:0
    v_exp_f32 v136, v136
    v_cvt_pk_bf16_f32 v46, v132, v133
    v_exp_f32 v137, v137
    v_exp_f32 v138, v138
    v_cvt_pk_bf16_f32 v47, v134, v135
    v_exp_f32 v139, v139
    v_exp_f32 v140, v140
    v_cvt_pk_bf16_f32 v48, v136, v137
    v_exp_f32 v141, v141
    s_waitcnt lgkmcnt(1)
    v_mfma_f32_32x32x16_bf16 v[64:79], v[28:31], v[44:47], v[64:79]
    ds_read_b128 v[36:39], v2 offset:10240
    buffer_load_dwordx4 v8, s[4:7], s20 offen offset:0 sc1 lds
    v_exp_f32 v142, v142
    v_cvt_pk_bf16_f32 v49, v138, v139
    v_exp_f32 v143, v143
    v_exp_f32 v144, v144
    v_cvt_pk_bf16_f32 v50, v140, v141
    v_exp_f32 v145, v145
    v_exp_f32 v146, v146
    v_cvt_pk_bf16_f32 v51, v142, v143
    v_exp_f32 v147, v147
    v_exp_f32 v148, v148
    v_cvt_pk_bf16_f32 v52, v144, v145
    v_exp_f32 v149, v149
    v_mfma_f32_32x32x16_bf16 v[64:79], v[32:35], v[48:51], v[64:79]
    ds_read_b128 v[40:43], v2 offset:11264
    buffer_load_dwordx4 v8, s[4:7], s20 offen offset:1024 sc1 lds
    v_exp_f32 v150, v150
    v_cvt_pk_bf16_f32 v53, v146, v147
    v_exp_f32 v151, v151
    v_exp_f32 v152, v152
    v_cvt_pk_bf16_f32 v54, v148, v149
    v_exp_f32 v153, v153
    v_exp_f32 v154, v154
    v_cvt_pk_bf16_f32 v55, v150, v151
    v_exp_f32 v155, v155
    v_exp_f32 v156, v156
    v_cvt_pk_bf16_f32 v56, v152, v153
    v_exp_f32 v157, v157
    v_mfma_f32_32x32x16_bf16 v[80:95], v[28:31], v[52:55], v[80:95]
    buffer_load_dwordx4 v8, s[4:7], s20 offen offset:2048 sc1 lds
    v_exp_f32 v158, v158
    v_cvt_pk_bf16_f32 v57, v154, v155
    v_exp_f32 v159, v159
    v_exp_f32 v160, v160
    v_cvt_pk_bf16_f32 v58, v156, v157
    v_exp_f32 v161, v161
    v_cvt_pk_bf16_f32 v59, v158, v159
    v_exp_f32 v162, v162
    s_waitcnt lgkmcnt(2)
    v_mfma_f32_32x32x16_bf16 v[128:143], v[20:23], v[12:15], v[96:111]
    ds_add_u32 v60, v63 offset:256
    v_exp_f32 v163, v163
    v_exp_f32 v164, v164
    v_cvt_pk_bf16_f32 v44, v160, v161
    v_exp_f32 v165, v165
    v_mfma_f32_32x32x16_bf16 v[80:95], v[32:35], v[56:59], v[80:95]
    s_add_u32 s26, s26, 4
    s_add_u32 s27, s27, 4
    v_exp_f32 v166, v166
    v_cvt_pk_bf16_f32 v45, v162, v163
    v_exp_f32 v167, v167
    v_mfma_f32_32x32x16_bf16 v[144:159], v[20:23], v[16:19], v[112:127]
    ds_read_b128 v[24:27], v3 offset:3072
    s_waitcnt vmcnt(3)
    ds_add_u32 v60, v63 offset:0
    v_exp_f32 v168, v168
    v_cvt_pk_bf16_f32 v46, v164, v165
    v_exp_f32 v169, v169
    v_exp_f32 v170, v170
    v_cvt_pk_bf16_f32 v47, v166, v167
    v_exp_f32 v171, v171
    v_exp_f32 v172, v172
    v_cvt_pk_bf16_f32 v48, v168, v169
    v_exp_f32 v173, v173
    s_waitcnt lgkmcnt(3)
    v_mfma_f32_32x32x16_bf16 v[64:79], v[36:39], v[44:47], v[64:79]
    ds_read_b128 v[28:31], v3 offset:1024
    s_add_u32 s20, s20, 12288
    s_add_u32 s21, s21, 12288
    v_exp_f32 v174, v174
    v_cvt_pk_bf16_f32 v49, v170, v171
    v_exp_f32 v175, v175
    v_exp_f32 v176, v176
    v_cvt_pk_bf16_f32 v50, v172, v173
    v_exp_f32 v177, v177
    v_exp_f32 v178, v178
    v_cvt_pk_bf16_f32 v51, v174, v175
    v_exp_f32 v179, v179
    v_exp_f32 v180, v180
    v_cvt_pk_bf16_f32 v52, v176, v177
    v_exp_f32 v181, v181
    v_mfma_f32_32x32x16_bf16 v[64:79], v[40:43], v[48:51], v[64:79]
    ds_read_b128 v[32:35], v3 offset:2048
    s_cmp_eq_u32 s21, s24
    s_cselect_b32 s21, s23, s21
    v_exp_f32 v182, v182
    v_cvt_pk_bf16_f32 v53, v178, v179
    v_exp_f32 v183, v183
    v_exp_f32 v184, v184
    v_cvt_pk_bf16_f32 v54, v180, v181
    v_exp_f32 v185, v185
    v_exp_f32 v186, v186
    v_cvt_pk_bf16_f32 v55, v182, v183
    v_exp_f32 v187, v187
    v_exp_f32 v188, v188
    v_cvt_pk_bf16_f32 v56, v184, v185
    v_exp_f32 v189, v189
    v_mfma_f32_32x32x16_bf16 v[80:95], v[36:39], v[52:55], v[80:95]
    s_add_u32 s22, s22, 12288
    s_cmp_eq_u32 s22, 49152
    s_cselect_b32 s22, 0, s22
    v_exp_f32 v190, v190
    v_cvt_pk_bf16_f32 v57, v186, v187
    v_mov_b32 v2, v3
    v_exp_f32 v191, v191
    v_add_u32 v3, s22, v1
    s_sub_u32 s19, s19, 1
    s_cbranch_scc0 c_A_LOOP
    v_cvt_pk_bf16_f32 v58, v188, v189
    v_cvt_pk_bf16_f32 v59, v190, v191
    s_nop 1
    v_mfma_f32_32x32x16_bf16 v[80:95], v[40:43], v[56:59], v[80:95]
    s_nop 7
    s_nop 7
    v_mov_b32 v6, s25
    s_nop 1
    v_cmp_nlt_f32 vcc, v72, v6
    v_cmp_nlt_f32 s[38:39], v88, v6
    s_nop 1
    s_or_b64 vcc, vcc, s[38:39]
    s_nop 4
    s_cbranch_vccnz c_A_SLOW
c_A_FLAGBACK:
    v_rcp_f32 v4, v72
    v_rcp_f32 v5, v88
    v_and_b32 v6, 63, v0
    v_bfe_u32 v7, v6, 4, 1
    v_lshlrev_b32 v7, 14, v7
    v_lshrrev_b32 v2, 5, v6
    v_lshl_add_u32 v7, v2, 8, v7
    v_and_b32 v6, 15, v6
    v_lshl_add_u32 v7, v6, 4, v7
    s_lshl_b32 s23, s17, 4
    s_lshl_b32 s24, s18, 2
    s_add_u32 s23, s23, s24
    s_lshl_b32 s23, s23, 14
    s_lshr_b32 s24, s16, 1
    s_lshl_b32 s24, s24, 10
    s_add_u32 s23, s23, s24
    s_and_b32 s24, s16, 1
    s_lshl_b32 s24, s24, 9
    s_add_u32 s23, s23, s24
    v_mul_f32 v64, v4, v64
    v_mul_f32 v65, v4, v65
    v_mul_f32 v66, v4, v66
    v_mul_f32 v67, v4, v67
    v_mul_f32 v68, v4, v68
    v_mul_f32 v69, v4, v69
    v_mul_f32 v70, v4, v70
    v_mul_f32 v71, v4, v71
    v_cvt_pk_bf16_f32 v64, v64, v65
    v_cvt_pk_bf16_f32 v65, v66, v67
    v_cvt_pk_bf16_f32 v66, v68, v69
    v_cvt_pk_bf16_f32 v67, v70, v71
    buffer_store_dwordx4 v[64:67], v7, s[12:15], s23 offen sc1
    v_mul_f32 v80, v5, v80
    v_mul_f32 v81, v5, v81
    v_mul_f32 v82, v5, v82
    v_mul_f32 v83, v5, v83
    v_mul_f32 v84, v5, v84
    v_mul_f32 v85, v5, v85
    v_mul_f32 v86, v5, v86
    v_mul_f32 v87, v5, v87
    v_cvt_pk_bf16_f32 v80, v80, v81
    v_cvt_pk_bf16_f32 v81, v82, v83
    v_cvt_pk_bf16_f32 v82, v84, v85
    v_cvt_pk_bf16_f32 v83, v86, v87
    s_add_u32 s23, s23, 32768
    buffer_store_dwordx4 v[80:83], v7, s[12:15], s23 offen sc1
    s_waitcnt vmcnt(0) lgkmcnt(0)
    s_branch K4_ENTRY
c_ASPIN_R:
    ds_read_b32 v192, v60 offset:0
    s_waitcnt lgkmcnt(0)
    v_cmp_gt_u32 vcc, s26, v192
    s_nop 4
    s_cbranch_vccnz c_ASPIN_R
    s_branch c_ASPB_R
c_ASPIN_D:
    ds_read_b32 v192, v60 offset:256
    s_waitcnt lgkmcnt(0)
    v_cmp_gt_u32 vcc, s27, v192
    s_nop 4
    s_cbranch_vccnz c_ASPIN_D
    s_branch c_ASPB_D
c_A_SLOW:
    s_waitcnt vmcnt(0) lgkmcnt(0)
    s_mov_b32 s22, 0
    v_mov_b32 v9, 0
    v_mov_b32 v10, 0
    v_mov_b32 v4, 0xf149f2ca
    v_mov_b32 v5, 0xf149f2ca
c_A_SLOW_PASS:
    v_mov_b64 v[64:65], 0
    v_mov_b64 v[66:67], 0
    v_mov_b64 v[68:69], 0
    v_mov_b64 v[70:71], 0
    v_mov_b64 v[72:73], 0
    v_mov_b64 v[74:75], 0
    v_mov_b64 v[76:77], 0
    v_mov_b64 v[78:79], 0
    v_mov_b64 v[80:81], 0
    v_mov_b64 v[82:83], 0
    v_mov_b64 v[84:85], 0
    v_mov_b64 v[86:87], 0
    v_mov_b64 v[88:89], 0
    v_mov_b64 v[90:91], 0
    v_mov_b64 v[92:93], 0
    v_mov_b64 v[94:95], 0
    v_mov_b32 v96, v9
    v_mov_b32 v97, v9
    v_mov_b32 v98, v9
    v_mov_b32 v99, v9
    v_mov_b32 v100, v9
    v_mov_b32 v101, v9
    v_mov_b32 v102, v9
    v_mov_b32 v103, v9
    v_mov_b32 v104, v9
    v_mov_b32 v105, v9
    v_mov_b32 v106, v9
    v_mov_b32 v107, v9
    v_mov_b32 v108, v9
    v_mov_b32 v109, v9
    v_mov_b32 v110, v9
    v_mov_b32 v111, v9
    v_mov_b32 v112, v10
    v_mov_b32 v113, v10
    v_mov_b32 v114, v10
    v_mov_b32 v115, v10
    v_mov_b32 v116, v10
    v_mov_b32 v117, v10
    v_mov_b32 v118, v10
    v_mov_b32 v119, v10
    v_mov_b32 v120, v10
    v_mov_b32 v121, v10
    v_mov_b32 v122, v10
    v_mov_b32 v123, v10
    v_mov_b32 v124, v10
    v_mov_b32 v125, v10
    v_mov_b32 v126, v10
    v_mov_b32 v127, v10
    s_mov_b32 s19, 0
c_A_SLOW_TILE:
    buffer_load_dwordx4 v[20:23], v1, s[4:7], s19 offen sc1
    buffer_load_dwordx4 v[28:31], v1, s[4:7], s19 offen offset:1024 sc1
    buffer_load_dwordx4 v[32:35], v1, s[4:7], s19 offen offset:2048 sc1
    s_waitcnt vmcnt(0)
    v_mfma_f32_32x32x16_bf16 v[128:143], v[20:23], v[12:15], v[96:111]
    v_mfma_f32_32x32x16_bf16 v[144:159], v[20:23], v[16:19], v[112:127]
    s_nop 7
    s_nop 7
    s_cmp_eq_u32 s22, 0
    s_cbranch_scc0 c_A_SLOW_PV
    v_max3_f32 v4, v4, v128, v129
    v_max3_f32 v4, v4, v130, v131
    v_max3_f32 v4, v4, v132, v133
    v_max3_f32 v4, v4, v134, v135
    v_max3_f32 v4, v4, v136, v137
    v_max3_f32 v4, v4, v138, v139
    v_max3_f32 v4, v4, v140, v141
    v_max3_f32 v4, v4, v142, v143
    v_max3_f32 v5, v5, v144, v145
    v_max3_f32 v5, v5, v146, v147
    v_max3_f32 v5, v5, v148, v149
    v_max3_f32 v5, v5, v150, v151
    v_max3_f32 v5, v5, v152, v153
    v_max3_f32 v5, v5, v154, v155
    v_max3_f32 v5, v5, v156, v157
    v_max3_f32 v5, v5, v158, v159
    s_branch c_A_SLOW_NEXT
c_A_SLOW_PV:
    v_exp_f32 v128, v128
    v_exp_f32 v129, v129
    v_exp_f32 v130, v130
    v_exp_f32 v131, v131
    v_exp_f32 v132, v132
    v_exp_f32 v133, v133
    v_exp_f32 v134, v134
    v_exp_f32 v135, v135
    v_exp_f32 v136, v136
    v_exp_f32 v137, v137
    v_exp_f32 v138, v138
    v_exp_f32 v139, v139
    v_exp_f32 v140, v140
    v_exp_f32 v141, v141
    v_exp_f32 v142, v142
    v_exp_f32 v143, v143
    v_exp_f32 v144, v144
    v_exp_f32 v145, v145
    v_exp_f32 v146, v146
    v_exp_f32 v147, v147
    v_exp_f32 v148, v148
    v_exp_f32 v149, v149
    v_exp_f32 v150, v150
    v_exp_f32 v151, v151
    v_exp_f32 v152, v152
    v_exp_f32 v153, v153
    v_exp_f32 v154, v154
    v_exp_f32 v155, v155
    v_exp_f32 v156, v156
    v_exp_f32 v157, v157
    v_exp_f32 v158, v158
    v_exp_f32 v159, v159
    s_nop 0
    v_cvt_pk_bf16_f32 v44, v128, v129
    v_cvt_pk_bf16_f32 v45, v130, v131
    v_cvt_pk_bf16_f32 v46, v132, v133
    v_cvt_pk_bf16_f32 v47, v134, v135
    v_cvt_pk_bf16_f32 v48, v136, v137
    v_cvt_pk_bf16_f32 v49, v138, v139
    v_cvt_pk_bf16_f32 v50, v140, v141
    v_cvt_pk_bf16_f32 v51, v142, v143
    v_cvt_pk_bf16_f32 v52, v144, v145
    v_cvt_pk_bf16_f32 v53, v146, v147
    v_cvt_pk_bf16_f32 v54, v148, v149
    v_cvt_pk_bf16_f32 v55, v150, v151
    v_cvt_pk_bf16_f32 v56, v152, v153
    v_cvt_pk_bf16_f32 v57, v154, v155
    v_cvt_pk_bf16_f32 v58, v156, v157
    v_cvt_pk_bf16_f32 v59, v158, v159
    s_nop 1
    v_mfma_f32_32x32x16_bf16 v[64:79], v[28:31], v[44:47], v[64:79]
    v_mfma_f32_32x32x16_bf16 v[64:79], v[32:35], v[48:51], v[64:79]
    v_mfma_f32_32x32x16_bf16 v[80:95], v[28:31], v[52:55], v[80:95]
    v_mfma_f32_32x32x16_bf16 v[80:95], v[32:35], v[56:59], v[80:95]
    s_nop 7
c_A_SLOW_NEXT:
    s_add_u32 s19, s19, 3072
    s_cmp_lt_u32 s19, 196608
    s_cbranch_scc1 c_A_SLOW_TILE
    s_cmp_eq_u32 s22, 0
    s_cbranch_scc0 c_A_SLOW_DONE
    v_mov_b32 v6, v4
    v_mov_b32 v7, v5
    s_nop 1
    v_permlane32_swap_b32 v4, v6
    v_permlane32_swap_b32 v5, v7
    s_nop 1
    v_max_f32 v4, v4, v6
    v_max_f32 v5, v5, v7
    v_sub_f32 v9, 0, v4
    v_sub_f32 v10, 0, v5
    s_mov_b32 s22, 1
    s_branch c_A_SLOW_PASS
c_A_SLOW_DONE:
    s_nop 7
    s_nop 7
    s_branch c_A_FLAGBACK
c_M_B:
    s_sub_u32 s18, s18, 4
    s_load_dwordx2 s[34:35], s[0:1], 88
    s_load_dwordx2 s[36:37], s[0:1], 64
    s_load_dwordx2 s[40:41], s[0:1], 72
    v_and_b32 v1, 63, v0
    v_lshlrev_b32 v2, 4, v1
    s_and_b32 s22, s2, 7
    s_lshl_b32 s22, s22, 2
    s_bfe_u32 s16, s2, 0x20003
    s_add_u32 s16, s16, s22
    s_lshr_b32 s17, s2, 5
    v_lshrrev_b32 v3, 3, v1
    v_lshlrev_b32 v3, 10, v3
    v_lshrrev_b32 v4, 4, v1
    v_lshlrev_b32 v5, 1, v4
    v_and_b32 v6, 7, v1
    v_xor_b32 v5, v5, v6
    v_lshl_add_u32 v8, v5, 4, v3
    v_add_u32 v9, 7168, v8
    v_add_u32 v10, 14336, v8
    v_add_u32 v11, 21504, v8
    v_and_b32 v3, 15, v1
    v_lshrrev_b32 v5, 2, v3
    s_mul_i32 s25, s18, 16384
    s_add_u32 s25, s25, 50176
    v_lshl_add_u32 v6, v4, 2, v5
    v_bfe_u32 v56, v6, 1, 2
    v_lshlrev_b32 v6, 7, v6
    v_and_b32 v57, 3, v3
    v_lshl_add_u32 v6, v57, 3, v6
    v_add_u32 v6, s25, v6
    v_xor_b32 v57, 0, v56
    v_lshl_add_u32 v12, v57, 5, v6
    v_xor_b32 v57, 1, v56
    v_lshl_add_u32 v13, v57, 5, v6
    v_xor_b32 v57, 2, v56
    v_lshl_add_u32 v14, v57, 5, v6
    v_xor_b32 v57, 3, v56
    v_lshl_add_u32 v15, v57, 5, v6
    v_mov_b64 v[64:65], 0
    v_mov_b64 v[66:67], 0
    v_mov_b64 v[68:69], 0
    v_mov_b64 v[70:71], 0
    v_mov_b64 v[72:73], 0
    v_mov_b64 v[74:75], 0
    v_mov_b64 v[76:77], 0
    v_mov_b64 v[78:79], 0
    v_mov_b64 v[80:81], 0
    v_mov_b64 v[82:83], 0
    v_mov_b64 v[84:85], 0
    v_mov_b64 v[86:87], 0
    v_mov_b64 v[88:89], 0
    v_mov_b64 v[90:91], 0
    v_mov_b64 v[92:93], 0
    v_mov_b64 v[94:95], 0
    v_mov_b64 v[96:97], 0
    v_mov_b64 v[98:99], 0
    v_mov_b64 v[100:101], 0
    v_mov_b64 v[102:103], 0
    v_mov_b64 v[104:105], 0
    v_mov_b64 v[106:107], 0
    v_mov_b64 v[108:109], 0
    v_mov_b64 v[110:111], 0
    v_mov_b64 v[112:113], 0
    v_mov_b64 v[114:115], 0
    v_mov_b64 v[116:117], 0
    v_mov_b64 v[118:119], 0
    v_mov_b64 v[120:121], 0
    v_mov_b64 v[122:123], 0
    v_mov_b64 v[124:125], 0
    v_mov_b64 v[126:127], 0
    v_add_u32 v21, 4096, v2
    s_waitcnt lgkmcnt(0)
    s_add_u32 s4, s36, 0
    s_addc_u32 s5, s37, 0
    s_mov_b32 s6, 4194304
    s_mov_b32 s7, 0x20000
    s_add_u32 s8, s34, 50331648
    s_addc_u32 s9, s35, 0
    s_mov_b32 s10, 16777216
    s_mov_b32 s11, 0x20000
    s_add_u32 s12, s40, 0
    s_addc_u32 s13, s41, 0
    s_mov_b32 s14, 4194304
    s_mov_b32 s15, 0x20000
    s_lshl_b32 s20, s18, 20
    s_lshl_b32 s22, s17, 7
    s_add_u32 s20, s20, s22
    s_lshl_b32 s21, s16, 19
    s_lshl_b32 s22, s18, 16
    s_add_u32 s21, s21, s22
    s_add_u32 s24, s21, 262144
    s_mov_b32 s26, 0
    v_mov_b32 v5, 115712
    v_mov_b32 v6, 0
    ds_write_b32 v5, v6
    ds_write_b32 v5, v6 offset:4
    s_waitcnt vmcnt(0) lgkmcnt(0)
    s_barrier
    v_mov_b32 v5, 115712
    s_cmp_eq_u32 s18, 0
    s_cbranch_scc0 c_B_SPIN
    s_lshr_b32 s22, s2, 5
    s_add_u32 s22, s22, 64
    s_lshl_b32 s60, s22, 7
    s_lshl_b32 s61, s16, 2
    s_add_u32 s60, s60, s61
    v_and_b32 v3, 63, v0
    v_lshlrev_b32 v3, 16, v3
    v_mov_b32 v4, s63
    buffer_store_dword v4, v3, s[56:59], s60 offen sc1
    s_lshr_b32 s22, s16, 1
    s_sub_u32 s23, 15, s22
    s_min_u32 s22, s22, s23
    s_add_u32 s22, s22, 64
    v_and_b32 v3, 31, v0
    v_lshlrev_b32 v3, 2, v3
    s_lshl_b32 s62, s22, 7
    s_mov_b32 s61, 0
c_W_C:
    buffer_load_dword v4, v3, s[56:59], s62 offen sc1
    s_waitcnt vmcnt(0)
    v_cmp_ne_u32 vcc, s63, v4
    s_nop 4
    s_cbranch_vccz c_WOK_C
    s_sleep 8
    s_add_u32 s61, s61, 1
    s_cmp_lt_u32 s61, 65536
    s_cbranch_scc1 c_W_C
c_WOK_C:
    v_mov_b32 v6, 1
    ds_write_b32 v5, v6
    s_waitcnt lgkmcnt(0)
    s_branch c_B_GO
c_B_SPIN0:
    s_sleep 2
c_B_SPIN:
    ds_read_b32 v6, v5
    s_waitcnt lgkmcnt(0)
    v_cmp_eq_u32 vcc, 0, v6
    s_nop 4
    s_cbranch_vccnz c_B_SPIN0
c_B_GO:
    s_mov_b32 s26, 0
    s_add_u32 m0, s25, 0
    s_nop 0
    buffer_load_dwordx4 v8, s[4:7], s20 offen offset:0 lds
    buffer_load_dwordx4 v9, s[4:7], s20 offen offset:1024 lds
    buffer_load_dwordx4 v10, s[4:7], s20 offen offset:2048 lds
    buffer_load_dwordx4 v11, s[4:7], s20 offen offset:3072 lds
    buffer_load_dwordx4 v[128:131], v2, s[8:11], s21 offen sc1
    buffer_load_dwordx4 v[132:135], v21, s[8:11], s21 offen sc1
    buffer_load_dwordx4 v[136:139], v2, s[8:11], s24 offen sc1
    buffer_load_dwordx4 v[140:143], v21, s[8:11], s24 offen sc1
    s_add_u32 s20, s20, 32768
    s_and_b32 s22, s26, 3
    s_cmp_eq_u32 s22, 3
    s_cselect_b32 s22, 4096, 0
    s_add_u32 s22, s22, 1024
    s_add_u32 s21, s21, s22
    s_add_u32 s24, s24, s22
    s_add_u32 s26, s26, 1
    s_cmp_ge_u32 s26, 32
    s_cselect_b32 s6, 0, s6
    s_cselect_b32 s10, 0, s10
    s_add_u32 m0, s25, 4096
    s_nop 0
    buffer_load_dwordx4 v8, s[4:7], s20 offen offset:0 lds
    buffer_load_dwordx4 v9, s[4:7], s20 offen offset:1024 lds
    buffer_load_dwordx4 v10, s[4:7], s20 offen offset:2048 lds
    buffer_load_dwordx4 v11, s[4:7], s20 offen offset:3072 lds
    buffer_load_dwordx4 v[144:147], v2, s[8:11], s21 offen sc1
    buffer_load_dwordx4 v[148:151], v21, s[8:11], s21 offen sc1
    buffer_load_dwordx4 v[152:155], v2, s[8:11], s24 offen sc1
    buffer_load_dwordx4 v[156:159], v21, s[8:11], s24 offen sc1
    s_add_u32 s20, s20, 32768
    s_and_b32 s22, s26, 3
    s_cmp_eq_u32 s22, 3
    s_cselect_b32 s22, 4096, 0
    s_add_u32 s22, s22, 1024
    s_add_u32 s21, s21, s22
    s_add_u32 s24, s24, s22
    s_add_u32 s26, s26, 1
    s_cmp_ge_u32 s26, 32
    s_cselect_b32 s6, 0, s6
    s_cselect_b32 s10, 0, s10
    s_add_u32 m0, s25, 8192
    s_nop 0
    buffer_load_dwordx4 v8, s[4:7], s20 offen offset:0 lds
    buffer_load_dwordx4 v9, s[4:7], s20 offen offset:1024 lds
    buffer_load_dwordx4 v10, s[4:7], s20 offen offset:2048 lds
    buffer_load_dwordx4 v11, s[4:7], s20 offen offset:3072 lds
    buffer_load_dwordx4 v[160:163], v2, s[8:11], s21 offen sc1
    buffer_load_dwordx4 v[164:167], v21, s[8:11], s21 offen sc1
    buffer_load_dwordx4 v[168:171], v2, s[8:11], s24 offen sc1
    buffer_load_dwordx4 v[172:175], v21, s[8:11], s24 offen sc1
    s_add_u32 s20, s20, 32768
    s_and_b32 s22, s26, 3
    s_cmp_eq_u32 s22, 3
    s_cselect_b32 s22, 4096, 0
    s_add_u32 s22, s22, 1024
    s_add_u32 s21, s21, s22
    s_add_u32 s24, s24, s22
    s_add_u32 s26, s26, 1
    s_cmp_ge_u32 s26, 32
    s_cselect_b32 s6, 0, s6
    s_cselect_b32 s10, 0, s10
    s_add_u32 m0, s25, 12288
    s_nop 0
    buffer_load_dwordx4 v8, s[4:7], s20 offen offset:0 lds
    buffer_load_dwordx4 v9, s[4:7], s20 offen offset:1024 lds
    buffer_load_dwordx4 v10, s[4:7], s20 offen offset:2048 lds
    buffer_load_dwordx4 v11, s[4:7], s20 offen offset:3072 lds
    buffer_load_dwordx4 v[176:179], v2, s[8:11], s21 offen sc1
    buffer_load_dwordx4 v[180:183], v21, s[8:11], s21 offen sc1
    buffer_load_dwordx4 v[184:187], v2, s[8:11], s24 offen sc1
    buffer_load_dwordx4 v[188:191], v21, s[8:11], s24 offen sc1
    s_add_u32 s20, s20, 32768
    s_and_b32 s22, s26, 3
    s_cmp_eq_u32 s22, 3
    s_cselect_b32 s22, 4096, 0
    s_add_u32 s22, s22, 1024
    s_add_u32 s21, s21, s22
    s_add_u32 s24, s24, s22
    s_add_u32 s26, s26, 1
    s_cmp_ge_u32 s26, 32
    s_cselect_b32 s6, 0, s6
    s_cselect_b32 s10, 0, s10
    s_waitcnt vmcnt(24)
    ds_read_b64_tr_b16 v[24:25], v12 offset:0
    ds_read_b64_tr_b16 v[26:27], v12 offset:2048
    ds_read_b64_tr_b16 v[28:29], v13 offset:0
    ds_read_b64_tr_b16 v[30:31], v13 offset:2048
    ds_read_b64_tr_b16 v[32:33], v14 offset:0
    ds_read_b64_tr_b16 v[34:35], v14 offset:2048
    ds_read_b64_tr_b16 v[36:37], v15 offset:0
    ds_read_b64_tr_b16 v[38:39], v15 offset:2048
    s_waitcnt lgkmcnt(0)
    s_mov_b32 s19, 7
c_B_LOOP:
    s_waitcnt vmcnt(16)
    v_mfma_f32_16x16x32_bf16 v[64:67], v[24:27], v[128:131], v[64:67]
    ds_read_b64_tr_b16 v[40:41], v12 offset:4096
    v_mfma_f32_16x16x32_bf16 v[80:83], v[28:31], v[128:131], v[80:83]
    ds_read_b64_tr_b16 v[42:43], v12 offset:6144
    v_mfma_f32_16x16x32_bf16 v[96:99], v[32:35], v[128:131], v[96:99]
    ds_read_b64_tr_b16 v[44:45], v13 offset:4096
    v_mfma_f32_16x16x32_bf16 v[112:115], v[36:39], v[128:131], v[112:115]
    ds_read_b64_tr_b16 v[46:47], v13 offset:6144
    s_add_u32 m0, s25, 0
    buffer_load_dwordx4 v[128:131], v2, s[8:11], s21 offen sc1
    v_mfma_f32_16x16x32_bf16 v[68:71], v[24:27], v[132:135], v[68:71]
    ds_read_b64_tr_b16 v[48:49], v14 offset:4096
    v_mfma_f32_16x16x32_bf16 v[84:87], v[28:31], v[132:135], v[84:87]
    ds_read_b64_tr_b16 v[50:51], v14 offset:6144
    v_mfma_f32_16x16x32_bf16 v[100:103], v[32:35], v[132:135], v[100:103]
    ds_read_b64_tr_b16 v[52:53], v15 offset:4096
    v_mfma_f32_16x16x32_bf16 v[116:119], v[36:39], v[132:135], v[116:119]
    ds_read_b64_tr_b16 v[54:55], v15 offset:6144
    buffer_load_dwordx4 v[132:135], v21, s[8:11], s21 offen sc1
    buffer_load_dwordx4 v8, s[4:7], s20 offen offset:0 lds
    v_mfma_f32_16x16x32_bf16 v[72:75], v[24:27], v[136:139], v[72:75]
    v_mfma_f32_16x16x32_bf16 v[88:91], v[28:31], v[136:139], v[88:91]
    v_mfma_f32_16x16x32_bf16 v[104:107], v[32:35], v[136:139], v[104:107]
    v_mfma_f32_16x16x32_bf16 v[120:123], v[36:39], v[136:139], v[120:123]
    buffer_load_dwordx4 v[136:139], v2, s[8:11], s24 offen sc1
    buffer_load_dwordx4 v9, s[4:7], s20 offen offset:1024 lds
    v_mfma_f32_16x16x32_bf16 v[76:79], v[24:27], v[140:143], v[76:79]
    v_mfma_f32_16x16x32_bf16 v[92:95], v[28:31], v[140:143], v[92:95]
    v_mfma_f32_16x16x32_bf16 v[108:111], v[32:35], v[140:143], v[108:111]
    v_mfma_f32_16x16x32_bf16 v[124:127], v[36:39], v[140:143], v[124:127]
    buffer_load_dwordx4 v[140:143], v21, s[8:11], s24 offen sc1
    buffer_load_dwordx4 v10, s[4:7], s20 offen offset:2048 lds
    buffer_load_dwordx4 v11, s[4:7], s20 offen offset:3072 lds
    s_add_u32 s20, s20, 32768
    s_and_b32 s22, s26, 3
    s_cmp_eq_u32 s22, 3
    s_cselect_b32 s22, 4096, 0
    s_add_u32 s22, s22, 1024
    s_add_u32 s21, s21, s22
    s_add_u32 s24, s24, s22
    s_add_u32 s26, s26, 1
    s_cmp_ge_u32 s26, 32
    s_cselect_b32 s6, 0, s6
    s_cselect_b32 s10, 0, s10
    s_waitcnt lgkmcnt(0)
    s_waitcnt vmcnt(16)
    v_mfma_f32_16x16x32_bf16 v[64:67], v[40:43], v[144:147], v[64:67]
    ds_read_b64_tr_b16 v[24:25], v12 offset:8192
    v_mfma_f32_16x16x32_bf16 v[80:83], v[44:47], v[144:147], v[80:83]
    ds_read_b64_tr_b16 v[26:27], v12 offset:10240
    v_mfma_f32_16x16x32_bf16 v[96:99], v[48:51], v[144:147], v[96:99]
    ds_read_b64_tr_b16 v[28:29], v13 offset:8192
    v_mfma_f32_16x16x32_bf16 v[112:115], v[52:55], v[144:147], v[112:115]
    ds_read_b64_tr_b16 v[30:31], v13 offset:10240
    s_add_u32 m0, s25, 4096
    buffer_load_dwordx4 v[144:147], v2, s[8:11], s21 offen sc1
    v_mfma_f32_16x16x32_bf16 v[68:71], v[40:43], v[148:151], v[68:71]
    ds_read_b64_tr_b16 v[32:33], v14 offset:8192
    v_mfma_f32_16x16x32_bf16 v[84:87], v[44:47], v[148:151], v[84:87]
    ds_read_b64_tr_b16 v[34:35], v14 offset:10240
    v_mfma_f32_16x16x32_bf16 v[100:103], v[48:51], v[148:151], v[100:103]
    ds_read_b64_tr_b16 v[36:37], v15 offset:8192
    v_mfma_f32_16x16x32_bf16 v[116:119], v[52:55], v[148:151], v[116:119]
    ds_read_b64_tr_b16 v[38:39], v15 offset:10240
    buffer_load_dwordx4 v[148:151], v21, s[8:11], s21 offen sc1
    buffer_load_dwordx4 v8, s[4:7], s20 offen offset:0 lds
    v_mfma_f32_16x16x32_bf16 v[72:75], v[40:43], v[152:155], v[72:75]
    v_mfma_f32_16x16x32_bf16 v[88:91], v[44:47], v[152:155], v[88:91]
    v_mfma_f32_16x16x32_bf16 v[104:107], v[48:51], v[152:155], v[104:107]
    v_mfma_f32_16x16x32_bf16 v[120:123], v[52:55], v[152:155], v[120:123]
    buffer_load_dwordx4 v[152:155], v2, s[8:11], s24 offen sc1
    buffer_load_dwordx4 v9, s[4:7], s20 offen offset:1024 lds
    v_mfma_f32_16x16x32_bf16 v[76:79], v[40:43], v[156:159], v[76:79]
    v_mfma_f32_16x16x32_bf16 v[92:95], v[44:47], v[156:159], v[92:95]
    v_mfma_f32_16x16x32_bf16 v[108:111], v[48:51], v[156:159], v[108:111]
    v_mfma_f32_16x16x32_bf16 v[124:127], v[52:55], v[156:159], v[124:127]
    buffer_load_dwordx4 v[156:159], v21, s[8:11], s24 offen sc1
    buffer_load_dwordx4 v10, s[4:7], s20 offen offset:2048 lds
    buffer_load_dwordx4 v11, s[4:7], s20 offen offset:3072 lds
    s_add_u32 s20, s20, 32768
    s_and_b32 s22, s26, 3
    s_cmp_eq_u32 s22, 3
    s_cselect_b32 s22, 4096, 0
    s_add_u32 s22, s22, 1024
    s_add_u32 s21, s21, s22
    s_add_u32 s24, s24, s22
    s_add_u32 s26, s26, 1
    s_cmp_ge_u32 s26, 32
    s_cselect_b32 s6, 0, s6
    s_cselect_b32 s10, 0, s10
    s_waitcnt lgkmcnt(0)
    s_waitcnt vmcnt(16)
    v_mfma_f32_16x16x32_bf16 v[64:67], v[24:27], v[160:163], v[64:67]
    ds_read_b64_tr_b16 v[40:41], v12 offset:12288
    v_mfma_f32_16x16x32_bf16 v[80:83], v[28:31], v[160:163], v[80:83]
    ds_read_b64_tr_b16 v[42:43], v12 offset:14336
    v_mfma_f32_16x16x32_bf16 v[96:99], v[32:35], v[160:163], v[96:99]
    ds_read_b64_tr_b16 v[44:45], v13 offset:12288
    v_mfma_f32_16x16x32_bf16 v[112:115], v[36:39], v[160:163], v[112:115]
    ds_read_b64_tr_b16 v[46:47], v13 offset:14336
    s_add_u32 m0, s25, 8192
    buffer_load_dwordx4 v[160:163], v2, s[8:11], s21 offen sc1
    v_mfma_f32_16x16x32_bf16 v[68:71], v[24:27], v[164:167], v[68:71]
    ds_read_b64_tr_b16 v[48:49], v14 offset:12288
    v_mfma_f32_16x16x32_bf16 v[84:87], v[28:31], v[164:167], v[84:87]
    ds_read_b64_tr_b16 v[50:51], v14 offset:14336
    v_mfma_f32_16x16x32_bf16 v[100:103], v[32:35], v[164:167], v[100:103]
    ds_read_b64_tr_b16 v[52:53], v15 offset:12288
    v_mfma_f32_16x16x32_bf16 v[116:119], v[36:39], v[164:167], v[116:119]
    ds_read_b64_tr_b16 v[54:55], v15 offset:14336
    buffer_load_dwordx4 v[164:167], v21, s[8:11], s21 offen sc1
    buffer_load_dwordx4 v8, s[4:7], s20 offen offset:0 lds
    v_mfma_f32_16x16x32_bf16 v[72:75], v[24:27], v[168:171], v[72:75]
    v_mfma_f32_16x16x32_bf16 v[88:91], v[28:31], v[168:171], v[88:91]
    v_mfma_f32_16x16x32_bf16 v[104:107], v[32:35], v[168:171], v[104:107]
    v_mfma_f32_16x16x32_bf16 v[120:123], v[36:39], v[168:171], v[120:123]
    buffer_load_dwordx4 v[168:171], v2, s[8:11], s24 offen sc1
    buffer_load_dwordx4 v9, s[4:7], s20 offen offset:1024 lds
    v_mfma_f32_16x16x32_bf16 v[76:79], v[24:27], v[172:175], v[76:79]
    v_mfma_f32_16x16x32_bf16 v[92:95], v[28:31], v[172:175], v[92:95]
    v_mfma_f32_16x16x32_bf16 v[108:111], v[32:35], v[172:175], v[108:111]
    v_mfma_f32_16x16x32_bf16 v[124:127], v[36:39], v[172:175], v[124:127]
    buffer_load_dwordx4 v[172:175], v21, s[8:11], s24 offen sc1
    buffer_load_dwordx4 v10, s[4:7], s20 offen offset:2048 lds
    buffer_load_dwordx4 v11, s[4:7], s20 offen offset:3072 lds
    s_add_u32 s20, s20, 32768
    s_and_b32 s22, s26, 3
    s_cmp_eq_u32 s22, 3
    s_cselect_b32 s22, 4096, 0
    s_add_u32 s22, s22, 1024
    s_add_u32 s21, s21, s22
    s_add_u32 s24, s24, s22
    s_add_u32 s26, s26, 1
    s_cmp_ge_u32 s26, 32
    s_cselect_b32 s6, 0, s6
    s_cselect_b32 s10, 0, s10
    s_waitcnt lgkmcnt(0)
    s_waitcnt vmcnt(16)
    v_mfma_f32_16x16x32_bf16 v[64:67], v[40:43], v[176:179], v[64:67]
    ds_read_b64_tr_b16 v[24:25], v12 offset:0
    v_mfma_f32_16x16x32_bf16 v[80:83], v[44:47], v[176:179], v[80:83]
    ds_read_b64_tr_b16 v[26:27], v12 offset:2048
    v_mfma_f32_16x16x32_bf16 v[96:99], v[48:51], v[176:179], v[96:99]
    ds_read_b64_tr_b16 v[28:29], v13 offset:0
    v_mfma_f32_16x16x32_bf16 v[112:115], v[52:55], v[176:179], v[112:115]
    ds_read_b64_tr_b16 v[30:31], v13 offset:2048
    s_add_u32 m0, s25, 12288
    buffer_load_dwordx4 v[176:179], v2, s[8:11], s21 offen sc1
    v_mfma_f32_16x16x32_bf16 v[68:71], v[40:43], v[180:183], v[68:71]
    ds_read_b64_tr_b16 v[32:33], v14 offset:0
    v_mfma_f32_16x16x32_bf16 v[84:87], v[44:47], v[180:183], v[84:87]
    ds_read_b64_tr_b16 v[34:35], v14 offset:2048
    v_mfma_f32_16x16x32_bf16 v[100:103], v[48:51], v[180:183], v[100:103]
    ds_read_b64_tr_b16 v[36:37], v15 offset:0
    v_mfma_f32_16x16x32_bf16 v[116:119], v[52:55], v[180:183], v[116:119]
    ds_read_b64_tr_b16 v[38:39], v15 offset:2048
    buffer_load_dwordx4 v[180:183], v21, s[8:11], s21 offen sc1
    buffer_load_dwordx4 v8, s[4:7], s20 offen offset:0 lds
    v_mfma_f32_16x16x32_bf16 v[72:75], v[40:43], v[184:187], v[72:75]
    v_mfma_f32_16x16x32_bf16 v[88:91], v[44:47], v[184:187], v[88:91]
    v_mfma_f32_16x16x32_bf16 v[104:107], v[48:51], v[184:187], v[104:107]
    v_mfma_f32_16x16x32_bf16 v[120:123], v[52:55], v[184:187], v[120:123]
    buffer_load_dwordx4 v[184:187], v2, s[8:11], s24 offen sc1
    buffer_load_dwordx4 v9, s[4:7], s20 offen offset:1024 lds
    v_mfma_f32_16x16x32_bf16 v[76:79], v[40:43], v[188:191], v[76:79]
    v_mfma_f32_16x16x32_bf16 v[92:95], v[44:47], v[188:191], v[92:95]
    v_mfma_f32_16x16x32_bf16 v[108:111], v[48:51], v[188:191], v[108:111]
    v_mfma_f32_16x16x32_bf16 v[124:127], v[52:55], v[188:191], v[124:127]
    buffer_load_dwordx4 v[188:191], v21, s[8:11], s24 offen sc1
    buffer_load_dwordx4 v10, s[4:7], s20 offen offset:2048 lds
    buffer_load_dwordx4 v11, s[4:7], s20 offen offset:3072 lds
    s_add_u32 s20, s20, 32768
    s_and_b32 s22, s26, 3
    s_cmp_eq_u32 s22, 3
    s_cselect_b32 s22, 4096, 0
    s_add_u32 s22, s22, 1024
    s_add_u32 s21, s21, s22
    s_add_u32 s24, s24, s22
    s_add_u32 s26, s26, 1
    s_cmp_ge_u32 s26, 32
    s_cselect_b32 s6, 0, s6
    s_cselect_b32 s10, 0, s10
    s_waitcnt lgkmcnt(0)
    s_sub_u32 s19, s19, 1
    s_cbranch_scc0 c_B_LOOP
    s_waitcnt vmcnt(0)
    s_lshl_b32 s22, s18, 14
    s_add_u32 s22, s22, 50176
    v_add_u32 v3, s22, v2
    ds_write_b128 v3, v[64:67] offset:0
    ds_write_b128 v3, v[68:71] offset:1024
    ds_write_b128 v3, v[72:75] offset:2048
    ds_write_b128 v3, v[76:79] offset:3072
    ds_write_b128 v3, v[80:83] offset:4096
    ds_write_b128 v3, v[84:87] offset:5120
    ds_write_b128 v3, v[88:91] offset:6144
    ds_write_b128 v3, v[92:95] offset:7168
    ds_write_b128 v3, v[96:99] offset:8192
    ds_write_b128 v3, v[100:103] offset:9216
    ds_write_b128 v3, v[104:107] offset:10240
    ds_write_b128 v3, v[108:111] offset:11264
    ds_write_b128 v3, v[112:115] offset:12288
    ds_write_b128 v3, v[116:119] offset:13312
    ds_write_b128 v3, v[120:123] offset:14336
    ds_write_b128 v3, v[124:127] offset:15360
    s_waitcnt lgkmcnt(0)
    v_mov_b32 v5, 115712
    v_cmp_eq_u32 vcc, 0, v1
    s_nop 1
    v_cndmask_b32 v6, 0, 1, vcc
    ds_add_u32 v5, v6 offset:4
c_B_RED:
    ds_read_b32 v6, v5 offset:4
    s_waitcnt lgkmcnt(0)
    v_cmp_gt_u32 vcc, 4, v6
    s_nop 4
    s_cbranch_vccnz c_B_RED
    s_lshl_b32 s22, s18, 10
    s_add_u32 s22, s22, 50176
    v_add_u32 v3, s22, v2
    ds_read_b128 v[64:67], v3 offset:0
    ds_read_b128 v[68:71], v3 offset:16384
    ds_read_b128 v[72:75], v3 offset:32768
    ds_read_b128 v[76:79], v3 offset:49152
    ds_read_b128 v[80:83], v3 offset:4096
    ds_read_b128 v[84:87], v3 offset:20480
    ds_read_b128 v[88:91], v3 offset:36864
    ds_read_b128 v[92:95], v3 offset:53248
    ds_read_b128 v[96:99], v3 offset:8192
    ds_read_b128 v[100:103], v3 offset:24576
    ds_read_b128 v[104:107], v3 offset:40960
    ds_read_b128 v[108:111], v3 offset:57344
    ds_read_b128 v[112:115], v3 offset:12288
    ds_read_b128 v[116:119], v3 offset:28672
    ds_read_b128 v[120:123], v3 offset:45056
    ds_read_b128 v[124:127], v3 offset:61440
    v_and_b32 v4, 15, v1
    v_lshlrev_b32 v4, 11, v4
    v_lshrrev_b32 v5, 4, v1
    v_lshl_add_u32 v20, v5, 3, v4
    s_lshl_b32 s22, s16, 17
    s_lshl_b32 s23, s18, 15
    s_add_u32 s22, s22, s23
    s_lshl_b32 s23, s17, 7
    s_add_u32 s22, s22, s23
    s_add_u32 s22, s22, 1024
    s_waitcnt lgkmcnt(12)
    v_add_f32 v64, v64, v68
    v_add_f32 v72, v72, v76
    v_add_f32 v65, v65, v69
    v_add_f32 v73, v73, v77
    v_add_f32 v66, v66, v70
    v_add_f32 v74, v74, v78
    v_add_f32 v67, v67, v71
    v_add_f32 v75, v75, v79
    v_add_f32 v64, v64, v72
    v_add_f32 v65, v65, v73
    v_add_f32 v66, v66, v74
    v_add_f32 v67, v67, v75
    v_cvt_pk_bf16_f32 v56, v64, v65
    v_cvt_pk_bf16_f32 v57, v66, v67
    buffer_store_dwordx2 v[56:57], v20, s[12:15], s22 offen offset:0
    s_waitcnt lgkmcnt(8)
    v_add_f32 v80, v80, v84
    v_add_f32 v88, v88, v92
    v_add_f32 v81, v81, v85
    v_add_f32 v89, v89, v93
    v_add_f32 v82, v82, v86
    v_add_f32 v90, v90, v94
    v_add_f32 v83, v83, v87
    v_add_f32 v91, v91, v95
    v_add_f32 v80, v80, v88
    v_add_f32 v81, v81, v89
    v_add_f32 v82, v82, v90
    v_add_f32 v83, v83, v91
    v_cvt_pk_bf16_f32 v58, v80, v81
    v_cvt_pk_bf16_f32 v59, v82, v83
    buffer_store_dwordx2 v[58:59], v20, s[12:15], s22 offen offset:32
    s_waitcnt lgkmcnt(4)
    v_add_f32 v96, v96, v100
    v_add_f32 v104, v104, v108
    v_add_f32 v97, v97, v101
    v_add_f32 v105, v105, v109
    v_add_f32 v98, v98, v102
    v_add_f32 v106, v106, v110
    v_add_f32 v99, v99, v103
    v_add_f32 v107, v107, v111
    v_add_f32 v96, v96, v104
    v_add_f32 v97, v97, v105
    v_add_f32 v98, v98, v106
    v_add_f32 v99, v99, v107
    v_cvt_pk_bf16_f32 v60, v96, v97
    v_cvt_pk_bf16_f32 v61, v98, v99
    buffer_store_dwordx2 v[60:61], v20, s[12:15], s22 offen offset:64
    s_waitcnt lgkmcnt(0)
    v_add_f32 v112, v112, v116
    v_add_f32 v120, v120, v124
    v_add_f32 v113, v113, v117
    v_add_f32 v121, v121, v125
    v_add_f32 v114, v114, v118
    v_add_f32 v122, v122, v126
    v_add_f32 v115, v115, v119
    v_add_f32 v123, v123, v127
    v_add_f32 v112, v112, v120
    v_add_f32 v113, v113, v121
    v_add_f32 v114, v114, v122
    v_add_f32 v115, v115, v123
    v_cvt_pk_bf16_f32 v62, v112, v113
    v_cvt_pk_bf16_f32 v63, v114, v115
    buffer_store_dwordx2 v[62:63], v20, s[12:15], s22 offen offset:96
    s_waitcnt vmcnt(0) lgkmcnt(0)
    s_endpgm
K4_ENTRY:
    s_load_dwordx2 s[34:35], s[0:1], 88
    s_load_dwordx2 s[38:39], s[0:1], 16
    s_load_dwordx2 s[40:41], s[0:1], 72
    v_and_b32 v1, 63, v0
    v_lshlrev_b32 v2, 4, v1
    v_and_b32 v4, 0x3ff, v0
    v_lshrrev_b32 v4, 6, v4
    s_and_b32 s21, s2, 7
    s_lshl_b32 s21, s21, 2
    v_readfirstlane_b32 s18, v4
    s_bfe_u32 s16, s2, 0x20003
    s_add_u32 s16, s16, s21
    s_lshr_b32 s17, s2, 5
    v_lshrrev_b32 v3, 3, v1
    v_lshlrev_b32 v3, 10, v3
    v_lshrrev_b32 v4, 4, v1
    v_lshlrev_b32 v5, 1, v4
    v_and_b32 v6, 7, v1
    v_xor_b32 v5, v5, v6
    v_lshl_add_u32 v8, v5, 4, v3
    v_add_u32 v9, 7168, v8
    v_add_u32 v10, 14336, v8
    v_add_u32 v11, 21504, v8
    s_waitcnt lgkmcnt(0)
    s_add_u32 s4, s38, 0
    s_addc_u32 s5, s39, 0
    s_mov_b32 s6, 524288
    s_mov_b32 s7, 0x20000
    s_add_u32 s8, s34, 75497472
    s_addc_u32 s9, s35, 0
    s_mov_b32 s10, 2097152
    s_mov_b32 s11, 0x20000
    s_add_u32 s12, s40, 0
    s_addc_u32 s13, s41, 0
    s_mov_b32 s14, 4194304
    s_mov_b32 s15, 0x20000
    s_barrier
    s_lshl_b32 s19, s18, 17
    s_lshl_b32 s21, s17, 7
    s_add_u32 s19, s19, s21
    s_lshl_b32 s22, s18, 14
    s_cmp_eq_u32 s18, 3
    s_cselect_b32 s22, 116736, s22
    s_add_u32 m0, s22, 0
    s_nop 0
    buffer_load_dwordx4 v8, s[4:7], s19 offen offset:0 lds
    buffer_load_dwordx4 v9, s[4:7], s19 offen offset:1024 lds
    buffer_load_dwordx4 v10, s[4:7], s19 offen offset:2048 lds
    buffer_load_dwordx4 v11, s[4:7], s19 offen offset:3072 lds
    s_add_u32 s19, s19, 32768
    s_add_u32 m0, s22, 4096
    s_nop 0
    buffer_load_dwordx4 v8, s[4:7], s19 offen offset:0 lds
    buffer_load_dwordx4 v9, s[4:7], s19 offen offset:1024 lds
    buffer_load_dwordx4 v10, s[4:7], s19 offen offset:2048 lds
    buffer_load_dwordx4 v11, s[4:7], s19 offen offset:3072 lds
    s_add_u32 s19, s19, 32768
    s_add_u32 m0, s22, 8192
    s_nop 0
    buffer_load_dwordx4 v8, s[4:7], s19 offen offset:0 lds
    buffer_load_dwordx4 v9, s[4:7], s19 offen offset:1024 lds
    buffer_load_dwordx4 v10, s[4:7], s19 offen offset:2048 lds
    buffer_load_dwordx4 v11, s[4:7], s19 offen offset:3072 lds
    s_add_u32 s19, s19, 32768
    s_add_u32 m0, s22, 12288
    s_nop 0
    buffer_load_dwordx4 v8, s[4:7], s19 offen offset:0 lds
    buffer_load_dwordx4 v9, s[4:7], s19 offen offset:1024 lds
    buffer_load_dwordx4 v10, s[4:7], s19 offen offset:2048 lds
    buffer_load_dwordx4 v11, s[4:7], s19 offen offset:3072 lds
    s_add_u32 s19, s19, 32768
    s_cmp_eq_u32 s18, 0
    s_cbranch_scc0 d_K4_NOSIG
    s_lshr_b32 s21, s2, 5
    s_add_u32 s21, s21, 72
    s_lshl_b32 s60, s21, 7
    s_lshl_b32 s61, s16, 2
    s_add_u32 s60, s60, s61
    v_and_b32 v5, 63, v0
    v_lshlrev_b32 v5, 16, v5
    v_mov_b32 v6, s63
    buffer_store_dword v6, v5, s[56:59], s60 offen sc1
    s_and_b32 s21, s2, 7
    s_add_u32 s21, s21, 72
    v_and_b32 v5, 31, v0
    v_lshlrev_b32 v5, 2, v5
    s_lshl_b32 s62, s21, 7
    s_mov_b32 s61, 0
d_W_D:
    buffer_load_dword v6, v5, s[56:59], s62 offen sc1
    s_waitcnt vmcnt(0)
    v_cmp_ne_u32 vcc, s63, v6
    s_nop 4
    s_cbranch_vccz d_WOK_D
    s_sleep 8
    s_add_u32 s61, s61, 1
    s_cmp_lt_u32 s61, 65536
    s_cbranch_scc1 d_W_D
d_WOK_D:
d_K4_NOSIG:
    s_barrier
    s_lshl_b32 s20, s16, 2
    s_add_u32 s20, s20, s18
    s_lshl_b32 s20, s20, 14
    buffer_load_dwordx4 v[128:131], v2, s[8:11], s20 offen offset:0 sc1
    buffer_load_dwordx4 v[132:135], v2, s[8:11], s20 offen offset:1024 sc1
    buffer_load_dwordx4 v[136:139], v2, s[8:11], s20 offen offset:2048 sc1
    buffer_load_dwordx4 v[140:143], v2, s[8:11], s20 offen offset:3072 sc1
    s_add_u32 s20, s20, 4096
    buffer_load_dwordx4 v[144:147], v2, s[8:11], s20 offen offset:0 sc1
    buffer_load_dwordx4 v[148:151], v2, s[8:11], s20 offen offset:1024 sc1
    buffer_load_dwordx4 v[152:155], v2, s[8:11], s20 offen offset:2048 sc1
    buffer_load_dwordx4 v[156:159], v2, s[8:11], s20 offen offset:3072 sc1
    s_add_u32 s20, s20, 4096
    buffer_load_dwordx4 v[160:163], v2, s[8:11], s20 offen offset:0 sc1
    buffer_load_dwordx4 v[164:167], v2, s[8:11], s20 offen offset:1024 sc1
    buffer_load_dwordx4 v[168:171], v2, s[8:11], s20 offen offset:2048 sc1
    buffer_load_dwordx4 v[172:175], v2, s[8:11], s20 offen offset:3072 sc1
    s_add_u32 s20, s20, 4096
    buffer_load_dwordx4 v[176:179], v2, s[8:11], s20 offen offset:0 sc1
    buffer_load_dwordx4 v[180:183], v2, s[8:11], s20 offen offset:1024 sc1
    buffer_load_dwordx4 v[184:187], v2, s[8:11], s20 offen offset:2048 sc1
    buffer_load_dwordx4 v[188:191], v2, s[8:11], s20 offen offset:3072 sc1
    v_lshrrev_b32 v4, 4, v1
    v_and_b32 v3, 15, v1
    v_lshrrev_b32 v5, 2, v3
    v_and_b32 v6, 1, v4
    v_lshl_add_u32 v6, v6, 2, v5
    v_lshrrev_b32 v56, 1, v4
    v_lshl_add_u32 v6, v56, 4, v6
    v_bfe_u32 v56, v6, 1, 2
    v_lshlrev_b32 v6, 7, v6
    v_and_b32 v57, 3, v3
    v_lshl_add_u32 v6, v57, 3, v6
    v_xor_b32 v57, 0, v56
    v_lshl_add_u32 v12, v57, 5, v6
    v_add_u32 v16, 116736, v12
    v_xor_b32 v57, 1, v56
    v_lshl_add_u32 v13, v57, 5, v6
    v_add_u32 v17, 116736, v13
    v_xor_b32 v57, 2, v56
    v_lshl_add_u32 v14, v57, 5, v6
    v_add_u32 v18, 116736, v14
    v_xor_b32 v57, 3, v56
    v_lshl_add_u32 v15, v57, 5, v6
    v_add_u32 v19, 116736, v15
    v_mov_b64 v[64:65], 0
    v_mov_b64 v[66:67], 0
    v_mov_b64 v[68:69], 0
    v_mov_b64 v[70:71], 0
    v_mov_b64 v[72:73], 0
    v_mov_b64 v[74:75], 0
    v_mov_b64 v[76:77], 0
    v_mov_b64 v[78:79], 0
    s_waitcnt vmcnt(16)
    s_barrier
    ds_read_b64_tr_b16 v[24:25], v12 offset:0
    ds_read_b64_tr_b16 v[26:27], v12 offset:1024
    ds_read_b64_tr_b16 v[28:29], v13 offset:0
    ds_read_b64_tr_b16 v[30:31], v13 offset:1024
    ds_read_b64_tr_b16 v[32:33], v14 offset:0
    ds_read_b64_tr_b16 v[34:35], v14 offset:1024
    ds_read_b64_tr_b16 v[36:37], v15 offset:0
    ds_read_b64_tr_b16 v[38:39], v15 offset:1024
    ds_read_b64_tr_b16 v[40:41], v12 offset:4096
    ds_read_b64_tr_b16 v[42:43], v12 offset:5120
    ds_read_b64_tr_b16 v[44:45], v13 offset:4096
    ds_read_b64_tr_b16 v[46:47], v13 offset:5120
    ds_read_b64_tr_b16 v[48:49], v14 offset:4096
    ds_read_b64_tr_b16 v[50:51], v14 offset:5120
    ds_read_b64_tr_b16 v[52:53], v15 offset:4096
    ds_read_b64_tr_b16 v[54:55], v15 offset:5120
    s_waitcnt vmcnt(15) lgkmcnt(8)
    v_mfma_f32_16x16x32_bf16 v[64:67], v[24:27], v[128:131], v[64:67]
    v_mfma_f32_16x16x32_bf16 v[68:71], v[28:31], v[128:131], v[68:71]
    v_mfma_f32_16x16x32_bf16 v[72:75], v[32:35], v[128:131], v[72:75]
    v_mfma_f32_16x16x32_bf16 v[76:79], v[36:39], v[128:131], v[76:79]
    ds_read_b64_tr_b16 v[24:25], v12 offset:8192
    ds_read_b64_tr_b16 v[26:27], v12 offset:9216
    ds_read_b64_tr_b16 v[28:29], v13 offset:8192
    ds_read_b64_tr_b16 v[30:31], v13 offset:9216
    ds_read_b64_tr_b16 v[32:33], v14 offset:8192
    ds_read_b64_tr_b16 v[34:35], v14 offset:9216
    ds_read_b64_tr_b16 v[36:37], v15 offset:8192
    ds_read_b64_tr_b16 v[38:39], v15 offset:9216
    s_waitcnt vmcnt(14) lgkmcnt(8)
    v_mfma_f32_16x16x32_bf16 v[64:67], v[40:43], v[132:135], v[64:67]
    v_mfma_f32_16x16x32_bf16 v[68:71], v[44:47], v[132:135], v[68:71]
    v_mfma_f32_16x16x32_bf16 v[72:75], v[48:51], v[132:135], v[72:75]
    v_mfma_f32_16x16x32_bf16 v[76:79], v[52:55], v[132:135], v[76:79]
    ds_read_b64_tr_b16 v[40:41], v12 offset:12288
    ds_read_b64_tr_b16 v[42:43], v12 offset:13312
    ds_read_b64_tr_b16 v[44:45], v13 offset:12288
    ds_read_b64_tr_b16 v[46:47], v13 offset:13312
    ds_read_b64_tr_b16 v[48:49], v14 offset:12288
    ds_read_b64_tr_b16 v[50:51], v14 offset:13312
    ds_read_b64_tr_b16 v[52:53], v15 offset:12288
    ds_read_b64_tr_b16 v[54:55], v15 offset:13312
    s_waitcnt vmcnt(13) lgkmcnt(8)
    v_mfma_f32_16x16x32_bf16 v[64:67], v[24:27], v[136:139], v[64:67]
    v_mfma_f32_16x16x32_bf16 v[68:71], v[28:31], v[136:139], v[68:71]
    v_mfma_f32_16x16x32_bf16 v[72:75], v[32:35], v[136:139], v[72:75]
    v_mfma_f32_16x16x32_bf16 v[76:79], v[36:39], v[136:139], v[76:79]
    ds_read_b64_tr_b16 v[24:25], v12 offset:16384
    ds_read_b64_tr_b16 v[26:27], v12 offset:17408
    ds_read_b64_tr_b16 v[28:29], v13 offset:16384
    ds_read_b64_tr_b16 v[30:31], v13 offset:17408
    ds_read_b64_tr_b16 v[32:33], v14 offset:16384
    ds_read_b64_tr_b16 v[34:35], v14 offset:17408
    ds_read_b64_tr_b16 v[36:37], v15 offset:16384
    ds_read_b64_tr_b16 v[38:39], v15 offset:17408
    s_waitcnt vmcnt(12) lgkmcnt(8)
    v_mfma_f32_16x16x32_bf16 v[64:67], v[40:43], v[140:143], v[64:67]
    v_mfma_f32_16x16x32_bf16 v[68:71], v[44:47], v[140:143], v[68:71]
    v_mfma_f32_16x16x32_bf16 v[72:75], v[48:51], v[140:143], v[72:75]
    v_mfma_f32_16x16x32_bf16 v[76:79], v[52:55], v[140:143], v[76:79]
    ds_read_b64_tr_b16 v[40:41], v12 offset:20480
    ds_read_b64_tr_b16 v[42:43], v12 offset:21504
    ds_read_b64_tr_b16 v[44:45], v13 offset:20480
    ds_read_b64_tr_b16 v[46:47], v13 offset:21504
    ds_read_b64_tr_b16 v[48:49], v14 offset:20480
    ds_read_b64_tr_b16 v[50:51], v14 offset:21504
    ds_read_b64_tr_b16 v[52:53], v15 offset:20480
    ds_read_b64_tr_b16 v[54:55], v15 offset:21504
    s_waitcnt vmcnt(11) lgkmcnt(8)
    v_mfma_f32_16x16x32_bf16 v[64:67], v[24:27], v[144:147], v[64:67]
    v_mfma_f32_16x16x32_bf16 v[68:71], v[28:31], v[144:147], v[68:71]
    v_mfma_f32_16x16x32_bf16 v[72:75], v[32:35], v[144:147], v[72:75]
    v_mfma_f32_16x16x32_bf16 v[76:79], v[36:39], v[144:147], v[76:79]
    ds_read_b64_tr_b16 v[24:25], v12 offset:24576
    ds_read_b64_tr_b16 v[26:27], v12 offset:25600
    ds_read_b64_tr_b16 v[28:29], v13 offset:24576
    ds_read_b64_tr_b16 v[30:31], v13 offset:25600
    ds_read_b64_tr_b16 v[32:33], v14 offset:24576
    ds_read_b64_tr_b16 v[34:35], v14 offset:25600
    ds_read_b64_tr_b16 v[36:37], v15 offset:24576
    ds_read_b64_tr_b16 v[38:39], v15 offset:25600
    s_waitcnt vmcnt(10) lgkmcnt(8)
    v_mfma_f32_16x16x32_bf16 v[64:67], v[40:43], v[148:151], v[64:67]
    v_mfma_f32_16x16x32_bf16 v[68:71], v[44:47], v[148:151], v[68:71]
    v_mfma_f32_16x16x32_bf16 v[72:75], v[48:51], v[148:151], v[72:75]
    v_mfma_f32_16x16x32_bf16 v[76:79], v[52:55], v[148:151], v[76:79]
    ds_read_b64_tr_b16 v[40:41], v12 offset:28672
    ds_read_b64_tr_b16 v[42:43], v12 offset:29696
    ds_read_b64_tr_b16 v[44:45], v13 offset:28672
    ds_read_b64_tr_b16 v[46:47], v13 offset:29696
    ds_read_b64_tr_b16 v[48:49], v14 offset:28672
    ds_read_b64_tr_b16 v[50:51], v14 offset:29696
    ds_read_b64_tr_b16 v[52:53], v15 offset:28672
    ds_read_b64_tr_b16 v[54:55], v15 offset:29696
    s_waitcnt vmcnt(9) lgkmcnt(8)
    v_mfma_f32_16x16x32_bf16 v[64:67], v[24:27], v[152:155], v[64:67]
    v_mfma_f32_16x16x32_bf16 v[68:71], v[28:31], v[152:155], v[68:71]
    v_mfma_f32_16x16x32_bf16 v[72:75], v[32:35], v[152:155], v[72:75]
    v_mfma_f32_16x16x32_bf16 v[76:79], v[36:39], v[152:155], v[76:79]
    ds_read_b64_tr_b16 v[24:25], v12 offset:32768
    ds_read_b64_tr_b16 v[26:27], v12 offset:33792
    ds_read_b64_tr_b16 v[28:29], v13 offset:32768
    ds_read_b64_tr_b16 v[30:31], v13 offset:33792
    ds_read_b64_tr_b16 v[32:33], v14 offset:32768
    ds_read_b64_tr_b16 v[34:35], v14 offset:33792
    ds_read_b64_tr_b16 v[36:37], v15 offset:32768
    ds_read_b64_tr_b16 v[38:39], v15 offset:33792
    s_waitcnt vmcnt(8) lgkmcnt(8)
    v_mfma_f32_16x16x32_bf16 v[64:67], v[40:43], v[156:159], v[64:67]
    v_mfma_f32_16x16x32_bf16 v[68:71], v[44:47], v[156:159], v[68:71]
    v_mfma_f32_16x16x32_bf16 v[72:75], v[48:51], v[156:159], v[72:75]
    v_mfma_f32_16x16x32_bf16 v[76:79], v[52:55], v[156:159], v[76:79]
    ds_read_b64_tr_b16 v[40:41], v12 offset:36864
    ds_read_b64_tr_b16 v[42:43], v12 offset:37888
    ds_read_b64_tr_b16 v[44:45], v13 offset:36864
    ds_read_b64_tr_b16 v[46:47], v13 offset:37888
    ds_read_b64_tr_b16 v[48:49], v14 offset:36864
    ds_read_b64_tr_b16 v[50:51], v14 offset:37888
    ds_read_b64_tr_b16 v[52:53], v15 offset:36864
    ds_read_b64_tr_b16 v[54:55], v15 offset:37888
    s_waitcnt vmcnt(7) lgkmcnt(8)
    v_mfma_f32_16x16x32_bf16 v[64:67], v[24:27], v[160:163], v[64:67]
    v_mfma_f32_16x16x32_bf16 v[68:71], v[28:31], v[160:163], v[68:71]
    v_mfma_f32_16x16x32_bf16 v[72:75], v[32:35], v[160:163], v[72:75]
    v_mfma_f32_16x16x32_bf16 v[76:79], v[36:39], v[160:163], v[76:79]
    ds_read_b64_tr_b16 v[24:25], v12 offset:40960
    ds_read_b64_tr_b16 v[26:27], v12 offset:41984
    ds_read_b64_tr_b16 v[28:29], v13 offset:40960
    ds_read_b64_tr_b16 v[30:31], v13 offset:41984
    ds_read_b64_tr_b16 v[32:33], v14 offset:40960
    ds_read_b64_tr_b16 v[34:35], v14 offset:41984
    ds_read_b64_tr_b16 v[36:37], v15 offset:40960
    ds_read_b64_tr_b16 v[38:39], v15 offset:41984
    s_waitcnt vmcnt(6) lgkmcnt(8)
    v_mfma_f32_16x16x32_bf16 v[64:67], v[40:43], v[164:167], v[64:67]
    v_mfma_f32_16x16x32_bf16 v[68:71], v[44:47], v[164:167], v[68:71]
    v_mfma_f32_16x16x32_bf16 v[72:75], v[48:51], v[164:167], v[72:75]
    v_mfma_f32_16x16x32_bf16 v[76:79], v[52:55], v[164:167], v[76:79]
    ds_read_b64_tr_b16 v[40:41], v12 offset:45056
    ds_read_b64_tr_b16 v[42:43], v12 offset:46080
    ds_read_b64_tr_b16 v[44:45], v13 offset:45056
    ds_read_b64_tr_b16 v[46:47], v13 offset:46080
    ds_read_b64_tr_b16 v[48:49], v14 offset:45056
    ds_read_b64_tr_b16 v[50:51], v14 offset:46080
    ds_read_b64_tr_b16 v[52:53], v15 offset:45056
    ds_read_b64_tr_b16 v[54:55], v15 offset:46080
    s_waitcnt vmcnt(5) lgkmcnt(8)
    v_mfma_f32_16x16x32_bf16 v[64:67], v[24:27], v[168:171], v[64:67]
    v_mfma_f32_16x16x32_bf16 v[68:71], v[28:31], v[168:171], v[68:71]
    v_mfma_f32_16x16x32_bf16 v[72:75], v[32:35], v[168:171], v[72:75]
    v_mfma_f32_16x16x32_bf16 v[76:79], v[36:39], v[168:171], v[76:79]
    ds_read_b64_tr_b16 v[24:25], v16 offset:0
    ds_read_b64_tr_b16 v[26:27], v16 offset:1024
    ds_read_b64_tr_b16 v[28:29], v17 offset:0
    ds_read_b64_tr_b16 v[30:31], v17 offset:1024
    ds_read_b64_tr_b16 v[32:33], v18 offset:0
    ds_read_b64_tr_b16 v[34:35], v18 offset:1024
    ds_read_b64_tr_b16 v[36:37], v19 offset:0
    ds_read_b64_tr_b16 v[38:39], v19 offset:1024
    s_waitcnt vmcnt(4) lgkmcnt(8)
    v_mfma_f32_16x16x32_bf16 v[64:67], v[40:43], v[172:175], v[64:67]
    v_mfma_f32_16x16x32_bf16 v[68:71], v[44:47], v[172:175], v[68:71]
    v_mfma_f32_16x16x32_bf16 v[72:75], v[48:51], v[172:175], v[72:75]
    v_mfma_f32_16x16x32_bf16 v[76:79], v[52:55], v[172:175], v[76:79]
    ds_read_b64_tr_b16 v[40:41], v16 offset:4096
    ds_read_b64_tr_b16 v[42:43], v16 offset:5120
    ds_read_b64_tr_b16 v[44:45], v17 offset:4096
    ds_read_b64_tr_b16 v[46:47], v17 offset:5120
    ds_read_b64_tr_b16 v[48:49], v18 offset:4096
    ds_read_b64_tr_b16 v[50:51], v18 offset:5120
    ds_read_b64_tr_b16 v[52:53], v19 offset:4096
    ds_read_b64_tr_b16 v[54:55], v19 offset:5120
    s_waitcnt vmcnt(3) lgkmcnt(8)
    v_mfma_f32_16x16x32_bf16 v[64:67], v[24:27], v[176:179], v[64:67]
    v_mfma_f32_16x16x32_bf16 v[68:71], v[28:31], v[176:179], v[68:71]
    v_mfma_f32_16x16x32_bf16 v[72:75], v[32:35], v[176:179], v[72:75]
    v_mfma_f32_16x16x32_bf16 v[76:79], v[36:39], v[176:179], v[76:79]
    ds_read_b64_tr_b16 v[24:25], v16 offset:8192
    ds_read_b64_tr_b16 v[26:27], v16 offset:9216
    ds_read_b64_tr_b16 v[28:29], v17 offset:8192
    ds_read_b64_tr_b16 v[30:31], v17 offset:9216
    ds_read_b64_tr_b16 v[32:33], v18 offset:8192
    ds_read_b64_tr_b16 v[34:35], v18 offset:9216
    ds_read_b64_tr_b16 v[36:37], v19 offset:8192
    ds_read_b64_tr_b16 v[38:39], v19 offset:9216
    s_waitcnt vmcnt(2) lgkmcnt(8)
    v_mfma_f32_16x16x32_bf16 v[64:67], v[40:43], v[180:183], v[64:67]
    v_mfma_f32_16x16x32_bf16 v[68:71], v[44:47], v[180:183], v[68:71]
    v_mfma_f32_16x16x32_bf16 v[72:75], v[48:51], v[180:183], v[72:75]
    v_mfma_f32_16x16x32_bf16 v[76:79], v[52:55], v[180:183], v[76:79]
    ds_read_b64_tr_b16 v[40:41], v16 offset:12288
    ds_read_b64_tr_b16 v[42:43], v16 offset:13312
    ds_read_b64_tr_b16 v[44:45], v17 offset:12288
    ds_read_b64_tr_b16 v[46:47], v17 offset:13312
    ds_read_b64_tr_b16 v[48:49], v18 offset:12288
    ds_read_b64_tr_b16 v[50:51], v18 offset:13312
    ds_read_b64_tr_b16 v[52:53], v19 offset:12288
    ds_read_b64_tr_b16 v[54:55], v19 offset:13312
    s_waitcnt vmcnt(1) lgkmcnt(8)
    v_mfma_f32_16x16x32_bf16 v[64:67], v[24:27], v[184:187], v[64:67]
    v_mfma_f32_16x16x32_bf16 v[68:71], v[28:31], v[184:187], v[68:71]
    v_mfma_f32_16x16x32_bf16 v[72:75], v[32:35], v[184:187], v[72:75]
    v_mfma_f32_16x16x32_bf16 v[76:79], v[36:39], v[184:187], v[76:79]
    s_waitcnt vmcnt(0) lgkmcnt(0)
    v_mfma_f32_16x16x32_bf16 v[64:67], v[40:43], v[188:191], v[64:67]
    v_mfma_f32_16x16x32_bf16 v[68:71], v[44:47], v[188:191], v[68:71]
    v_mfma_f32_16x16x32_bf16 v[72:75], v[48:51], v[188:191], v[72:75]
    v_mfma_f32_16x16x32_bf16 v[76:79], v[52:55], v[188:191], v[76:79]
    v_and_b32 v4, 15, v1
    v_lshlrev_b32 v4, 11, v4
    v_lshrrev_b32 v5, 4, v1
    v_lshl_add_u32 v20, v5, 3, v4
    s_lshl_b32 s21, s16, 17
    s_lshl_b32 s22, s18, 15
    s_add_u32 s21, s21, s22
    s_lshl_b32 s22, s17, 7
    s_add_u32 s21, s21, s22
    s_nop 2
    v_cvt_pk_bf16_f32 v56, v64, v65
    v_cvt_pk_bf16_f32 v57, v66, v67
    buffer_store_dwordx2 v[56:57], v20, s[12:15], s21 offen offset:0
    v_cvt_pk_bf16_f32 v58, v68, v69
    v_cvt_pk_bf16_f32 v59, v70, v71
    buffer_store_dwordx2 v[58:59], v20, s[12:15], s21 offen offset:32
    v_cvt_pk_bf16_f32 v60, v72, v73
    v_cvt_pk_bf16_f32 v61, v74, v75
    buffer_store_dwordx2 v[60:61], v20, s[12:15], s21 offen offset:64
    v_cvt_pk_bf16_f32 v62, v76, v77
    v_cvt_pk_bf16_f32 v63, v78, v79
    buffer_store_dwordx2 v[62:63], v20, s[12:15], s21 offen offset:96
    s_waitcnt vmcnt(0) lgkmcnt(0)
    s_endpgm
MEGA_END:
    s_endpgm
.section .rodata,"a"
.p2align 6
.amdhsa_kernel concat_heads__mha_block__compressed_kv_cla__prompt_kernel
  .amdhsa_next_free_vgpr 254
  .amdhsa_next_free_sgpr 88
  .amdhsa_accum_offset 256
  .amdhsa_group_segment_fixed_size 0
  .amdhsa_kernarg_size 96
  .amdhsa_user_sgpr_count 2
  .amdhsa_user_sgpr_kernarg_segment_ptr 1
  .amdhsa_system_sgpr_workgroup_id_x 1
.end_amdhsa_kernel
```
